```python
import torch

def _softmax(x, axis=-1):
    return torch.softmax(x, dim=axis)

def _gelu(x):
    return torch.nn.functional.gelu(x, approximate='tanh')

def _silu(x):
    return torch.nn.functional.silu(x)

def _sigmoid(x):
    return torch.sigmoid(x)

def _layernorm(x, axis=-1, eps=1e-05):
    m = x.mean(dim=axis, keepdim=True)
    v = x.var(dim=axis, keepdim=True, unbiased=False)
    return (x - m) / torch.sqrt(v + eps)

def _scatter_add(tgt, idx, src, axis=0):
    return tgt.clone().index_add_(axis, idx, src)

def _segment_sum(src, seg, n):
    out = torch.zeros((n,) + src.shape[1:], dtype=src.dtype)
    return out.index_add_(0, seg, src)

def _pad(x, pw):
    flat = tuple((v for pair in reversed(pw) for v in pair))
    return torch.nn.functional.pad(x, flat)
kernel_name = 'concat_heads__memory_aug_recurrent_mem_tr__mha_block__prompt'

def setup_inputs():

    _w = lambda a: (lambda t: t.to(torch.bfloat16) if t.is_floating_point() else t)(torch.as_tensor(a))

    def _A_setup():
        B, S, Dm = (1, 2048, 640)
        H, Dh = (32, 128)
        M, seg = (8, 32)
        seg = min(seg, S)
        S = S // seg * seg
        return {'x': _w((lambda *s: torch.randn(*s, dtype=torch.bfloat16) * 0.05)(B, S, Dm)), 'mem0': _w((lambda *s: torch.randn(*s, dtype=torch.bfloat16) * 0.8)(B, M, Dm)), 'Wq': _w((lambda *s: torch.randn(*s, dtype=torch.bfloat16) * 1.6)(Dm, H, Dh) * Dm ** (-0.5)), 'Wk': _w((lambda *s: torch.randn(*s, dtype=torch.bfloat16) * 1.6)(Dm, H, Dh) * Dm ** (-0.5)), 'Wv': _w((lambda *s: torch.randn(*s, dtype=torch.bfloat16) * 0.8)(Dm, H, Dh) * Dm ** (-0.5)), 'Wo': _w((lambda *s: torch.randn(*s, dtype=torch.bfloat16) * 0.8)(H, Dh, Dm) * (H * Dh) ** (-0.5)), 'seg_len': seg}
    _A_in = _A_setup()

    def _B_setup():
        B, S, D, H = (1, 2048, 640, 32)
        return {'x': _w((lambda *s: torch.randn(*s, dtype=torch.bfloat16) * 0.2)(B, S, D)), 'wqkv': _w((lambda *s: torch.randn(*s, dtype=torch.bfloat16) * 0.2)(D, 3 * D)), 'wo': _w((lambda *s: torch.randn(*s, dtype=torch.bfloat16) * 0.05)(D, D))}
    _B_in = _B_setup()
    return {'A_x': _A_in['x'], 'A_mem0': _A_in['mem0'], 'A_Wq': _A_in['Wq'], 'A_Wk': _A_in['Wk'], 'A_Wv': _A_in['Wv'], 'A_Wo': _A_in['Wo'], 'A_seg_len': _A_in['seg_len'], 'B_x': _B_in['x'], 'B_wqkv': _B_in['wqkv'], 'B_wo': _B_in['wo']}

def reference(A_x, A_mem0, A_Wq, A_Wk, A_Wv, A_Wo, A_seg_len, B_x, B_wqkv, B_wo):

    def _A_ref(x, mem0, Wq, Wk, Wv, Wo, seg_len):
        B, S, Dm = x.shape
        H, Dh = (Wq.shape[1], Wq.shape[2])
        M = mem0.shape[1]
        scale = Dh ** (-0.5)
        n_seg = S // seg_len
        L = M + seg_len
        idx = torch.arange(L)
        mask = (idx[:, None] < M) | (idx[:, None] >= idx[None, :])
        mem = mem0
        outs = []
        for s in range(n_seg):
            xs = x[:, s * seg_len:(s + 1) * seg_len, :].clone()
            h = torch.concatenate([mem, xs], axis=1)
            q = torch.einsum('btd,dhe->bhte', h, Wq)
            k = torch.einsum('btd,dhe->bhte', h, Wk)
            v = torch.einsum('btd,dhe->bhte', h, Wv)
            scores = torch.einsum('bhqe,bhke->bhqk', q, k) * scale
            scores = torch.where(mask[None, None], scores, -1000000000.0)
            p = _softmax(scores, axis=-1)
            o = torch.einsum('bhqk,bhke->bhqe', p, v)
            o = torch.einsum('bhte,hed->btd', o, Wo)
            mem = o[:, :M, :].clone()
            outs.append(o[:, M:, :])
        return torch.concatenate(outs, axis=1)

    def _B_ref(x, wqkv, wo):
        B, S, D = x.shape
        H = 32
        Dh = D // H
        qkv = (lambda x, *d: x.permute(*d))((x @ wqkv).reshape(B, S, 3, H, Dh), 2, 0, 3, 1, 4)
        q, k, v = (qkv[0], qkv[1], qkv[2])
        scores = torch.einsum('bhqd,bhkd->bhqk', q, k) * Dh ** (-0.5)
        p = _softmax(scores, axis=-1)
        o = torch.einsum('bhqk,bhkd->bhqd', p, v)
        return (lambda x, *d: x.permute(*d))(o, 0, 2, 1, 3).reshape(B, S, D) @ wo
    a = _A_ref(A_x, A_mem0, A_Wq, A_Wk, A_Wv, A_Wo, A_seg_len)
    b = _B_ref(B_x, B_wqkv, B_wo)
    return torch.concatenate([a, b], axis=-1)
```

```asm
; @launch grid=(256,1,1) block=(512,1,1) lds=163840
.amdgcn_target "amdgcn-amd-amdhsa--gfx950"
.text
.globl concat_heads__memory_aug_recurrent_mem_tr__mha_block__prompt_kernel
.p2align 8
.type concat_heads__memory_aug_recurrent_mem_tr__mha_block__prompt_kernel,@function
concat_heads__memory_aug_recurrent_mem_tr__mha_block__prompt_kernel:
  s_cmp_ge_u32 s2, 256
  s_cbranch_scc1 L_exit
  s_load_dwordx4 s[4:7], s[0:1], 88
  s_getreg_b32 s98, hwreg(HW_REG_XCC_ID)
  s_and_b32 s98, s98, 15
  v_and_b32 v1, 63, v0
  v_lshrrev_b32 v2, 6, v0
s_nop 0
  v_readfirstlane_b32 s30, v2
  s_waitcnt lgkmcnt(0)
  s_mov_b32 s8, s6
  s_and_b32 s9, s7, 0xffff
  s_mov_b32 s10, 0x10000000
  s_mov_b32 s11, 0x20000
  s_mov_b32 s12, s4
  s_and_b32 s13, s5, 0xffff
  s_mov_b32 s14, 0x100
  s_mov_b32 s15, 0x20000
  s_mov_b32 s33, 131072
  s_mov_b32 s31, 0
  v_mov_b32 v9, 0
  s_cmp_lg_u32 s30, 0
  s_cbranch_scc1 L_st_clr
  s_and_b32 s35, s98, 3
  s_lshl_b32 s35, s35, 4
  s_bfe_u32 s36, s98, 0x10002
  s_lshl_b32 s36, s36, 7
  s_add_u32 s35, s35, s36
  s_lshr_b32 s36, s98, 3
  s_lshl_b32 s36, s36, 6
  s_add_u32 s35, s35, s36
  v_mov_b32 v8, s35
  v_mov_b32 v9, 1
  s_mov_b64 exec, 1
  buffer_atomic_add v9, v8, s[12:15], 0 offen sc0
  s_mov_b64 exec, -1
  s_branch L_st_clr2
L_st_clr:
  s_getpc_b64 s[16:17]
L_pc:
  s_sub_u32 s16, s16, L_pc-concat_heads__memory_aug_recurrent_mem_tr__mha_block__prompt_kernel
  s_subb_u32 s17, s17, 0
  s_and_b32 s17, s17, 0xffff
  s_mov_b32 s18, L_exit-concat_heads__memory_aug_recurrent_mem_tr__mha_block__prompt_kernel
  s_mov_b32 s19, 0x20000
  s_lshr_b32 s20, s2, 3
  s_mul_i32 s20, s20, 3072
  v_lshlrev_b32 v3, 4, v0
  v_subrev_u32 v3, 1024, v3
  buffer_load_dwordx4 v[12:15], v3, s[16:19], s20 offen
L_st_clr2:
  s_lshl_b32 s35, s2, 14
  s_sub_u32 s36, s35, 3801088
  s_cmp_lt_u32 s36, 0xc000
  s_cselect_b32 s36, 0, -1
  v_mov_b32 v4, s36
  v_mov_b32 v5, s36
  v_mov_b32 v6, s36
  v_mov_b32 v7, s36
  v_lshlrev_b32 v2, 4, v0
  s_add_u32 s36, s35, 8192
  buffer_store_dwordx4 v[4:7], v2, s[8:11], s35 offen sc1
  buffer_store_dwordx4 v[4:7], v2, s[8:11], s36 offen sc1
L_st_noclr:
  s_cmp_lg_u32 s30, 0
  s_cbranch_scc1 L_st_w1
  s_waitcnt vmcnt(2)
  v_readfirstlane_b32 s35, v9
s_nop 1
  v_mov_b32 v4, s35
  v_mov_b32 v8, 0
  ds_write_b32 v8, v4
  s_waitcnt lgkmcnt(0)
L_st_w1:
  s_barrier
  v_mov_b32 v8, 0
  ds_read_b32 v4, v8
  s_waitcnt lgkmcnt(0)
  v_readfirstlane_b32 s99, v4
s_nop 3
  s_min_u32 s29, s99, 31
  s_and_b32 s28, s98, 7
  s_waitcnt vmcnt(0)
  s_barrier
  s_cmp_lg_u32 s30, 0
  s_cbranch_scc1 L_dispatch
  s_and_b32 s35, s98, 3
  s_lshl_b32 s35, s35, 4
  s_bfe_u32 s36, s98, 0x10002
  s_lshl_b32 s36, s36, 7
  s_add_u32 s35, s35, s36
  s_lshr_b32 s36, s98, 3
  s_lshl_b32 s36, s36, 6
  s_add_u32 s35, s35, s36
  s_add_u32 s35, s35, 8
  v_mov_b32 v8, s35
  v_mov_b32 v9, 1
  s_mov_b64 exec, 1
  buffer_atomic_add v9, v8, s[12:15], 0 offen
  s_mov_b64 exec, -1
L_dispatch:
  s_cmp_ge_u32 s28, 4
  s_cbranch_scc1 L_hi
  s_cmp_lt_u32 s29, 24
  s_cbranch_scc1 L_chain
  s_lshl_b32 s41, s28, 3
  s_add_u32 s41, s41, s29
  s_add_u32 s41, s41, 8
  s_branch L_brole
L_hi:
  s_sub_u32 s34, s28, 4
  s_mul_i32 s41, s34, 12
  s_add_u32 s41, s41, s29
  s_cmp_lt_u32 s29, 12
  s_cbranch_scc1 L_proj
  s_lshl_b32 s41, s34, 3
  s_add_u32 s41, s41, s29
  s_sub_u32 s41, s41, 12
  s_cmp_lt_u32 s29, 20
  s_cbranch_scc1 L_brole
  s_mul_i32 s41, s34, 10
  s_add_u32 s41, s41, s29
  s_sub_u32 s41, s41, 20
  s_cmp_lt_u32 s29, 30
  s_cbranch_scc1 L_out
  s_lshl_b32 s41, s34, 1
  s_add_u32 s41, s41, s29
  s_sub_u32 s41, s41, 30
  s_branch L_att
L_proj:
  s_lshr_b32 s42, s41, 4
  s_and_b32 s43, s41, 15
  s_lshl_b32 s34, s42, 3
  s_add_u32 s34, s34, 16
  s_load_dwordx2 s[4:5], s[0:1], s34
  s_load_dwordx2 s[6:7], s[0:1], 0
  s_waitcnt lgkmcnt(0)
  s_mov_b32 s16, s4
  s_and_b32 s17, s5, 0xffff
  s_mov_b32 s18, 0x500000
  s_mov_b32 s19, 0x20000
  s_mov_b32 s20, s6
  s_and_b32 s21, s7, 0xffff
  s_mov_b32 s22, 0x280000
  s_mov_b32 s23, 0x20000
  v_lshlrev_b32 v2, 4, v0
  v_add_u32 v10, 0, v0
  v_mul_u32_u24 v11, 52429, v10
  v_lshrrev_b32 v11, 22, v11
  v_add_u32 v11, v11, v10
  v_lshlrev_b32 v3, 4, v11
  v_add_u32 v10, 512, v0
  v_mul_u32_u24 v11, 52429, v10
  v_lshrrev_b32 v11, 22, v11
  v_add_u32 v11, v11, v10
  v_lshlrev_b32 v4, 4, v11
  v_add_u32 v10, 1024, v0
  v_mul_u32_u24 v11, 52429, v10
  v_lshrrev_b32 v11, 22, v11
  v_add_u32 v11, v11, v10
  v_lshlrev_b32 v5, 4, v11
  v_add_u32 v10, 1536, v0
  v_mul_u32_u24 v11, 52429, v10
  v_lshrrev_b32 v11, 22, v11
  v_add_u32 v11, v11, v10
  v_lshlrev_b32 v6, 4, v11
  v_add_u32 v10, 2048, v0
  v_mul_u32_u24 v11, 52429, v10
  v_lshrrev_b32 v11, 22, v11
  v_add_u32 v11, v11, v10
  v_lshlrev_b32 v7, 4, v11
  s_cmp_lg_u32 s42, 0
  s_cselect_b32 s49, 3, 0
  s_mul_i32 s50, s49, 40960
  s_add_u32 s34, s50, 0
  buffer_load_dwordx4 v[208:211], v2, s[20:23], s34 offen
  s_add_u32 s34, s50, 8192
  buffer_load_dwordx4 v[212:215], v2, s[20:23], s34 offen
  s_add_u32 s34, s50, 16384
  buffer_load_dwordx4 v[216:219], v2, s[20:23], s34 offen
  s_add_u32 s34, s50, 24576
  buffer_load_dwordx4 v[220:223], v2, s[20:23], s34 offen
  s_add_u32 s34, s50, 32768
  buffer_load_dwordx4 v[224:227], v2, s[20:23], s34 offen
  v_lshrrev_b32 v10, 5, v0
  v_and_b32 v11, 31, v0
  v_lshlrev_b32 v12, 13, v10
  v_lshl_add_u32 v12, v11, 4, v12
  s_lshl_b32 s34, s43, 9
  v_add_u32 v12, s34, v12
  s_mov_b32 s34, 0
  buffer_load_dwordx4 v[32:35], v12, s[16:19], s34 offen
  s_mov_b32 s34, 131072
  buffer_load_dwordx4 v[36:39], v12, s[16:19], s34 offen
  s_mov_b32 s34, 262144
  buffer_load_dwordx4 v[40:43], v12, s[16:19], s34 offen
  s_mov_b32 s34, 393216
  buffer_load_dwordx4 v[44:47], v12, s[16:19], s34 offen
  s_mov_b32 s34, 524288
  buffer_load_dwordx4 v[48:51], v12, s[16:19], s34 offen
  s_mov_b32 s34, 655360
  buffer_load_dwordx4 v[52:55], v12, s[16:19], s34 offen
  s_mov_b32 s34, 786432
  buffer_load_dwordx4 v[56:59], v12, s[16:19], s34 offen
  s_mov_b32 s34, 917504
  buffer_load_dwordx4 v[60:63], v12, s[16:19], s34 offen
  s_mov_b32 s34, 1048576
  buffer_load_dwordx4 v[64:67], v12, s[16:19], s34 offen
  s_mov_b32 s34, 1179648
  buffer_load_dwordx4 v[68:71], v12, s[16:19], s34 offen
  s_mov_b32 s34, 1310720
  buffer_load_dwordx4 v[72:75], v12, s[16:19], s34 offen
  s_mov_b32 s34, 1441792
  buffer_load_dwordx4 v[76:79], v12, s[16:19], s34 offen
  s_mov_b32 s34, 1572864
  buffer_load_dwordx4 v[80:83], v12, s[16:19], s34 offen
  s_mov_b32 s34, 1703936
  buffer_load_dwordx4 v[84:87], v12, s[16:19], s34 offen
  s_mov_b32 s34, 1835008
  buffer_load_dwordx4 v[88:91], v12, s[16:19], s34 offen
  s_mov_b32 s34, 1966080
  buffer_load_dwordx4 v[92:95], v12, s[16:19], s34 offen
  s_mov_b32 s34, 2097152
  buffer_load_dwordx4 v[96:99], v12, s[16:19], s34 offen
  s_mov_b32 s34, 2228224
  buffer_load_dwordx4 v[100:103], v12, s[16:19], s34 offen
  s_mov_b32 s34, 2359296
  buffer_load_dwordx4 v[104:107], v12, s[16:19], s34 offen
  s_mov_b32 s34, 2490368
  buffer_load_dwordx4 v[108:111], v12, s[16:19], s34 offen
  s_mov_b32 s34, 2621440
  buffer_load_dwordx4 v[112:115], v12, s[16:19], s34 offen
  s_mov_b32 s34, 2752512
  buffer_load_dwordx4 v[116:119], v12, s[16:19], s34 offen
  s_mov_b32 s34, 2883584
  buffer_load_dwordx4 v[120:123], v12, s[16:19], s34 offen
  s_mov_b32 s34, 3014656
  buffer_load_dwordx4 v[124:127], v12, s[16:19], s34 offen
  s_mov_b32 s34, 3145728
  buffer_load_dwordx4 v[128:131], v12, s[16:19], s34 offen
  s_mov_b32 s34, 3276800
  buffer_load_dwordx4 v[132:135], v12, s[16:19], s34 offen
  s_mov_b32 s34, 3407872
  buffer_load_dwordx4 v[136:139], v12, s[16:19], s34 offen
  s_mov_b32 s34, 3538944
  buffer_load_dwordx4 v[140:143], v12, s[16:19], s34 offen
  s_mov_b32 s34, 3670016
  buffer_load_dwordx4 v[144:147], v12, s[16:19], s34 offen
  s_mov_b32 s34, 3801088
  buffer_load_dwordx4 v[148:151], v12, s[16:19], s34 offen
  s_mov_b32 s34, 3932160
  buffer_load_dwordx4 v[152:155], v12, s[16:19], s34 offen
  s_mov_b32 s34, 4063232
  buffer_load_dwordx4 v[156:159], v12, s[16:19], s34 offen
  s_mov_b32 s34, 4194304
  buffer_load_dwordx4 v[160:163], v12, s[16:19], s34 offen
  s_mov_b32 s34, 4325376
  buffer_load_dwordx4 v[164:167], v12, s[16:19], s34 offen
  s_mov_b32 s34, 4456448
  buffer_load_dwordx4 v[168:171], v12, s[16:19], s34 offen
  s_mov_b32 s34, 4587520
  buffer_load_dwordx4 v[172:175], v12, s[16:19], s34 offen
  s_mov_b32 s34, 4718592
  buffer_load_dwordx4 v[176:179], v12, s[16:19], s34 offen
  s_mov_b32 s34, 4849664
  buffer_load_dwordx4 v[180:183], v12, s[16:19], s34 offen
  s_mov_b32 s34, 4980736
  buffer_load_dwordx4 v[184:187], v12, s[16:19], s34 offen
  s_mov_b32 s34, 5111808
  buffer_load_dwordx4 v[188:191], v12, s[16:19], s34 offen
  s_add_u32 s34, s50, 40960
  buffer_load_dwordx4 v[228:231], v2, s[20:23], s34 offen
  s_add_u32 s34, s50, 49152
  buffer_load_dwordx4 v[232:235], v2, s[20:23], s34 offen
  s_add_u32 s34, s50, 57344
  buffer_load_dwordx4 v[236:239], v2, s[20:23], s34 offen
  s_add_u32 s34, s50, 65536
  buffer_load_dwordx4 v[240:243], v2, s[20:23], s34 offen
  s_add_u32 s34, s50, 73728
  buffer_load_dwordx4 v[244:247], v2, s[20:23], s34 offen
  v_and_b32 v13, 3, v10
  v_lshlrev_b32 v13, 1, v13
  v_lshrrev_b32 v14, 1, v11
  v_add_u32 v13, v13, v14
  v_and_b32 v13, 15, v13
  v_lshlrev_b32 v13, 5, v13
  v_and_b32 v14, 1, v11
  v_lshl_add_u32 v13, v14, 4, v13
  v_lshl_add_u32 v13, v10, 9, v13
  v_add_u32 v13, 83968, v13
  v_lshrrev_b32 v10, 4, v1
  v_lshrrev_b32 v11, 1, v10
  v_and_b32 v10, 1, v10
  v_bfe_u32 v14, v1, 2, 2
  v_lshl_add_u32 v11, v11, 3, v14
  v_lshlrev_b32 v11, 9, v11
  v_lshl_add_u32 v10, v14, 1, v10
  s_lshl_b32 s34, s30, 1
  v_add_u32 v10, s34, v10
  v_and_b32 v10, 15, v10
  v_lshl_add_u32 v11, v10, 5, v11
  v_and_b32 v10, 3, v1
  v_lshl_add_u32 v14, v10, 3, v11
  v_add_u32 v14, 83968, v14
  s_lshr_b32 s34, s30, 2
  s_lshl_b32 s35, s43, 1
  s_add_u32 s34, s34, s35
  s_lshl_b32 s34, s34, 13
  s_and_b32 s35, s30, 3
  v_lshrrev_b32 v10, 5, v1
  v_and_b32 v11, 15, v1
  v_lshl_add_u32 v11, v10, 4, v11
  v_lshlrev_b32 v11, 4, v11
  v_bfe_u32 v10, v1, 4, 1
  s_cmp_eq_u32 s42, 2
  s_cbranch_scc1 L_pj_ov
  s_lshl_b32 s35, s35, 10
  v_lshl_add_u32 v11, v10, 12, v11
  s_branch L_pj_od
L_pj_ov:
  s_lshl_b32 s35, s35, 11
  v_lshl_add_u32 v11, v10, 10, v11
L_pj_od:
  s_add_u32 s34, s34, s35
  v_add_u32 v8, s34, v11
  s_add_u32 s35, s42, 2
  s_cmp_eq_u32 s42, 0
  s_cselect_b32 s35, 3, s42
  s_lshl_b32 s44, s35, 24
  v_and_b32 v10, 31, v1
  v_mul_u32_u24 v10, 1296, v10
  v_lshrrev_b32 v11, 5, v1
  v_lshl_add_u32 v9, v11, 4, v10
  s_waitcnt vmcnt(45)
  ds_write_b128 v3, v[208:211]
  ds_write_b128 v4, v[212:215]
  ds_write_b128 v5, v[216:219]
  ds_write_b128 v6, v[220:223]
  ds_write_b128 v7, v[224:227]
  s_waitcnt lgkmcnt(0)
  s_add_u32 s34, s50, 81920
  buffer_load_dwordx4 v[208:211], v2, s[20:23], s34 offen
  s_add_u32 s34, s50, 90112
  buffer_load_dwordx4 v[212:215], v2, s[20:23], s34 offen
  s_add_u32 s34, s50, 98304
  buffer_load_dwordx4 v[216:219], v2, s[20:23], s34 offen
  s_add_u32 s34, s50, 106496
  buffer_load_dwordx4 v[220:223], v2, s[20:23], s34 offen
  s_add_u32 s34, s50, 114688
  buffer_load_dwordx4 v[224:227], v2, s[20:23], s34 offen
  s_waitcnt vmcnt(46)
  ds_write_b128 v13, v[32:35] offset:0
  ds_write_b128 v13, v[36:39] offset:8192
  ds_write_b128 v13, v[40:43] offset:16384
  ds_write_b128 v13, v[44:47] offset:24576
  s_waitcnt lgkmcnt(0)
  s_barrier
  s_waitcnt vmcnt(42)
  ds_write_b128 v13, v[48:51] offset:32768
  ds_write_b128 v13, v[52:55] offset:40960
  ds_write_b128 v13, v[56:59] offset:49152
  ds_write_b128 v13, v[60:63] offset:57344
  ds_read_b64_tr_b16 v[16:17], v14 offset:0
  ds_read_b64_tr_b16 v[18:19], v14 offset:2048
  ds_read_b64_tr_b16 v[20:21], v14 offset:8192
  ds_read_b64_tr_b16 v[22:23], v14 offset:10240
  ds_read_b64_tr_b16 v[24:25], v14 offset:16384
  ds_read_b64_tr_b16 v[26:27], v14 offset:18432
  ds_read_b64_tr_b16 v[28:29], v14 offset:24576
  ds_read_b64_tr_b16 v[30:31], v14 offset:26624
  ds_read_b128 v[248:251], v9 offset:0
  ds_read_b128 v[252:255], v9 offset:32
  s_waitcnt lgkmcnt(0)
  s_cmp_eq_u32 s42, 2
  s_cbranch_scc1 p0v_1
  v_mfma_f32_32x32x16_bf16 v[192:207], v[16:19], v[248:251], 0
  v_mfma_f32_32x32x16_bf16 v[192:207], v[20:23], v[252:255], v[192:207]
  s_branch p0d_2
p0v_1:
  v_mfma_f32_32x32x16_bf16 v[192:207], v[248:251], v[16:19], 0
  v_mfma_f32_32x32x16_bf16 v[192:207], v[252:255], v[20:23], v[192:207]
p0d_2:
  ds_read_b128 v[248:251], v9 offset:64
  ds_read_b128 v[252:255], v9 offset:96
  s_waitcnt lgkmcnt(0)
  s_cmp_eq_u32 s42, 2
  s_cbranch_scc1 p0v_3
  v_mfma_f32_32x32x16_bf16 v[192:207], v[24:27], v[248:251], v[192:207]
  v_mfma_f32_32x32x16_bf16 v[192:207], v[28:31], v[252:255], v[192:207]
  s_branch p0d_4
p0v_3:
  v_mfma_f32_32x32x16_bf16 v[192:207], v[248:251], v[24:27], v[192:207]
  v_mfma_f32_32x32x16_bf16 v[192:207], v[252:255], v[28:31], v[192:207]
p0d_4:
  s_barrier
  s_waitcnt vmcnt(38)
  ds_write_b128 v13, v[64:67] offset:0
  ds_write_b128 v13, v[68:71] offset:8192
  ds_write_b128 v13, v[72:75] offset:16384
  ds_write_b128 v13, v[76:79] offset:24576
  ds_read_b64_tr_b16 v[32:33], v14 offset:32768
  ds_read_b64_tr_b16 v[34:35], v14 offset:34816
  ds_read_b64_tr_b16 v[36:37], v14 offset:40960
  ds_read_b64_tr_b16 v[38:39], v14 offset:43008
  ds_read_b64_tr_b16 v[40:41], v14 offset:49152
  ds_read_b64_tr_b16 v[42:43], v14 offset:51200
  ds_read_b64_tr_b16 v[44:45], v14 offset:57344
  ds_read_b64_tr_b16 v[46:47], v14 offset:59392
  ds_read_b128 v[248:251], v9 offset:128
  ds_read_b128 v[252:255], v9 offset:160
  s_waitcnt lgkmcnt(0)
  s_cmp_eq_u32 s42, 2
  s_cbranch_scc1 p0v_5
  v_mfma_f32_32x32x16_bf16 v[192:207], v[32:35], v[248:251], v[192:207]
  v_mfma_f32_32x32x16_bf16 v[192:207], v[36:39], v[252:255], v[192:207]
  s_branch p0d_6
p0v_5:
  v_mfma_f32_32x32x16_bf16 v[192:207], v[248:251], v[32:35], v[192:207]
  v_mfma_f32_32x32x16_bf16 v[192:207], v[252:255], v[36:39], v[192:207]
p0d_6:
  ds_read_b128 v[248:251], v9 offset:192
  ds_read_b128 v[252:255], v9 offset:224
  s_waitcnt lgkmcnt(0)
  s_cmp_eq_u32 s42, 2
  s_cbranch_scc1 p0v_7
  v_mfma_f32_32x32x16_bf16 v[192:207], v[40:43], v[248:251], v[192:207]
  v_mfma_f32_32x32x16_bf16 v[192:207], v[44:47], v[252:255], v[192:207]
  s_branch p0d_8
p0v_7:
  v_mfma_f32_32x32x16_bf16 v[192:207], v[248:251], v[40:43], v[192:207]
  v_mfma_f32_32x32x16_bf16 v[192:207], v[252:255], v[44:47], v[192:207]
p0d_8:
  s_barrier
  s_waitcnt vmcnt(34)
  ds_write_b128 v13, v[80:83] offset:32768
  ds_write_b128 v13, v[84:87] offset:40960
  ds_write_b128 v13, v[88:91] offset:49152
  ds_write_b128 v13, v[92:95] offset:57344
  ds_read_b64_tr_b16 v[48:49], v14 offset:0
  ds_read_b64_tr_b16 v[50:51], v14 offset:2048
  ds_read_b64_tr_b16 v[52:53], v14 offset:8192
  ds_read_b64_tr_b16 v[54:55], v14 offset:10240
  ds_read_b64_tr_b16 v[56:57], v14 offset:16384
  ds_read_b64_tr_b16 v[58:59], v14 offset:18432
  ds_read_b64_tr_b16 v[60:61], v14 offset:24576
  ds_read_b64_tr_b16 v[62:63], v14 offset:26624
  ds_read_b128 v[248:251], v9 offset:256
  ds_read_b128 v[252:255], v9 offset:288
  s_waitcnt lgkmcnt(0)
  s_cmp_eq_u32 s42, 2
  s_cbranch_scc1 p0v_9
  v_mfma_f32_32x32x16_bf16 v[192:207], v[48:51], v[248:251], v[192:207]
  v_mfma_f32_32x32x16_bf16 v[192:207], v[52:55], v[252:255], v[192:207]
  s_branch p0d_10
p0v_9:
  v_mfma_f32_32x32x16_bf16 v[192:207], v[248:251], v[48:51], v[192:207]
  v_mfma_f32_32x32x16_bf16 v[192:207], v[252:255], v[52:55], v[192:207]
p0d_10:
  ds_read_b128 v[248:251], v9 offset:320
  ds_read_b128 v[252:255], v9 offset:352
  s_waitcnt lgkmcnt(0)
  s_cmp_eq_u32 s42, 2
  s_cbranch_scc1 p0v_11
  v_mfma_f32_32x32x16_bf16 v[192:207], v[56:59], v[248:251], v[192:207]
  v_mfma_f32_32x32x16_bf16 v[192:207], v[60:63], v[252:255], v[192:207]
  s_branch p0d_12
p0v_11:
  v_mfma_f32_32x32x16_bf16 v[192:207], v[248:251], v[56:59], v[192:207]
  v_mfma_f32_32x32x16_bf16 v[192:207], v[252:255], v[60:63], v[192:207]
p0d_12:
  s_barrier
  s_waitcnt vmcnt(30)
  ds_write_b128 v13, v[96:99] offset:0
  ds_write_b128 v13, v[100:103] offset:8192
  ds_write_b128 v13, v[104:107] offset:16384
  ds_write_b128 v13, v[108:111] offset:24576
  ds_read_b64_tr_b16 v[64:65], v14 offset:32768
  ds_read_b64_tr_b16 v[66:67], v14 offset:34816
  ds_read_b64_tr_b16 v[68:69], v14 offset:40960
  ds_read_b64_tr_b16 v[70:71], v14 offset:43008
  ds_read_b64_tr_b16 v[72:73], v14 offset:49152
  ds_read_b64_tr_b16 v[74:75], v14 offset:51200
  ds_read_b64_tr_b16 v[76:77], v14 offset:57344
  ds_read_b64_tr_b16 v[78:79], v14 offset:59392
  ds_read_b128 v[248:251], v9 offset:384
  ds_read_b128 v[252:255], v9 offset:416
  s_waitcnt lgkmcnt(0)
  s_cmp_eq_u32 s42, 2
  s_cbranch_scc1 p0v_13
  v_mfma_f32_32x32x16_bf16 v[192:207], v[64:67], v[248:251], v[192:207]
  v_mfma_f32_32x32x16_bf16 v[192:207], v[68:71], v[252:255], v[192:207]
  s_branch p0d_14
p0v_13:
  v_mfma_f32_32x32x16_bf16 v[192:207], v[248:251], v[64:67], v[192:207]
  v_mfma_f32_32x32x16_bf16 v[192:207], v[252:255], v[68:71], v[192:207]
p0d_14:
  ds_read_b128 v[248:251], v9 offset:448
  ds_read_b128 v[252:255], v9 offset:480
  s_waitcnt lgkmcnt(0)
  s_cmp_eq_u32 s42, 2
  s_cbranch_scc1 p0v_15
  v_mfma_f32_32x32x16_bf16 v[192:207], v[72:75], v[248:251], v[192:207]
  v_mfma_f32_32x32x16_bf16 v[192:207], v[76:79], v[252:255], v[192:207]
  s_branch p0d_16
p0v_15:
  v_mfma_f32_32x32x16_bf16 v[192:207], v[248:251], v[72:75], v[192:207]
  v_mfma_f32_32x32x16_bf16 v[192:207], v[252:255], v[76:79], v[192:207]
p0d_16:
  s_barrier
  s_waitcnt vmcnt(26)
  ds_write_b128 v13, v[112:115] offset:32768
  ds_write_b128 v13, v[116:119] offset:40960
  ds_write_b128 v13, v[120:123] offset:49152
  ds_write_b128 v13, v[124:127] offset:57344
  ds_read_b64_tr_b16 v[80:81], v14 offset:0
  ds_read_b64_tr_b16 v[82:83], v14 offset:2048
  ds_read_b64_tr_b16 v[84:85], v14 offset:8192
  ds_read_b64_tr_b16 v[86:87], v14 offset:10240
  ds_read_b64_tr_b16 v[88:89], v14 offset:16384
  ds_read_b64_tr_b16 v[90:91], v14 offset:18432
  ds_read_b64_tr_b16 v[92:93], v14 offset:24576
  ds_read_b64_tr_b16 v[94:95], v14 offset:26624
  ds_read_b128 v[248:251], v9 offset:512
  ds_read_b128 v[252:255], v9 offset:544
  s_waitcnt lgkmcnt(0)
  s_cmp_eq_u32 s42, 2
  s_cbranch_scc1 p0v_17
  v_mfma_f32_32x32x16_bf16 v[192:207], v[80:83], v[248:251], v[192:207]
  v_mfma_f32_32x32x16_bf16 v[192:207], v[84:87], v[252:255], v[192:207]
  s_branch p0d_18
p0v_17:
  v_mfma_f32_32x32x16_bf16 v[192:207], v[248:251], v[80:83], v[192:207]
  v_mfma_f32_32x32x16_bf16 v[192:207], v[252:255], v[84:87], v[192:207]
p0d_18:
  ds_read_b128 v[248:251], v9 offset:576
  ds_read_b128 v[252:255], v9 offset:608
  s_waitcnt lgkmcnt(0)
  s_cmp_eq_u32 s42, 2
  s_cbranch_scc1 p0v_19
  v_mfma_f32_32x32x16_bf16 v[192:207], v[88:91], v[248:251], v[192:207]
  v_mfma_f32_32x32x16_bf16 v[192:207], v[92:95], v[252:255], v[192:207]
  s_branch p0d_20
p0v_19:
  v_mfma_f32_32x32x16_bf16 v[192:207], v[248:251], v[88:91], v[192:207]
  v_mfma_f32_32x32x16_bf16 v[192:207], v[252:255], v[92:95], v[192:207]
p0d_20:
  s_barrier
  s_waitcnt vmcnt(22)
  ds_write_b128 v13, v[128:131] offset:0
  ds_write_b128 v13, v[132:135] offset:8192
  ds_write_b128 v13, v[136:139] offset:16384
  ds_write_b128 v13, v[140:143] offset:24576
  ds_read_b64_tr_b16 v[96:97], v14 offset:32768
  ds_read_b64_tr_b16 v[98:99], v14 offset:34816
  ds_read_b64_tr_b16 v[100:101], v14 offset:40960
  ds_read_b64_tr_b16 v[102:103], v14 offset:43008
  ds_read_b64_tr_b16 v[104:105], v14 offset:49152
  ds_read_b64_tr_b16 v[106:107], v14 offset:51200
  ds_read_b64_tr_b16 v[108:109], v14 offset:57344
  ds_read_b64_tr_b16 v[110:111], v14 offset:59392
  ds_read_b128 v[248:251], v9 offset:640
  ds_read_b128 v[252:255], v9 offset:672
  s_waitcnt lgkmcnt(0)
  s_cmp_eq_u32 s42, 2
  s_cbranch_scc1 p0v_21
  v_mfma_f32_32x32x16_bf16 v[192:207], v[96:99], v[248:251], v[192:207]
  v_mfma_f32_32x32x16_bf16 v[192:207], v[100:103], v[252:255], v[192:207]
  s_branch p0d_22
p0v_21:
  v_mfma_f32_32x32x16_bf16 v[192:207], v[248:251], v[96:99], v[192:207]
  v_mfma_f32_32x32x16_bf16 v[192:207], v[252:255], v[100:103], v[192:207]
p0d_22:
  ds_read_b128 v[248:251], v9 offset:704
  ds_read_b128 v[252:255], v9 offset:736
  s_waitcnt lgkmcnt(0)
  s_cmp_eq_u32 s42, 2
  s_cbranch_scc1 p0v_23
  v_mfma_f32_32x32x16_bf16 v[192:207], v[104:107], v[248:251], v[192:207]
  v_mfma_f32_32x32x16_bf16 v[192:207], v[108:111], v[252:255], v[192:207]
  s_branch p0d_24
p0v_23:
  v_mfma_f32_32x32x16_bf16 v[192:207], v[248:251], v[104:107], v[192:207]
  v_mfma_f32_32x32x16_bf16 v[192:207], v[252:255], v[108:111], v[192:207]
p0d_24:
  s_barrier
  s_waitcnt vmcnt(18)
  ds_write_b128 v13, v[144:147] offset:32768
  ds_write_b128 v13, v[148:151] offset:40960
  ds_write_b128 v13, v[152:155] offset:49152
  ds_write_b128 v13, v[156:159] offset:57344
  ds_read_b64_tr_b16 v[112:113], v14 offset:0
  ds_read_b64_tr_b16 v[114:115], v14 offset:2048
  ds_read_b64_tr_b16 v[116:117], v14 offset:8192
  ds_read_b64_tr_b16 v[118:119], v14 offset:10240
  ds_read_b64_tr_b16 v[120:121], v14 offset:16384
  ds_read_b64_tr_b16 v[122:123], v14 offset:18432
  ds_read_b64_tr_b16 v[124:125], v14 offset:24576
  ds_read_b64_tr_b16 v[126:127], v14 offset:26624
  ds_read_b128 v[248:251], v9 offset:768
  ds_read_b128 v[252:255], v9 offset:800
  s_waitcnt lgkmcnt(0)
  s_cmp_eq_u32 s42, 2
  s_cbranch_scc1 p0v_25
  v_mfma_f32_32x32x16_bf16 v[192:207], v[112:115], v[248:251], v[192:207]
  v_mfma_f32_32x32x16_bf16 v[192:207], v[116:119], v[252:255], v[192:207]
  s_branch p0d_26
p0v_25:
  v_mfma_f32_32x32x16_bf16 v[192:207], v[248:251], v[112:115], v[192:207]
  v_mfma_f32_32x32x16_bf16 v[192:207], v[252:255], v[116:119], v[192:207]
p0d_26:
  ds_read_b128 v[248:251], v9 offset:832
  ds_read_b128 v[252:255], v9 offset:864
  s_waitcnt lgkmcnt(0)
  s_cmp_eq_u32 s42, 2
  s_cbranch_scc1 p0v_27
  v_mfma_f32_32x32x16_bf16 v[192:207], v[120:123], v[248:251], v[192:207]
  v_mfma_f32_32x32x16_bf16 v[192:207], v[124:127], v[252:255], v[192:207]
  s_branch p0d_28
p0v_27:
  v_mfma_f32_32x32x16_bf16 v[192:207], v[248:251], v[120:123], v[192:207]
  v_mfma_f32_32x32x16_bf16 v[192:207], v[252:255], v[124:127], v[192:207]
p0d_28:
  s_barrier
  s_waitcnt vmcnt(14)
  ds_write_b128 v13, v[160:163] offset:0
  ds_write_b128 v13, v[164:167] offset:8192
  ds_write_b128 v13, v[168:171] offset:16384
  ds_write_b128 v13, v[172:175] offset:24576
  ds_read_b64_tr_b16 v[128:129], v14 offset:32768
  ds_read_b64_tr_b16 v[130:131], v14 offset:34816
  ds_read_b64_tr_b16 v[132:133], v14 offset:40960
  ds_read_b64_tr_b16 v[134:135], v14 offset:43008
  ds_read_b64_tr_b16 v[136:137], v14 offset:49152
  ds_read_b64_tr_b16 v[138:139], v14 offset:51200
  ds_read_b64_tr_b16 v[140:141], v14 offset:57344
  ds_read_b64_tr_b16 v[142:143], v14 offset:59392
  ds_read_b128 v[248:251], v9 offset:896
  ds_read_b128 v[252:255], v9 offset:928
  s_waitcnt lgkmcnt(0)
  s_cmp_eq_u32 s42, 2
  s_cbranch_scc1 p0v_29
  v_mfma_f32_32x32x16_bf16 v[192:207], v[128:131], v[248:251], v[192:207]
  v_mfma_f32_32x32x16_bf16 v[192:207], v[132:135], v[252:255], v[192:207]
  s_branch p0d_30
p0v_29:
  v_mfma_f32_32x32x16_bf16 v[192:207], v[248:251], v[128:131], v[192:207]
  v_mfma_f32_32x32x16_bf16 v[192:207], v[252:255], v[132:135], v[192:207]
p0d_30:
  ds_read_b128 v[248:251], v9 offset:960
  ds_read_b128 v[252:255], v9 offset:992
  s_waitcnt lgkmcnt(0)
  s_cmp_eq_u32 s42, 2
  s_cbranch_scc1 p0v_31
  v_mfma_f32_32x32x16_bf16 v[192:207], v[136:139], v[248:251], v[192:207]
  v_mfma_f32_32x32x16_bf16 v[192:207], v[140:143], v[252:255], v[192:207]
  s_branch p0d_32
p0v_31:
  v_mfma_f32_32x32x16_bf16 v[192:207], v[248:251], v[136:139], v[192:207]
  v_mfma_f32_32x32x16_bf16 v[192:207], v[252:255], v[140:143], v[192:207]
p0d_32:
  s_barrier
  s_waitcnt vmcnt(10)
  ds_write_b128 v13, v[176:179] offset:32768
  ds_write_b128 v13, v[180:183] offset:40960
  ds_write_b128 v13, v[184:187] offset:49152
  ds_write_b128 v13, v[188:191] offset:57344
  ds_read_b64_tr_b16 v[144:145], v14 offset:0
  ds_read_b64_tr_b16 v[146:147], v14 offset:2048
  ds_read_b64_tr_b16 v[148:149], v14 offset:8192
  ds_read_b64_tr_b16 v[150:151], v14 offset:10240
  ds_read_b64_tr_b16 v[152:153], v14 offset:16384
  ds_read_b64_tr_b16 v[154:155], v14 offset:18432
  ds_read_b64_tr_b16 v[156:157], v14 offset:24576
  ds_read_b64_tr_b16 v[158:159], v14 offset:26624
  ds_read_b128 v[248:251], v9 offset:1024
  ds_read_b128 v[252:255], v9 offset:1056
  s_waitcnt lgkmcnt(0)
  s_cmp_eq_u32 s42, 2
  s_cbranch_scc1 p0v_33
  v_mfma_f32_32x32x16_bf16 v[192:207], v[144:147], v[248:251], v[192:207]
  v_mfma_f32_32x32x16_bf16 v[192:207], v[148:151], v[252:255], v[192:207]
  s_branch p0d_34
p0v_33:
  v_mfma_f32_32x32x16_bf16 v[192:207], v[248:251], v[144:147], v[192:207]
  v_mfma_f32_32x32x16_bf16 v[192:207], v[252:255], v[148:151], v[192:207]
p0d_34:
  ds_read_b128 v[248:251], v9 offset:1088
  ds_read_b128 v[252:255], v9 offset:1120
  s_waitcnt lgkmcnt(0)
  s_cmp_eq_u32 s42, 2
  s_cbranch_scc1 p0v_35
  v_mfma_f32_32x32x16_bf16 v[192:207], v[152:155], v[248:251], v[192:207]
  v_mfma_f32_32x32x16_bf16 v[192:207], v[156:159], v[252:255], v[192:207]
  s_branch p0d_36
p0v_35:
  v_mfma_f32_32x32x16_bf16 v[192:207], v[248:251], v[152:155], v[192:207]
  v_mfma_f32_32x32x16_bf16 v[192:207], v[252:255], v[156:159], v[192:207]
p0d_36:
  s_barrier
  ds_read_b64_tr_b16 v[160:161], v14 offset:32768
  ds_read_b64_tr_b16 v[162:163], v14 offset:34816
  ds_read_b64_tr_b16 v[164:165], v14 offset:40960
  ds_read_b64_tr_b16 v[166:167], v14 offset:43008
  ds_read_b64_tr_b16 v[168:169], v14 offset:49152
  ds_read_b64_tr_b16 v[170:171], v14 offset:51200
  ds_read_b64_tr_b16 v[172:173], v14 offset:57344
  ds_read_b64_tr_b16 v[174:175], v14 offset:59392
  ds_read_b128 v[248:251], v9 offset:1152
  ds_read_b128 v[252:255], v9 offset:1184
  s_waitcnt lgkmcnt(0)
  s_cmp_eq_u32 s42, 2
  s_cbranch_scc1 p0v_37
  v_mfma_f32_32x32x16_bf16 v[192:207], v[160:163], v[248:251], v[192:207]
  v_mfma_f32_32x32x16_bf16 v[192:207], v[164:167], v[252:255], v[192:207]
  s_branch p0d_38
p0v_37:
  v_mfma_f32_32x32x16_bf16 v[192:207], v[248:251], v[160:163], v[192:207]
  v_mfma_f32_32x32x16_bf16 v[192:207], v[252:255], v[164:167], v[192:207]
p0d_38:
  ds_read_b128 v[248:251], v9 offset:1216
  ds_read_b128 v[252:255], v9 offset:1248
  s_waitcnt lgkmcnt(0)
  s_cmp_eq_u32 s42, 2
  s_cbranch_scc1 p0v_39
  v_mfma_f32_32x32x16_bf16 v[192:207], v[168:171], v[248:251], v[192:207]
  v_mfma_f32_32x32x16_bf16 v[192:207], v[172:175], v[252:255], v[192:207]
  s_branch p0d_40
p0v_39:
  v_mfma_f32_32x32x16_bf16 v[192:207], v[248:251], v[168:171], v[192:207]
  v_mfma_f32_32x32x16_bf16 v[192:207], v[252:255], v[172:175], v[192:207]
p0d_40:
  s_barrier
  s_cmp_lg_u32 s31, 0
  s_cbranch_scc1 valok_43
  v_lshlrev_b32 v10, 2, v1
  s_mov_b32 s39, 0
val_41:
  buffer_load_dword v11, v10, s[12:15], 0 offen sc1
  s_waitcnt vmcnt(0)
  v_cmp_eq_u32 vcc, 32, v11
s_nop 3
  s_and_b32 s34, vcc_lo, vcc_hi
  s_and_b32 s34, s34, 0x5555
  s_cmp_eq_u32 s34, 0x5555
  s_cbranch_scc0 valg_42_s
  v_readlane_b32 s32, v11, 1
  s_mov_b32 s34, 0
  s_cmp_eq_u32 s34, 0
  s_cbranch_scc1 valg_42
valg_42_s:
  s_mov_b32 s36, 0
  s_mov_b32 s37, 0
  s_mov_b32 s38, 0
  s_mov_b32 s34, 0
  v_readlane_b32 s35, v11, 2
s_nop 3
  s_add_u32 s38, s38, s35
  v_readlane_b32 s35, v11, 0
s_nop 3
  s_add_u32 s36, s36, s35
  s_cmp_eq_u32 s35, 32
  s_cselect_b32 s97, 0, 1
  s_or_b32 s34, s34, s97
  s_cmp_gt_u32 s98, 0
  s_cselect_b32 s35, s35, 0
  s_add_u32 s37, s37, s35
  v_readlane_b32 s35, v11, 6
s_nop 3
  s_add_u32 s38, s38, s35
  v_readlane_b32 s35, v11, 4
s_nop 3
  s_add_u32 s36, s36, s35
  s_cmp_eq_u32 s35, 32
  s_cselect_b32 s97, 0, 1
  s_or_b32 s34, s34, s97
  s_cmp_gt_u32 s98, 1
  s_cselect_b32 s35, s35, 0
  s_add_u32 s37, s37, s35
  v_readlane_b32 s35, v11, 10
s_nop 3
  s_add_u32 s38, s38, s35
  v_readlane_b32 s35, v11, 8
s_nop 3
  s_add_u32 s36, s36, s35
  s_cmp_eq_u32 s35, 32
  s_cselect_b32 s97, 0, 1
  s_or_b32 s34, s34, s97
  s_cmp_gt_u32 s98, 2
  s_cselect_b32 s35, s35, 0
  s_add_u32 s37, s37, s35
  v_readlane_b32 s35, v11, 14
s_nop 3
  s_add_u32 s38, s38, s35
  v_readlane_b32 s35, v11, 12
s_nop 3
  s_add_u32 s36, s36, s35
  s_cmp_eq_u32 s35, 32
  s_cselect_b32 s97, 0, 1
  s_or_b32 s34, s34, s97
  s_cmp_gt_u32 s98, 3
  s_cselect_b32 s35, s35, 0
  s_add_u32 s37, s37, s35
  v_readlane_b32 s35, v11, 34
s_nop 3
  s_add_u32 s38, s38, s35
  v_readlane_b32 s35, v11, 32
s_nop 3
  s_add_u32 s36, s36, s35
  s_cmp_eq_u32 s35, 32
  s_cselect_b32 s97, 0, 1
  s_or_b32 s34, s34, s97
  s_cmp_gt_u32 s98, 4
  s_cselect_b32 s35, s35, 0
  s_add_u32 s37, s37, s35
  v_readlane_b32 s35, v11, 38
s_nop 3
  s_add_u32 s38, s38, s35
  v_readlane_b32 s35, v11, 36
s_nop 3
  s_add_u32 s36, s36, s35
  s_cmp_eq_u32 s35, 32
  s_cselect_b32 s97, 0, 1
  s_or_b32 s34, s34, s97
  s_cmp_gt_u32 s98, 5
  s_cselect_b32 s35, s35, 0
  s_add_u32 s37, s37, s35
  v_readlane_b32 s35, v11, 42
s_nop 3
  s_add_u32 s38, s38, s35
  v_readlane_b32 s35, v11, 40
s_nop 3
  s_add_u32 s36, s36, s35
  s_cmp_eq_u32 s35, 32
  s_cselect_b32 s97, 0, 1
  s_or_b32 s34, s34, s97
  s_cmp_gt_u32 s98, 6
  s_cselect_b32 s35, s35, 0
  s_add_u32 s37, s37, s35
  v_readlane_b32 s35, v11, 46
s_nop 3
  s_add_u32 s38, s38, s35
  v_readlane_b32 s35, v11, 44
s_nop 3
  s_add_u32 s36, s36, s35
  s_cmp_eq_u32 s35, 32
  s_cselect_b32 s97, 0, 1
  s_or_b32 s34, s34, s97
  s_cmp_gt_u32 s98, 7
  s_cselect_b32 s35, s35, 0
  s_add_u32 s37, s37, s35
  v_readlane_b32 s35, v11, 18
s_nop 3
  s_add_u32 s38, s38, s35
  v_readlane_b32 s35, v11, 16
s_nop 3
  s_add_u32 s36, s36, s35
  s_cmp_eq_u32 s35, 0
  s_cselect_b32 s97, 0, 1
  s_or_b32 s34, s34, s97
  s_cmp_gt_u32 s98, 8
  s_cselect_b32 s35, s35, 0
  s_add_u32 s37, s37, s35
  v_readlane_b32 s35, v11, 22
s_nop 3
  s_add_u32 s38, s38, s35
  v_readlane_b32 s35, v11, 20
s_nop 3
  s_add_u32 s36, s36, s35
  s_cmp_eq_u32 s35, 0
  s_cselect_b32 s97, 0, 1
  s_or_b32 s34, s34, s97
  s_cmp_gt_u32 s98, 9
  s_cselect_b32 s35, s35, 0
  s_add_u32 s37, s37, s35
  v_readlane_b32 s35, v11, 26
s_nop 3
  s_add_u32 s38, s38, s35
  v_readlane_b32 s35, v11, 24
s_nop 3
  s_add_u32 s36, s36, s35
  s_cmp_eq_u32 s35, 0
  s_cselect_b32 s97, 0, 1
  s_or_b32 s34, s34, s97
  s_cmp_gt_u32 s98, 10
  s_cselect_b32 s35, s35, 0
  s_add_u32 s37, s37, s35
  v_readlane_b32 s35, v11, 30
s_nop 3
  s_add_u32 s38, s38, s35
  v_readlane_b32 s35, v11, 28
s_nop 3
  s_add_u32 s36, s36, s35
  s_cmp_eq_u32 s35, 0
  s_cselect_b32 s97, 0, 1
  s_or_b32 s34, s34, s97
  s_cmp_gt_u32 s98, 11
  s_cselect_b32 s35, s35, 0
  s_add_u32 s37, s37, s35
  v_readlane_b32 s35, v11, 50
s_nop 3
  s_add_u32 s38, s38, s35
  v_readlane_b32 s35, v11, 48
s_nop 3
  s_add_u32 s36, s36, s35
  s_cmp_eq_u32 s35, 0
  s_cselect_b32 s97, 0, 1
  s_or_b32 s34, s34, s97
  s_cmp_gt_u32 s98, 12
  s_cselect_b32 s35, s35, 0
  s_add_u32 s37, s37, s35
  v_readlane_b32 s35, v11, 54
s_nop 3
  s_add_u32 s38, s38, s35
  v_readlane_b32 s35, v11, 52
s_nop 3
  s_add_u32 s36, s36, s35
  s_cmp_eq_u32 s35, 0
  s_cselect_b32 s97, 0, 1
  s_or_b32 s34, s34, s97
  s_cmp_gt_u32 s98, 13
  s_cselect_b32 s35, s35, 0
  s_add_u32 s37, s37, s35
  v_readlane_b32 s35, v11, 58
s_nop 3
  s_add_u32 s38, s38, s35
  v_readlane_b32 s35, v11, 56
s_nop 3
  s_add_u32 s36, s36, s35
  s_cmp_eq_u32 s35, 0
  s_cselect_b32 s97, 0, 1
  s_or_b32 s34, s34, s97
  s_cmp_gt_u32 s98, 14
  s_cselect_b32 s35, s35, 0
  s_add_u32 s37, s37, s35
  v_readlane_b32 s35, v11, 62
s_nop 3
  s_add_u32 s38, s38, s35
  v_readlane_b32 s35, v11, 60
s_nop 3
  s_add_u32 s36, s36, s35
  s_cmp_eq_u32 s35, 0
  s_cselect_b32 s97, 0, 1
  s_or_b32 s34, s34, s97
  s_cmp_gt_u32 s98, 15
  s_cselect_b32 s35, s35, 0
  s_add_u32 s37, s37, s35
  v_readlane_b32 s32, v11, 1
  s_cmp_eq_u32 s36, 256
  s_cselect_b32 s35, s38, 0
  s_cmp_eq_u32 s35, 256
  s_cbranch_scc1 valg_42
  s_sleep 2
  s_add_u32 s39, s39, 1
  s_cmp_lt_u32 s39, s33
  s_cbranch_scc1 val_41
  s_mov_b32 s33, 0
valg_42:
s_nop 0
  s_and_b32 s32, s32, 2
  s_lshl_b32 s32, s32, 12
  s_cmp_eq_u32 s34, 0
  s_cbranch_scc1 valok_43
  s_mov_b32 s31, 1
  s_mov_b32 s32, 0
  s_add_u32 s37, s37, s99
  s_and_b32 s37, s37, 255
  s_lshr_b32 s28, s37, 5
  s_and_b32 s29, s37, 31
  s_barrier
  s_branch L_dispatch
valok_43:
  s_cmp_lg_u32 s31, 0
  s_cbranch_scc1 pwd_45
  s_mov_b32 s39, 0
  v_mov_b32 v13, 4
pw_44:
  buffer_load_dword v12, v13, s[12:15], 0 offen sc1
  s_waitcnt vmcnt(0)
  v_readfirstlane_b32 s32, v12
s_nop 3
  s_cmp_lg_u32 s32, 0
  s_cbranch_scc1 pw_44_g
  s_sleep 2
  s_add_u32 s39, s39, 1
  s_cmp_lt_u32 s39, s33
  s_cbranch_scc1 pw_44
  s_mov_b32 s33, 0
pw_44_g:
  s_and_b32 s32, s32, 2
  s_lshl_b32 s32, s32, 12
pwd_45:
  s_xor_b32 s100, s32, 8192
  s_add_u32 s101, s100, 3817472
  s_add_u32 s100, s100, 3801088
  s_lshl_b32 s45, s41, 7
  s_add_u32 s45, s45, 32768
  s_add_u32 s45, s45, s100
  s_cmp_eq_u32 s42, 2
  s_cbranch_scc1 L_pj_s0V
L_pj_s0K:
  v_cvt_pk_bf16_f32 v192, v192, v193
  v_cvt_pk_bf16_f32 v193, v194, v195
  v_cvt_pk_bf16_f32 v194, v196, v197
  v_cvt_pk_bf16_f32 v195, v198, v199
  v_cvt_pk_bf16_f32 v196, v200, v201
  v_cvt_pk_bf16_f32 v197, v202, v203
  v_cvt_pk_bf16_f32 v198, v204, v205
  v_cvt_pk_bf16_f32 v199, v206, v207
  s_lshl_b32 s47, s49, 18
  s_add_u32 s47, s47, s44
  buffer_store_dwordx4 v[192:195], v8, s[8:11], s47 offen sc1
  buffer_store_dwordx4 v[196:199], v8, s[8:11], s47 offen offset:512 sc1
  s_waitcnt vmcnt(2)
  ds_write_b128 v3, v[228:231] offset:41472
  ds_write_b128 v4, v[232:235] offset:41472
  ds_write_b128 v5, v[236:239] offset:41472
  ds_write_b128 v6, v[240:243] offset:41472
  ds_write_b128 v7, v[244:247] offset:41472
  s_waitcnt lgkmcnt(0)
  s_add_u32 s34, s50, 122880
  buffer_load_dwordx4 v[228:231], v2, s[20:23], s34 offen
  s_add_u32 s34, s50, 131072
  buffer_load_dwordx4 v[232:235], v2, s[20:23], s34 offen
  s_add_u32 s34, s50, 139264
  buffer_load_dwordx4 v[236:239], v2, s[20:23], s34 offen
  s_add_u32 s34, s50, 147456
  buffer_load_dwordx4 v[240:243], v2, s[20:23], s34 offen
  s_add_u32 s34, s50, 155648
  buffer_load_dwordx4 v[244:247], v2, s[20:23], s34 offen
  s_cmp_eq_u32 s49, 0
  s_cbranch_scc1 pjw_46
  s_lshl_b32 s34, s43, 2
  s_add_u32 s34, s34, s42
  s_sub_u32 s34, s34, 1
  s_lshl_b32 s34, s34, 2
  s_add_u32 s34, s34, 1024
  s_add_u32 s34, s34, s100
  v_lshlrev_b32 v10, 3, v1
  v_add_u32 v10, s34, v10
  s_mov_b32 s36, 3
  s_mov_b32 s39, 0
  s_mov_b64 s[70:71], exec
  s_mov_b32 exec_lo, 0x3
  s_mov_b32 exec_hi, 0x0
pjw_47:
  buffer_load_dword v11, v10, s[8:11], 0 offen sc1
  s_waitcnt vmcnt(0)
  v_cmp_gt_u32 vcc, s36, v11
  s_cbranch_vccz pjwd_48
  s_sleep 2
  s_add_u32 s39, s39, 1
  s_cmp_lt_u32 s39, s33
  s_cbranch_scc1 pjw_47
  s_mov_b32 s33, 0
pjwd_48:
  s_mov_b64 exec, s[70:71]
pjw_46:
  s_waitcnt vmcnt(0)
  s_barrier
  s_add_u32 s40, s49, 1
  s_cmp_lg_u32 s30, 0
  s_cbranch_scc1 pjf_49
  v_mov_b32 v10, s45
  v_mov_b32 v11, s40
  s_mov_b64 exec, 1
  buffer_store_dword v11, v10, s[8:11], 0 offen sc1
  s_mov_b64 exec, -1
pjf_49:
  s_branch L_pj_par1K
L_pj_s0V:
  v_cvt_pk_bf16_f32 v192, v192, v193
  v_cvt_pk_bf16_f32 v193, v194, v195
  v_cvt_pk_bf16_f32 v194, v200, v201
  v_cvt_pk_bf16_f32 v195, v202, v203
  v_cvt_pk_bf16_f32 v196, v196, v197
  v_cvt_pk_bf16_f32 v197, v198, v199
  v_cvt_pk_bf16_f32 v198, v204, v205
  v_cvt_pk_bf16_f32 v199, v206, v207
  s_lshl_b32 s47, s49, 18
  s_add_u32 s47, s47, s44
  buffer_store_dwordx4 v[192:195], v8, s[8:11], s47 offen sc1
  buffer_store_dwordx4 v[196:199], v8, s[8:11], s47 offen offset:512 sc1
  s_waitcnt vmcnt(2)
  ds_write_b128 v3, v[228:231] offset:41472
  ds_write_b128 v4, v[232:235] offset:41472
  ds_write_b128 v5, v[236:239] offset:41472
  ds_write_b128 v6, v[240:243] offset:41472
  ds_write_b128 v7, v[244:247] offset:41472
  s_waitcnt lgkmcnt(0)
  s_add_u32 s34, s50, 122880
  buffer_load_dwordx4 v[228:231], v2, s[20:23], s34 offen
  s_add_u32 s34, s50, 131072
  buffer_load_dwordx4 v[232:235], v2, s[20:23], s34 offen
  s_add_u32 s34, s50, 139264
  buffer_load_dwordx4 v[236:239], v2, s[20:23], s34 offen
  s_add_u32 s34, s50, 147456
  buffer_load_dwordx4 v[240:243], v2, s[20:23], s34 offen
  s_add_u32 s34, s50, 155648
  buffer_load_dwordx4 v[244:247], v2, s[20:23], s34 offen
  s_cmp_eq_u32 s49, 0
  s_cbranch_scc1 pjw_50
  s_lshl_b32 s34, s43, 2
  s_add_u32 s34, s34, s42
  s_sub_u32 s34, s34, 1
  s_lshl_b32 s34, s34, 2
  s_add_u32 s34, s34, 1024
  s_add_u32 s34, s34, s100
  v_lshlrev_b32 v10, 3, v1
  v_add_u32 v10, s34, v10
  s_mov_b32 s36, 3
  s_mov_b32 s39, 0
  s_mov_b64 s[70:71], exec
  s_mov_b32 exec_lo, 0x3
  s_mov_b32 exec_hi, 0x0
pjw_51:
  buffer_load_dword v11, v10, s[8:11], 0 offen sc1
  s_waitcnt vmcnt(0)
  v_cmp_gt_u32 vcc, s36, v11
  s_cbranch_vccz pjwd_52
  s_sleep 2
  s_add_u32 s39, s39, 1
  s_cmp_lt_u32 s39, s33
  s_cbranch_scc1 pjw_51
  s_mov_b32 s33, 0
pjwd_52:
  s_mov_b64 exec, s[70:71]
pjw_50:
  s_waitcnt vmcnt(0)
  s_barrier
  s_add_u32 s40, s49, 1
  s_cmp_lg_u32 s30, 0
  s_cbranch_scc1 pjf_53
  v_mov_b32 v10, s45
  v_mov_b32 v11, s40
  s_mov_b64 exec, 1
  buffer_store_dword v11, v10, s[8:11], 0 offen sc1
  s_mov_b64 exec, -1
pjf_53:
  s_branch L_pj_par1V
L_pj_loopK:
  s_add_u32 s34, s40, 3
  s_min_u32 s34, s34, 63
  s_mul_i32 s46, s34, 40960
  s_sub_u32 s34, s40, 1
  s_lshl_b32 s47, s34, 18
  s_add_u32 s47, s47, s44
  ds_read_b128 v[12:15], v9 offset:0
  ds_read_b128 v[248:251], v9 offset:32
  ds_read_b128 v[252:255], v9 offset:64
  s_waitcnt lgkmcnt(2)
  v_mfma_f32_32x32x16_bf16 v[176:191], v[16:19], v[12:15], 0
  ds_read_b128 v[12:15], v9 offset:96
  s_waitcnt lgkmcnt(2)
  v_mfma_f32_32x32x16_bf16 v[176:191], v[20:23], v[248:251], v[176:191]
  ds_write_b128 v3, v[228:231] offset:41472
  ds_read_b128 v[248:251], v9 offset:128
  s_waitcnt lgkmcnt(2)
  v_mfma_f32_32x32x16_bf16 v[176:191], v[24:27], v[252:255], v[176:191]
  v_cvt_pk_bf16_f32 v192, v192, v193
  v_cvt_pk_bf16_f32 v193, v194, v195
  ds_read_b128 v[252:255], v9 offset:160
  s_waitcnt lgkmcnt(2)
  v_mfma_f32_32x32x16_bf16 v[176:191], v[28:31], v[12:15], v[176:191]
  ds_write_b128 v4, v[232:235] offset:41472
  ds_read_b128 v[12:15], v9 offset:192
  s_waitcnt lgkmcnt(2)
  v_mfma_f32_32x32x16_bf16 v[176:191], v[32:35], v[248:251], v[176:191]
  v_cvt_pk_bf16_f32 v194, v196, v197
  v_cvt_pk_bf16_f32 v195, v198, v199
  ds_read_b128 v[248:251], v9 offset:224
  s_waitcnt lgkmcnt(2)
  v_mfma_f32_32x32x16_bf16 v[176:191], v[36:39], v[252:255], v[176:191]
  ds_write_b128 v5, v[236:239] offset:41472
  ds_read_b128 v[252:255], v9 offset:256
  s_waitcnt lgkmcnt(2)
  v_mfma_f32_32x32x16_bf16 v[176:191], v[40:43], v[12:15], v[176:191]
  v_cvt_pk_bf16_f32 v196, v200, v201
  v_cvt_pk_bf16_f32 v197, v202, v203
  ds_read_b128 v[12:15], v9 offset:288
  s_waitcnt lgkmcnt(2)
  v_mfma_f32_32x32x16_bf16 v[176:191], v[44:47], v[248:251], v[176:191]
  ds_write_b128 v6, v[240:243] offset:41472
  ds_read_b128 v[248:251], v9 offset:320
  s_waitcnt lgkmcnt(2)
  v_mfma_f32_32x32x16_bf16 v[176:191], v[48:51], v[252:255], v[176:191]
  v_cvt_pk_bf16_f32 v198, v204, v205
  v_cvt_pk_bf16_f32 v199, v206, v207
  ds_read_b128 v[252:255], v9 offset:352
  s_waitcnt lgkmcnt(2)
  v_mfma_f32_32x32x16_bf16 v[176:191], v[52:55], v[12:15], v[176:191]
  ds_write_b128 v7, v[244:247] offset:41472
  ds_read_b128 v[12:15], v9 offset:384
  s_waitcnt lgkmcnt(2)
  v_mfma_f32_32x32x16_bf16 v[176:191], v[56:59], v[248:251], v[176:191]
  s_cmp_le_u32 s40, 6
  s_cbranch_scc1 pjs_54
  buffer_store_dwordx4 v[192:195], v8, s[8:11], s47 offen sc1
  buffer_store_dwordx4 v[196:199], v8, s[8:11], s47 offen offset:512 sc1
pjs_54:
  ds_read_b128 v[248:251], v9 offset:416
  s_waitcnt lgkmcnt(2)
  v_mfma_f32_32x32x16_bf16 v[176:191], v[60:63], v[252:255], v[176:191]
  s_add_u32 s48, s46, 0
  buffer_load_dwordx4 v[228:231], v2, s[20:23], s48 offen
  ds_read_b128 v[252:255], v9 offset:448
  s_waitcnt lgkmcnt(2)
  v_mfma_f32_32x32x16_bf16 v[176:191], v[64:67], v[12:15], v[176:191]
  s_add_u32 s48, s46, 8192
  buffer_load_dwordx4 v[232:235], v2, s[20:23], s48 offen
  ds_read_b128 v[12:15], v9 offset:480
  s_waitcnt lgkmcnt(2)
  v_mfma_f32_32x32x16_bf16 v[176:191], v[68:71], v[248:251], v[176:191]
  s_add_u32 s48, s46, 16384
  buffer_load_dwordx4 v[236:239], v2, s[20:23], s48 offen
  ds_read_b128 v[248:251], v9 offset:512
  s_waitcnt lgkmcnt(2)
  v_mfma_f32_32x32x16_bf16 v[176:191], v[72:75], v[252:255], v[176:191]
  s_add_u32 s48, s46, 24576
  buffer_load_dwordx4 v[240:243], v2, s[20:23], s48 offen
  ds_read_b128 v[252:255], v9 offset:544
  s_waitcnt lgkmcnt(2)
  v_mfma_f32_32x32x16_bf16 v[176:191], v[76:79], v[12:15], v[176:191]
  s_add_u32 s48, s46, 32768
  buffer_load_dwordx4 v[244:247], v2, s[20:23], s48 offen
  ds_read_b128 v[12:15], v9 offset:576
  s_waitcnt lgkmcnt(2)
  v_mfma_f32_32x32x16_bf16 v[176:191], v[80:83], v[248:251], v[176:191]
  s_cmp_gt_u32 s40, 6
  s_cbranch_scc1 pjm_55
  s_waitcnt vmcnt(5)
  s_barrier
  s_cmp_lg_u32 s30, 0
  s_cbranch_scc1 pjf_56
  v_mov_b32 v10, s45
  v_mov_b32 v11, s40
  s_mov_b64 exec, 1
  buffer_store_dword v11, v10, s[8:11], 0 offen sc1
  s_mov_b64 exec, -1
pjf_56:
pjm_55:
  ds_read_b128 v[248:251], v9 offset:608
  s_waitcnt lgkmcnt(2)
  v_mfma_f32_32x32x16_bf16 v[176:191], v[84:87], v[252:255], v[176:191]
  ds_read_b128 v[252:255], v9 offset:640
  s_waitcnt lgkmcnt(2)
  v_mfma_f32_32x32x16_bf16 v[176:191], v[88:91], v[12:15], v[176:191]
  ds_read_b128 v[12:15], v9 offset:672
  s_waitcnt lgkmcnt(2)
  v_mfma_f32_32x32x16_bf16 v[176:191], v[92:95], v[248:251], v[176:191]
  ds_read_b128 v[248:251], v9 offset:704
  s_waitcnt lgkmcnt(2)
  v_mfma_f32_32x32x16_bf16 v[176:191], v[96:99], v[252:255], v[176:191]
  ds_read_b128 v[252:255], v9 offset:736
  s_waitcnt lgkmcnt(2)
  v_mfma_f32_32x32x16_bf16 v[176:191], v[100:103], v[12:15], v[176:191]
  ds_read_b128 v[12:15], v9 offset:768
  s_waitcnt lgkmcnt(2)
  v_mfma_f32_32x32x16_bf16 v[176:191], v[104:107], v[248:251], v[176:191]
  ds_read_b128 v[248:251], v9 offset:800
  s_waitcnt lgkmcnt(2)
  v_mfma_f32_32x32x16_bf16 v[176:191], v[108:111], v[252:255], v[176:191]
  ds_read_b128 v[252:255], v9 offset:832
  s_waitcnt lgkmcnt(2)
  v_mfma_f32_32x32x16_bf16 v[176:191], v[112:115], v[12:15], v[176:191]
  ds_read_b128 v[12:15], v9 offset:864
  s_waitcnt lgkmcnt(2)
  v_mfma_f32_32x32x16_bf16 v[176:191], v[116:119], v[248:251], v[176:191]
  ds_read_b128 v[248:251], v9 offset:896
  s_waitcnt lgkmcnt(2)
  v_mfma_f32_32x32x16_bf16 v[176:191], v[120:123], v[252:255], v[176:191]
  ds_read_b128 v[252:255], v9 offset:928
  s_waitcnt lgkmcnt(2)
  v_mfma_f32_32x32x16_bf16 v[176:191], v[124:127], v[12:15], v[176:191]
  ds_read_b128 v[12:15], v9 offset:960
  s_waitcnt lgkmcnt(2)
  v_mfma_f32_32x32x16_bf16 v[176:191], v[128:131], v[248:251], v[176:191]
  ds_read_b128 v[248:251], v9 offset:992
  s_waitcnt lgkmcnt(2)
  v_mfma_f32_32x32x16_bf16 v[176:191], v[132:135], v[252:255], v[176:191]
  ds_read_b128 v[252:255], v9 offset:1024
  s_waitcnt lgkmcnt(2)
  v_mfma_f32_32x32x16_bf16 v[176:191], v[136:139], v[12:15], v[176:191]
  ds_read_b128 v[12:15], v9 offset:1056
  s_waitcnt lgkmcnt(2)
  v_mfma_f32_32x32x16_bf16 v[176:191], v[140:143], v[248:251], v[176:191]
  ds_read_b128 v[248:251], v9 offset:1088
  s_waitcnt lgkmcnt(2)
  v_mfma_f32_32x32x16_bf16 v[176:191], v[144:147], v[252:255], v[176:191]
  ds_read_b128 v[252:255], v9 offset:1120
  s_waitcnt lgkmcnt(2)
  v_mfma_f32_32x32x16_bf16 v[176:191], v[148:151], v[12:15], v[176:191]
  ds_read_b128 v[12:15], v9 offset:1152
  s_waitcnt lgkmcnt(2)
  v_mfma_f32_32x32x16_bf16 v[176:191], v[152:155], v[248:251], v[176:191]
  ds_read_b128 v[248:251], v9 offset:1184
  s_waitcnt lgkmcnt(2)
  v_mfma_f32_32x32x16_bf16 v[176:191], v[156:159], v[252:255], v[176:191]
  ds_read_b128 v[252:255], v9 offset:1216
  s_waitcnt lgkmcnt(2)
  v_mfma_f32_32x32x16_bf16 v[176:191], v[160:163], v[12:15], v[176:191]
  ds_read_b128 v[12:15], v9 offset:1248
  s_waitcnt lgkmcnt(2)
  v_mfma_f32_32x32x16_bf16 v[176:191], v[164:167], v[248:251], v[176:191]
  s_waitcnt lgkmcnt(1)
  v_mfma_f32_32x32x16_bf16 v[176:191], v[168:171], v[252:255], v[176:191]
  s_waitcnt lgkmcnt(0)
  v_mfma_f32_32x32x16_bf16 v[176:191], v[172:175], v[12:15], v[176:191]
  s_cmp_gt_u32 s40, 5
  s_cbranch_scc1 pje_57
s_nop 9
  v_cvt_pk_bf16_f32 v176, v176, v177
  v_cvt_pk_bf16_f32 v177, v178, v179
  v_cvt_pk_bf16_f32 v178, v180, v181
  v_cvt_pk_bf16_f32 v179, v182, v183
  v_cvt_pk_bf16_f32 v180, v184, v185
  v_cvt_pk_bf16_f32 v181, v186, v187
  v_cvt_pk_bf16_f32 v182, v188, v189
  v_cvt_pk_bf16_f32 v183, v190, v191
  s_lshl_b32 s47, s40, 18
  s_add_u32 s47, s47, s44
  buffer_store_dwordx4 v[176:179], v8, s[8:11], s47 offen sc1
  buffer_store_dwordx4 v[180:183], v8, s[8:11], s47 offen offset:512 sc1
  s_waitcnt vmcnt(7)
  s_barrier
  s_branch pje_57_d
pje_57:
  s_waitcnt vmcnt(5)
  s_barrier
  s_cmp_lg_u32 s30, 0
  s_cbranch_scc1 pjf_58
  v_mov_b32 v10, s45
  v_mov_b32 v11, s40
  s_mov_b64 exec, 1
  buffer_store_dword v11, v10, s[8:11], 0 offen sc1
  s_mov_b64 exec, -1
pjf_58:
pje_57_d:
  s_add_u32 s40, s40, 1
  s_cmp_ge_u32 s40, 64
  s_cbranch_scc1 L_pj_fin0K
L_pj_par1K:
  s_add_u32 s34, s40, 3
  s_min_u32 s34, s34, 63
  s_mul_i32 s46, s34, 40960
  s_sub_u32 s34, s40, 1
  s_lshl_b32 s47, s34, 18
  s_add_u32 s47, s47, s44
  ds_read_b128 v[12:15], v9 offset:41472
  ds_read_b128 v[248:251], v9 offset:41504
  ds_read_b128 v[252:255], v9 offset:41536
  s_waitcnt lgkmcnt(2)
  v_mfma_f32_32x32x16_bf16 v[192:207], v[16:19], v[12:15], 0
  ds_read_b128 v[12:15], v9 offset:41568
  s_waitcnt lgkmcnt(2)
  v_mfma_f32_32x32x16_bf16 v[192:207], v[20:23], v[248:251], v[192:207]
  ds_write_b128 v3, v[208:211] offset:0
  ds_read_b128 v[248:251], v9 offset:41600
  s_waitcnt lgkmcnt(2)
  v_mfma_f32_32x32x16_bf16 v[192:207], v[24:27], v[252:255], v[192:207]
  v_cvt_pk_bf16_f32 v176, v176, v177
  v_cvt_pk_bf16_f32 v177, v178, v179
  ds_read_b128 v[252:255], v9 offset:41632
  s_waitcnt lgkmcnt(2)
  v_mfma_f32_32x32x16_bf16 v[192:207], v[28:31], v[12:15], v[192:207]
  ds_write_b128 v4, v[212:215] offset:0
  ds_read_b128 v[12:15], v9 offset:41664
  s_waitcnt lgkmcnt(2)
  v_mfma_f32_32x32x16_bf16 v[192:207], v[32:35], v[248:251], v[192:207]
  v_cvt_pk_bf16_f32 v178, v180, v181
  v_cvt_pk_bf16_f32 v179, v182, v183
  ds_read_b128 v[248:251], v9 offset:41696
  s_waitcnt lgkmcnt(2)
  v_mfma_f32_32x32x16_bf16 v[192:207], v[36:39], v[252:255], v[192:207]
  ds_write_b128 v5, v[216:219] offset:0
  ds_read_b128 v[252:255], v9 offset:41728
  s_waitcnt lgkmcnt(2)
  v_mfma_f32_32x32x16_bf16 v[192:207], v[40:43], v[12:15], v[192:207]
  v_cvt_pk_bf16_f32 v180, v184, v185
  v_cvt_pk_bf16_f32 v181, v186, v187
  ds_read_b128 v[12:15], v9 offset:41760
  s_waitcnt lgkmcnt(2)
  v_mfma_f32_32x32x16_bf16 v[192:207], v[44:47], v[248:251], v[192:207]
  ds_write_b128 v6, v[220:223] offset:0
  ds_read_b128 v[248:251], v9 offset:41792
  s_waitcnt lgkmcnt(2)
  v_mfma_f32_32x32x16_bf16 v[192:207], v[48:51], v[252:255], v[192:207]
  v_cvt_pk_bf16_f32 v182, v188, v189
  v_cvt_pk_bf16_f32 v183, v190, v191
  ds_read_b128 v[252:255], v9 offset:41824
  s_waitcnt lgkmcnt(2)
  v_mfma_f32_32x32x16_bf16 v[192:207], v[52:55], v[12:15], v[192:207]
  ds_write_b128 v7, v[224:227] offset:0
  ds_read_b128 v[12:15], v9 offset:41856
  s_waitcnt lgkmcnt(2)
  v_mfma_f32_32x32x16_bf16 v[192:207], v[56:59], v[248:251], v[192:207]
  s_cmp_le_u32 s40, 6
  s_cbranch_scc1 pjs_59
  buffer_store_dwordx4 v[176:179], v8, s[8:11], s47 offen sc1
  buffer_store_dwordx4 v[180:183], v8, s[8:11], s47 offen offset:512 sc1
pjs_59:
  ds_read_b128 v[248:251], v9 offset:41888
  s_waitcnt lgkmcnt(2)
  v_mfma_f32_32x32x16_bf16 v[192:207], v[60:63], v[252:255], v[192:207]
  s_add_u32 s48, s46, 0
  buffer_load_dwordx4 v[208:211], v2, s[20:23], s48 offen
  ds_read_b128 v[252:255], v9 offset:41920
  s_waitcnt lgkmcnt(2)
  v_mfma_f32_32x32x16_bf16 v[192:207], v[64:67], v[12:15], v[192:207]
  s_add_u32 s48, s46, 8192
  buffer_load_dwordx4 v[212:215], v2, s[20:23], s48 offen
  ds_read_b128 v[12:15], v9 offset:41952
  s_waitcnt lgkmcnt(2)
  v_mfma_f32_32x32x16_bf16 v[192:207], v[68:71], v[248:251], v[192:207]
  s_add_u32 s48, s46, 16384
  buffer_load_dwordx4 v[216:219], v2, s[20:23], s48 offen
  ds_read_b128 v[248:251], v9 offset:41984
  s_waitcnt lgkmcnt(2)
  v_mfma_f32_32x32x16_bf16 v[192:207], v[72:75], v[252:255], v[192:207]
  s_add_u32 s48, s46, 24576
  buffer_load_dwordx4 v[220:223], v2, s[20:23], s48 offen
  ds_read_b128 v[252:255], v9 offset:42016
  s_waitcnt lgkmcnt(2)
  v_mfma_f32_32x32x16_bf16 v[192:207], v[76:79], v[12:15], v[192:207]
  s_add_u32 s48, s46, 32768
  buffer_load_dwordx4 v[224:227], v2, s[20:23], s48 offen
  ds_read_b128 v[12:15], v9 offset:42048
  s_waitcnt lgkmcnt(2)
  v_mfma_f32_32x32x16_bf16 v[192:207], v[80:83], v[248:251], v[192:207]
  s_cmp_gt_u32 s40, 6
  s_cbranch_scc1 pjm_60
  s_waitcnt vmcnt(5)
  s_barrier
  s_cmp_lg_u32 s30, 0
  s_cbranch_scc1 pjf_61
  v_mov_b32 v10, s45
  v_mov_b32 v11, s40
  s_mov_b64 exec, 1
  buffer_store_dword v11, v10, s[8:11], 0 offen sc1
  s_mov_b64 exec, -1
pjf_61:
pjm_60:
  ds_read_b128 v[248:251], v9 offset:42080
  s_waitcnt lgkmcnt(2)
  v_mfma_f32_32x32x16_bf16 v[192:207], v[84:87], v[252:255], v[192:207]
  ds_read_b128 v[252:255], v9 offset:42112
  s_waitcnt lgkmcnt(2)
  v_mfma_f32_32x32x16_bf16 v[192:207], v[88:91], v[12:15], v[192:207]
  ds_read_b128 v[12:15], v9 offset:42144
  s_waitcnt lgkmcnt(2)
  v_mfma_f32_32x32x16_bf16 v[192:207], v[92:95], v[248:251], v[192:207]
  ds_read_b128 v[248:251], v9 offset:42176
  s_waitcnt lgkmcnt(2)
  v_mfma_f32_32x32x16_bf16 v[192:207], v[96:99], v[252:255], v[192:207]
  ds_read_b128 v[252:255], v9 offset:42208
  s_waitcnt lgkmcnt(2)
  v_mfma_f32_32x32x16_bf16 v[192:207], v[100:103], v[12:15], v[192:207]
  ds_read_b128 v[12:15], v9 offset:42240
  s_waitcnt lgkmcnt(2)
  v_mfma_f32_32x32x16_bf16 v[192:207], v[104:107], v[248:251], v[192:207]
  ds_read_b128 v[248:251], v9 offset:42272
  s_waitcnt lgkmcnt(2)
  v_mfma_f32_32x32x16_bf16 v[192:207], v[108:111], v[252:255], v[192:207]
  ds_read_b128 v[252:255], v9 offset:42304
  s_waitcnt lgkmcnt(2)
  v_mfma_f32_32x32x16_bf16 v[192:207], v[112:115], v[12:15], v[192:207]
  ds_read_b128 v[12:15], v9 offset:42336
  s_waitcnt lgkmcnt(2)
  v_mfma_f32_32x32x16_bf16 v[192:207], v[116:119], v[248:251], v[192:207]
  ds_read_b128 v[248:251], v9 offset:42368
  s_waitcnt lgkmcnt(2)
  v_mfma_f32_32x32x16_bf16 v[192:207], v[120:123], v[252:255], v[192:207]
  ds_read_b128 v[252:255], v9 offset:42400
  s_waitcnt lgkmcnt(2)
  v_mfma_f32_32x32x16_bf16 v[192:207], v[124:127], v[12:15], v[192:207]
  ds_read_b128 v[12:15], v9 offset:42432
  s_waitcnt lgkmcnt(2)
  v_mfma_f32_32x32x16_bf16 v[192:207], v[128:131], v[248:251], v[192:207]
  ds_read_b128 v[248:251], v9 offset:42464
  s_waitcnt lgkmcnt(2)
  v_mfma_f32_32x32x16_bf16 v[192:207], v[132:135], v[252:255], v[192:207]
  ds_read_b128 v[252:255], v9 offset:42496
  s_waitcnt lgkmcnt(2)
  v_mfma_f32_32x32x16_bf16 v[192:207], v[136:139], v[12:15], v[192:207]
  ds_read_b128 v[12:15], v9 offset:42528
  s_waitcnt lgkmcnt(2)
  v_mfma_f32_32x32x16_bf16 v[192:207], v[140:143], v[248:251], v[192:207]
  ds_read_b128 v[248:251], v9 offset:42560
  s_waitcnt lgkmcnt(2)
  v_mfma_f32_32x32x16_bf16 v[192:207], v[144:147], v[252:255], v[192:207]
  ds_read_b128 v[252:255], v9 offset:42592
  s_waitcnt lgkmcnt(2)
  v_mfma_f32_32x32x16_bf16 v[192:207], v[148:151], v[12:15], v[192:207]
  ds_read_b128 v[12:15], v9 offset:42624
  s_waitcnt lgkmcnt(2)
  v_mfma_f32_32x32x16_bf16 v[192:207], v[152:155], v[248:251], v[192:207]
  ds_read_b128 v[248:251], v9 offset:42656
  s_waitcnt lgkmcnt(2)
  v_mfma_f32_32x32x16_bf16 v[192:207], v[156:159], v[252:255], v[192:207]
  ds_read_b128 v[252:255], v9 offset:42688
  s_waitcnt lgkmcnt(2)
  v_mfma_f32_32x32x16_bf16 v[192:207], v[160:163], v[12:15], v[192:207]
  ds_read_b128 v[12:15], v9 offset:42720
  s_waitcnt lgkmcnt(2)
  v_mfma_f32_32x32x16_bf16 v[192:207], v[164:167], v[248:251], v[192:207]
  s_waitcnt lgkmcnt(1)
  v_mfma_f32_32x32x16_bf16 v[192:207], v[168:171], v[252:255], v[192:207]
  s_waitcnt lgkmcnt(0)
  v_mfma_f32_32x32x16_bf16 v[192:207], v[172:175], v[12:15], v[192:207]
  s_cmp_gt_u32 s40, 5
  s_cbranch_scc1 pje_62
s_nop 9
  v_cvt_pk_bf16_f32 v192, v192, v193
  v_cvt_pk_bf16_f32 v193, v194, v195
  v_cvt_pk_bf16_f32 v194, v196, v197
  v_cvt_pk_bf16_f32 v195, v198, v199
  v_cvt_pk_bf16_f32 v196, v200, v201
  v_cvt_pk_bf16_f32 v197, v202, v203
  v_cvt_pk_bf16_f32 v198, v204, v205
  v_cvt_pk_bf16_f32 v199, v206, v207
  s_lshl_b32 s47, s40, 18
  s_add_u32 s47, s47, s44
  buffer_store_dwordx4 v[192:195], v8, s[8:11], s47 offen sc1
  buffer_store_dwordx4 v[196:199], v8, s[8:11], s47 offen offset:512 sc1
  s_waitcnt vmcnt(7)
  s_barrier
  s_branch pje_62_d
pje_62:
  s_waitcnt vmcnt(5)
  s_barrier
  s_cmp_lg_u32 s30, 0
  s_cbranch_scc1 pjf_63
  v_mov_b32 v10, s45
  v_mov_b32 v11, s40
  s_mov_b64 exec, 1
  buffer_store_dword v11, v10, s[8:11], 0 offen sc1
  s_mov_b64 exec, -1
pjf_63:
pje_62_d:
  s_add_u32 s40, s40, 1
  s_cmp_lt_u32 s40, 64
  s_cbranch_scc1 L_pj_loopK
s_nop 2
  v_cvt_pk_bf16_f32 v192, v192, v193
  v_cvt_pk_bf16_f32 v193, v194, v195
  v_cvt_pk_bf16_f32 v194, v196, v197
  v_cvt_pk_bf16_f32 v195, v198, v199
  v_cvt_pk_bf16_f32 v196, v200, v201
  v_cvt_pk_bf16_f32 v197, v202, v203
  v_cvt_pk_bf16_f32 v198, v204, v205
  v_cvt_pk_bf16_f32 v199, v206, v207
  s_mov_b32 s47, 63
  s_lshl_b32 s47, s47, 18
  s_add_u32 s47, s47, s44
  buffer_store_dwordx4 v[192:195], v8, s[8:11], s47 offen sc1
  buffer_store_dwordx4 v[196:199], v8, s[8:11], s47 offen offset:512 sc1
  s_branch L_pj_finK
L_pj_fin0K:
s_nop 2
  v_cvt_pk_bf16_f32 v176, v176, v177
  v_cvt_pk_bf16_f32 v177, v178, v179
  v_cvt_pk_bf16_f32 v178, v180, v181
  v_cvt_pk_bf16_f32 v179, v182, v183
  v_cvt_pk_bf16_f32 v180, v184, v185
  v_cvt_pk_bf16_f32 v181, v186, v187
  v_cvt_pk_bf16_f32 v182, v188, v189
  v_cvt_pk_bf16_f32 v183, v190, v191
  s_mov_b32 s47, 63
  s_lshl_b32 s47, s47, 18
  s_add_u32 s47, s47, s44
  buffer_store_dwordx4 v[176:179], v8, s[8:11], s47 offen sc1
  buffer_store_dwordx4 v[180:183], v8, s[8:11], s47 offen offset:512 sc1
L_pj_finK:
  s_waitcnt vmcnt(0)
  s_barrier
  s_cmp_lg_u32 s30, 0
  s_cbranch_scc1 pjf_64
  v_mov_b32 v10, s45
  v_mov_b32 v11, 64
  s_mov_b64 exec, 1
  buffer_store_dword v11, v10, s[8:11], 0 offen sc1
  s_mov_b64 exec, -1
pjf_64:
  s_branch L_end
L_pj_loopV:
  s_add_u32 s34, s40, 3
  s_min_u32 s34, s34, 63
  s_mul_i32 s46, s34, 40960
  s_sub_u32 s34, s40, 1
  s_lshl_b32 s47, s34, 18
  s_add_u32 s47, s47, s44
  ds_read_b128 v[12:15], v9 offset:0
  ds_read_b128 v[248:251], v9 offset:32
  ds_read_b128 v[252:255], v9 offset:64
  s_waitcnt lgkmcnt(2)
  v_mfma_f32_32x32x16_bf16 v[176:191], v[12:15], v[16:19], 0
  ds_read_b128 v[12:15], v9 offset:96
  s_waitcnt lgkmcnt(2)
  v_mfma_f32_32x32x16_bf16 v[176:191], v[248:251], v[20:23], v[176:191]
  ds_write_b128 v3, v[228:231] offset:41472
  ds_read_b128 v[248:251], v9 offset:128
  s_waitcnt lgkmcnt(2)
  v_mfma_f32_32x32x16_bf16 v[176:191], v[252:255], v[24:27], v[176:191]
  v_cvt_pk_bf16_f32 v192, v192, v193
  v_cvt_pk_bf16_f32 v193, v194, v195
  ds_read_b128 v[252:255], v9 offset:160
  s_waitcnt lgkmcnt(2)
  v_mfma_f32_32x32x16_bf16 v[176:191], v[12:15], v[28:31], v[176:191]
  ds_write_b128 v4, v[232:235] offset:41472
  ds_read_b128 v[12:15], v9 offset:192
  s_waitcnt lgkmcnt(2)
  v_mfma_f32_32x32x16_bf16 v[176:191], v[248:251], v[32:35], v[176:191]
  v_cvt_pk_bf16_f32 v194, v200, v201
  v_cvt_pk_bf16_f32 v195, v202, v203
  ds_read_b128 v[248:251], v9 offset:224
  s_waitcnt lgkmcnt(2)
  v_mfma_f32_32x32x16_bf16 v[176:191], v[252:255], v[36:39], v[176:191]
  ds_write_b128 v5, v[236:239] offset:41472
  ds_read_b128 v[252:255], v9 offset:256
  s_waitcnt lgkmcnt(2)
  v_mfma_f32_32x32x16_bf16 v[176:191], v[12:15], v[40:43], v[176:191]
  v_cvt_pk_bf16_f32 v196, v196, v197
  v_cvt_pk_bf16_f32 v197, v198, v199
  ds_read_b128 v[12:15], v9 offset:288
  s_waitcnt lgkmcnt(2)
  v_mfma_f32_32x32x16_bf16 v[176:191], v[248:251], v[44:47], v[176:191]
  ds_write_b128 v6, v[240:243] offset:41472
  ds_read_b128 v[248:251], v9 offset:320
  s_waitcnt lgkmcnt(2)
  v_mfma_f32_32x32x16_bf16 v[176:191], v[252:255], v[48:51], v[176:191]
  v_cvt_pk_bf16_f32 v198, v204, v205
  v_cvt_pk_bf16_f32 v199, v206, v207
  ds_read_b128 v[252:255], v9 offset:352
  s_waitcnt lgkmcnt(2)
  v_mfma_f32_32x32x16_bf16 v[176:191], v[12:15], v[52:55], v[176:191]
  ds_write_b128 v7, v[244:247] offset:41472
  ds_read_b128 v[12:15], v9 offset:384
  s_waitcnt lgkmcnt(2)
  v_mfma_f32_32x32x16_bf16 v[176:191], v[248:251], v[56:59], v[176:191]
  s_cmp_le_u32 s40, 6
  s_cbranch_scc1 pjs_65
  buffer_store_dwordx4 v[192:195], v8, s[8:11], s47 offen sc1
  buffer_store_dwordx4 v[196:199], v8, s[8:11], s47 offen offset:512 sc1
pjs_65:
  ds_read_b128 v[248:251], v9 offset:416
  s_waitcnt lgkmcnt(2)
  v_mfma_f32_32x32x16_bf16 v[176:191], v[252:255], v[60:63], v[176:191]
  s_add_u32 s48, s46, 0
  buffer_load_dwordx4 v[228:231], v2, s[20:23], s48 offen
  ds_read_b128 v[252:255], v9 offset:448
  s_waitcnt lgkmcnt(2)
  v_mfma_f32_32x32x16_bf16 v[176:191], v[12:15], v[64:67], v[176:191]
  s_add_u32 s48, s46, 8192
  buffer_load_dwordx4 v[232:235], v2, s[20:23], s48 offen
  ds_read_b128 v[12:15], v9 offset:480
  s_waitcnt lgkmcnt(2)
  v_mfma_f32_32x32x16_bf16 v[176:191], v[248:251], v[68:71], v[176:191]
  s_add_u32 s48, s46, 16384
  buffer_load_dwordx4 v[236:239], v2, s[20:23], s48 offen
  ds_read_b128 v[248:251], v9 offset:512
  s_waitcnt lgkmcnt(2)
  v_mfma_f32_32x32x16_bf16 v[176:191], v[252:255], v[72:75], v[176:191]
  s_add_u32 s48, s46, 24576
  buffer_load_dwordx4 v[240:243], v2, s[20:23], s48 offen
  ds_read_b128 v[252:255], v9 offset:544
  s_waitcnt lgkmcnt(2)
  v_mfma_f32_32x32x16_bf16 v[176:191], v[12:15], v[76:79], v[176:191]
  s_add_u32 s48, s46, 32768
  buffer_load_dwordx4 v[244:247], v2, s[20:23], s48 offen
  ds_read_b128 v[12:15], v9 offset:576
  s_waitcnt lgkmcnt(2)
  v_mfma_f32_32x32x16_bf16 v[176:191], v[248:251], v[80:83], v[176:191]
  s_cmp_gt_u32 s40, 6
  s_cbranch_scc1 pjm_66
  s_waitcnt vmcnt(5)
  s_barrier
  s_cmp_lg_u32 s30, 0
  s_cbranch_scc1 pjf_67
  v_mov_b32 v10, s45
  v_mov_b32 v11, s40
  s_mov_b64 exec, 1
  buffer_store_dword v11, v10, s[8:11], 0 offen sc1
  s_mov_b64 exec, -1
pjf_67:
pjm_66:
  ds_read_b128 v[248:251], v9 offset:608
  s_waitcnt lgkmcnt(2)
  v_mfma_f32_32x32x16_bf16 v[176:191], v[252:255], v[84:87], v[176:191]
  ds_read_b128 v[252:255], v9 offset:640
  s_waitcnt lgkmcnt(2)
  v_mfma_f32_32x32x16_bf16 v[176:191], v[12:15], v[88:91], v[176:191]
  ds_read_b128 v[12:15], v9 offset:672
  s_waitcnt lgkmcnt(2)
  v_mfma_f32_32x32x16_bf16 v[176:191], v[248:251], v[92:95], v[176:191]
  ds_read_b128 v[248:251], v9 offset:704
  s_waitcnt lgkmcnt(2)
  v_mfma_f32_32x32x16_bf16 v[176:191], v[252:255], v[96:99], v[176:191]
  ds_read_b128 v[252:255], v9 offset:736
  s_waitcnt lgkmcnt(2)
  v_mfma_f32_32x32x16_bf16 v[176:191], v[12:15], v[100:103], v[176:191]
  ds_read_b128 v[12:15], v9 offset:768
  s_waitcnt lgkmcnt(2)
  v_mfma_f32_32x32x16_bf16 v[176:191], v[248:251], v[104:107], v[176:191]
  ds_read_b128 v[248:251], v9 offset:800
  s_waitcnt lgkmcnt(2)
  v_mfma_f32_32x32x16_bf16 v[176:191], v[252:255], v[108:111], v[176:191]
  ds_read_b128 v[252:255], v9 offset:832
  s_waitcnt lgkmcnt(2)
  v_mfma_f32_32x32x16_bf16 v[176:191], v[12:15], v[112:115], v[176:191]
  ds_read_b128 v[12:15], v9 offset:864
  s_waitcnt lgkmcnt(2)
  v_mfma_f32_32x32x16_bf16 v[176:191], v[248:251], v[116:119], v[176:191]
  ds_read_b128 v[248:251], v9 offset:896
  s_waitcnt lgkmcnt(2)
  v_mfma_f32_32x32x16_bf16 v[176:191], v[252:255], v[120:123], v[176:191]
  ds_read_b128 v[252:255], v9 offset:928
  s_waitcnt lgkmcnt(2)
  v_mfma_f32_32x32x16_bf16 v[176:191], v[12:15], v[124:127], v[176:191]
  ds_read_b128 v[12:15], v9 offset:960
  s_waitcnt lgkmcnt(2)
  v_mfma_f32_32x32x16_bf16 v[176:191], v[248:251], v[128:131], v[176:191]
  ds_read_b128 v[248:251], v9 offset:992
  s_waitcnt lgkmcnt(2)
  v_mfma_f32_32x32x16_bf16 v[176:191], v[252:255], v[132:135], v[176:191]
  ds_read_b128 v[252:255], v9 offset:1024
  s_waitcnt lgkmcnt(2)
  v_mfma_f32_32x32x16_bf16 v[176:191], v[12:15], v[136:139], v[176:191]
  ds_read_b128 v[12:15], v9 offset:1056
  s_waitcnt lgkmcnt(2)
  v_mfma_f32_32x32x16_bf16 v[176:191], v[248:251], v[140:143], v[176:191]
  ds_read_b128 v[248:251], v9 offset:1088
  s_waitcnt lgkmcnt(2)
  v_mfma_f32_32x32x16_bf16 v[176:191], v[252:255], v[144:147], v[176:191]
  ds_read_b128 v[252:255], v9 offset:1120
  s_waitcnt lgkmcnt(2)
  v_mfma_f32_32x32x16_bf16 v[176:191], v[12:15], v[148:151], v[176:191]
  ds_read_b128 v[12:15], v9 offset:1152
  s_waitcnt lgkmcnt(2)
  v_mfma_f32_32x32x16_bf16 v[176:191], v[248:251], v[152:155], v[176:191]
  ds_read_b128 v[248:251], v9 offset:1184
  s_waitcnt lgkmcnt(2)
  v_mfma_f32_32x32x16_bf16 v[176:191], v[252:255], v[156:159], v[176:191]
  ds_read_b128 v[252:255], v9 offset:1216
  s_waitcnt lgkmcnt(2)
  v_mfma_f32_32x32x16_bf16 v[176:191], v[12:15], v[160:163], v[176:191]
  ds_read_b128 v[12:15], v9 offset:1248
  s_waitcnt lgkmcnt(2)
  v_mfma_f32_32x32x16_bf16 v[176:191], v[248:251], v[164:167], v[176:191]
  s_waitcnt lgkmcnt(1)
  v_mfma_f32_32x32x16_bf16 v[176:191], v[252:255], v[168:171], v[176:191]
  s_waitcnt lgkmcnt(0)
  v_mfma_f32_32x32x16_bf16 v[176:191], v[12:15], v[172:175], v[176:191]
  s_cmp_gt_u32 s40, 5
  s_cbranch_scc1 pje_68
s_nop 9
  v_cvt_pk_bf16_f32 v176, v176, v177
  v_cvt_pk_bf16_f32 v177, v178, v179
  v_cvt_pk_bf16_f32 v178, v184, v185
  v_cvt_pk_bf16_f32 v179, v186, v187
  v_cvt_pk_bf16_f32 v180, v180, v181
  v_cvt_pk_bf16_f32 v181, v182, v183
  v_cvt_pk_bf16_f32 v182, v188, v189
  v_cvt_pk_bf16_f32 v183, v190, v191
  s_lshl_b32 s47, s40, 18
  s_add_u32 s47, s47, s44
  buffer_store_dwordx4 v[176:179], v8, s[8:11], s47 offen sc1
  buffer_store_dwordx4 v[180:183], v8, s[8:11], s47 offen offset:512 sc1
  s_waitcnt vmcnt(7)
  s_barrier
  s_branch pje_68_d
pje_68:
  s_waitcnt vmcnt(5)
  s_barrier
  s_cmp_lg_u32 s30, 0
  s_cbranch_scc1 pjf_69
  v_mov_b32 v10, s45
  v_mov_b32 v11, s40
  s_mov_b64 exec, 1
  buffer_store_dword v11, v10, s[8:11], 0 offen sc1
  s_mov_b64 exec, -1
pjf_69:
pje_68_d:
  s_add_u32 s40, s40, 1
  s_cmp_ge_u32 s40, 64
  s_cbranch_scc1 L_pj_fin0V
L_pj_par1V:
  s_add_u32 s34, s40, 3
  s_min_u32 s34, s34, 63
  s_mul_i32 s46, s34, 40960
  s_sub_u32 s34, s40, 1
  s_lshl_b32 s47, s34, 18
  s_add_u32 s47, s47, s44
  ds_read_b128 v[12:15], v9 offset:41472
  ds_read_b128 v[248:251], v9 offset:41504
  ds_read_b128 v[252:255], v9 offset:41536
  s_waitcnt lgkmcnt(2)
  v_mfma_f32_32x32x16_bf16 v[192:207], v[12:15], v[16:19], 0
  ds_read_b128 v[12:15], v9 offset:41568
  s_waitcnt lgkmcnt(2)
  v_mfma_f32_32x32x16_bf16 v[192:207], v[248:251], v[20:23], v[192:207]
  ds_write_b128 v3, v[208:211] offset:0
  ds_read_b128 v[248:251], v9 offset:41600
  s_waitcnt lgkmcnt(2)
  v_mfma_f32_32x32x16_bf16 v[192:207], v[252:255], v[24:27], v[192:207]
  v_cvt_pk_bf16_f32 v176, v176, v177
  v_cvt_pk_bf16_f32 v177, v178, v179
  ds_read_b128 v[252:255], v9 offset:41632
  s_waitcnt lgkmcnt(2)
  v_mfma_f32_32x32x16_bf16 v[192:207], v[12:15], v[28:31], v[192:207]
  ds_write_b128 v4, v[212:215] offset:0
  ds_read_b128 v[12:15], v9 offset:41664
  s_waitcnt lgkmcnt(2)
  v_mfma_f32_32x32x16_bf16 v[192:207], v[248:251], v[32:35], v[192:207]
  v_cvt_pk_bf16_f32 v178, v184, v185
  v_cvt_pk_bf16_f32 v179, v186, v187
  ds_read_b128 v[248:251], v9 offset:41696
  s_waitcnt lgkmcnt(2)
  v_mfma_f32_32x32x16_bf16 v[192:207], v[252:255], v[36:39], v[192:207]
  ds_write_b128 v5, v[216:219] offset:0
  ds_read_b128 v[252:255], v9 offset:41728
  s_waitcnt lgkmcnt(2)
  v_mfma_f32_32x32x16_bf16 v[192:207], v[12:15], v[40:43], v[192:207]
  v_cvt_pk_bf16_f32 v180, v180, v181
  v_cvt_pk_bf16_f32 v181, v182, v183
  ds_read_b128 v[12:15], v9 offset:41760
  s_waitcnt lgkmcnt(2)
  v_mfma_f32_32x32x16_bf16 v[192:207], v[248:251], v[44:47], v[192:207]
  ds_write_b128 v6, v[220:223] offset:0
  ds_read_b128 v[248:251], v9 offset:41792
  s_waitcnt lgkmcnt(2)
  v_mfma_f32_32x32x16_bf16 v[192:207], v[252:255], v[48:51], v[192:207]
  v_cvt_pk_bf16_f32 v182, v188, v189
  v_cvt_pk_bf16_f32 v183, v190, v191
  ds_read_b128 v[252:255], v9 offset:41824
  s_waitcnt lgkmcnt(2)
  v_mfma_f32_32x32x16_bf16 v[192:207], v[12:15], v[52:55], v[192:207]
  ds_write_b128 v7, v[224:227] offset:0
  ds_read_b128 v[12:15], v9 offset:41856
  s_waitcnt lgkmcnt(2)
  v_mfma_f32_32x32x16_bf16 v[192:207], v[248:251], v[56:59], v[192:207]
  s_cmp_le_u32 s40, 6
  s_cbranch_scc1 pjs_70
  buffer_store_dwordx4 v[176:179], v8, s[8:11], s47 offen sc1
  buffer_store_dwordx4 v[180:183], v8, s[8:11], s47 offen offset:512 sc1
pjs_70:
  ds_read_b128 v[248:251], v9 offset:41888
  s_waitcnt lgkmcnt(2)
  v_mfma_f32_32x32x16_bf16 v[192:207], v[252:255], v[60:63], v[192:207]
  s_add_u32 s48, s46, 0
  buffer_load_dwordx4 v[208:211], v2, s[20:23], s48 offen
  ds_read_b128 v[252:255], v9 offset:41920
  s_waitcnt lgkmcnt(2)
  v_mfma_f32_32x32x16_bf16 v[192:207], v[12:15], v[64:67], v[192:207]
  s_add_u32 s48, s46, 8192
  buffer_load_dwordx4 v[212:215], v2, s[20:23], s48 offen
  ds_read_b128 v[12:15], v9 offset:41952
  s_waitcnt lgkmcnt(2)
  v_mfma_f32_32x32x16_bf16 v[192:207], v[248:251], v[68:71], v[192:207]
  s_add_u32 s48, s46, 16384
  buffer_load_dwordx4 v[216:219], v2, s[20:23], s48 offen
  ds_read_b128 v[248:251], v9 offset:41984
  s_waitcnt lgkmcnt(2)
  v_mfma_f32_32x32x16_bf16 v[192:207], v[252:255], v[72:75], v[192:207]
  s_add_u32 s48, s46, 24576
  buffer_load_dwordx4 v[220:223], v2, s[20:23], s48 offen
  ds_read_b128 v[252:255], v9 offset:42016
  s_waitcnt lgkmcnt(2)
  v_mfma_f32_32x32x16_bf16 v[192:207], v[12:15], v[76:79], v[192:207]
  s_add_u32 s48, s46, 32768
  buffer_load_dwordx4 v[224:227], v2, s[20:23], s48 offen
  ds_read_b128 v[12:15], v9 offset:42048
  s_waitcnt lgkmcnt(2)
  v_mfma_f32_32x32x16_bf16 v[192:207], v[248:251], v[80:83], v[192:207]
  s_cmp_gt_u32 s40, 6
  s_cbranch_scc1 pjm_71
  s_waitcnt vmcnt(5)
  s_barrier
  s_cmp_lg_u32 s30, 0
  s_cbranch_scc1 pjf_72
  v_mov_b32 v10, s45
  v_mov_b32 v11, s40
  s_mov_b64 exec, 1
  buffer_store_dword v11, v10, s[8:11], 0 offen sc1
  s_mov_b64 exec, -1
pjf_72:
pjm_71:
  ds_read_b128 v[248:251], v9 offset:42080
  s_waitcnt lgkmcnt(2)
  v_mfma_f32_32x32x16_bf16 v[192:207], v[252:255], v[84:87], v[192:207]
  ds_read_b128 v[252:255], v9 offset:42112
  s_waitcnt lgkmcnt(2)
  v_mfma_f32_32x32x16_bf16 v[192:207], v[12:15], v[88:91], v[192:207]
  ds_read_b128 v[12:15], v9 offset:42144
  s_waitcnt lgkmcnt(2)
  v_mfma_f32_32x32x16_bf16 v[192:207], v[248:251], v[92:95], v[192:207]
  ds_read_b128 v[248:251], v9 offset:42176
  s_waitcnt lgkmcnt(2)
  v_mfma_f32_32x32x16_bf16 v[192:207], v[252:255], v[96:99], v[192:207]
  ds_read_b128 v[252:255], v9 offset:42208
  s_waitcnt lgkmcnt(2)
  v_mfma_f32_32x32x16_bf16 v[192:207], v[12:15], v[100:103], v[192:207]
  ds_read_b128 v[12:15], v9 offset:42240
  s_waitcnt lgkmcnt(2)
  v_mfma_f32_32x32x16_bf16 v[192:207], v[248:251], v[104:107], v[192:207]
  ds_read_b128 v[248:251], v9 offset:42272
  s_waitcnt lgkmcnt(2)
  v_mfma_f32_32x32x16_bf16 v[192:207], v[252:255], v[108:111], v[192:207]
  ds_read_b128 v[252:255], v9 offset:42304
  s_waitcnt lgkmcnt(2)
  v_mfma_f32_32x32x16_bf16 v[192:207], v[12:15], v[112:115], v[192:207]
  ds_read_b128 v[12:15], v9 offset:42336
  s_waitcnt lgkmcnt(2)
  v_mfma_f32_32x32x16_bf16 v[192:207], v[248:251], v[116:119], v[192:207]
  ds_read_b128 v[248:251], v9 offset:42368
  s_waitcnt lgkmcnt(2)
  v_mfma_f32_32x32x16_bf16 v[192:207], v[252:255], v[120:123], v[192:207]
  ds_read_b128 v[252:255], v9 offset:42400
  s_waitcnt lgkmcnt(2)
  v_mfma_f32_32x32x16_bf16 v[192:207], v[12:15], v[124:127], v[192:207]
  ds_read_b128 v[12:15], v9 offset:42432
  s_waitcnt lgkmcnt(2)
  v_mfma_f32_32x32x16_bf16 v[192:207], v[248:251], v[128:131], v[192:207]
  ds_read_b128 v[248:251], v9 offset:42464
  s_waitcnt lgkmcnt(2)
  v_mfma_f32_32x32x16_bf16 v[192:207], v[252:255], v[132:135], v[192:207]
  ds_read_b128 v[252:255], v9 offset:42496
  s_waitcnt lgkmcnt(2)
  v_mfma_f32_32x32x16_bf16 v[192:207], v[12:15], v[136:139], v[192:207]
  ds_read_b128 v[12:15], v9 offset:42528
  s_waitcnt lgkmcnt(2)
  v_mfma_f32_32x32x16_bf16 v[192:207], v[248:251], v[140:143], v[192:207]
  ds_read_b128 v[248:251], v9 offset:42560
  s_waitcnt lgkmcnt(2)
  v_mfma_f32_32x32x16_bf16 v[192:207], v[252:255], v[144:147], v[192:207]
  ds_read_b128 v[252:255], v9 offset:42592
  s_waitcnt lgkmcnt(2)
  v_mfma_f32_32x32x16_bf16 v[192:207], v[12:15], v[148:151], v[192:207]
  ds_read_b128 v[12:15], v9 offset:42624
  s_waitcnt lgkmcnt(2)
  v_mfma_f32_32x32x16_bf16 v[192:207], v[248:251], v[152:155], v[192:207]
  ds_read_b128 v[248:251], v9 offset:42656
  s_waitcnt lgkmcnt(2)
  v_mfma_f32_32x32x16_bf16 v[192:207], v[252:255], v[156:159], v[192:207]
  ds_read_b128 v[252:255], v9 offset:42688
  s_waitcnt lgkmcnt(2)
  v_mfma_f32_32x32x16_bf16 v[192:207], v[12:15], v[160:163], v[192:207]
  ds_read_b128 v[12:15], v9 offset:42720
  s_waitcnt lgkmcnt(2)
  v_mfma_f32_32x32x16_bf16 v[192:207], v[248:251], v[164:167], v[192:207]
  s_waitcnt lgkmcnt(1)
  v_mfma_f32_32x32x16_bf16 v[192:207], v[252:255], v[168:171], v[192:207]
  s_waitcnt lgkmcnt(0)
  v_mfma_f32_32x32x16_bf16 v[192:207], v[12:15], v[172:175], v[192:207]
  s_cmp_gt_u32 s40, 5
  s_cbranch_scc1 pje_73
s_nop 9
  v_cvt_pk_bf16_f32 v192, v192, v193
  v_cvt_pk_bf16_f32 v193, v194, v195
  v_cvt_pk_bf16_f32 v194, v200, v201
  v_cvt_pk_bf16_f32 v195, v202, v203
  v_cvt_pk_bf16_f32 v196, v196, v197
  v_cvt_pk_bf16_f32 v197, v198, v199
  v_cvt_pk_bf16_f32 v198, v204, v205
  v_cvt_pk_bf16_f32 v199, v206, v207
  s_lshl_b32 s47, s40, 18
  s_add_u32 s47, s47, s44
  buffer_store_dwordx4 v[192:195], v8, s[8:11], s47 offen sc1
  buffer_store_dwordx4 v[196:199], v8, s[8:11], s47 offen offset:512 sc1
  s_waitcnt vmcnt(7)
  s_barrier
  s_branch pje_73_d
pje_73:
  s_waitcnt vmcnt(5)
  s_barrier
  s_cmp_lg_u32 s30, 0
  s_cbranch_scc1 pjf_74
  v_mov_b32 v10, s45
  v_mov_b32 v11, s40
  s_mov_b64 exec, 1
  buffer_store_dword v11, v10, s[8:11], 0 offen sc1
  s_mov_b64 exec, -1
pjf_74:
pje_73_d:
  s_add_u32 s40, s40, 1
  s_cmp_lt_u32 s40, 64
  s_cbranch_scc1 L_pj_loopV
s_nop 2
  v_cvt_pk_bf16_f32 v192, v192, v193
  v_cvt_pk_bf16_f32 v193, v194, v195
  v_cvt_pk_bf16_f32 v194, v200, v201
  v_cvt_pk_bf16_f32 v195, v202, v203
  v_cvt_pk_bf16_f32 v196, v196, v197
  v_cvt_pk_bf16_f32 v197, v198, v199
  v_cvt_pk_bf16_f32 v198, v204, v205
  v_cvt_pk_bf16_f32 v199, v206, v207
  s_mov_b32 s47, 63
  s_lshl_b32 s47, s47, 18
  s_add_u32 s47, s47, s44
  buffer_store_dwordx4 v[192:195], v8, s[8:11], s47 offen sc1
  buffer_store_dwordx4 v[196:199], v8, s[8:11], s47 offen offset:512 sc1
  s_branch L_pj_finV
L_pj_fin0V:
s_nop 2
  v_cvt_pk_bf16_f32 v176, v176, v177
  v_cvt_pk_bf16_f32 v177, v178, v179
  v_cvt_pk_bf16_f32 v178, v184, v185
  v_cvt_pk_bf16_f32 v179, v186, v187
  v_cvt_pk_bf16_f32 v180, v180, v181
  v_cvt_pk_bf16_f32 v181, v182, v183
  v_cvt_pk_bf16_f32 v182, v188, v189
  v_cvt_pk_bf16_f32 v183, v190, v191
  s_mov_b32 s47, 63
  s_lshl_b32 s47, s47, 18
  s_add_u32 s47, s47, s44
  buffer_store_dwordx4 v[176:179], v8, s[8:11], s47 offen sc1
  buffer_store_dwordx4 v[180:183], v8, s[8:11], s47 offen offset:512 sc1
L_pj_finV:
  s_waitcnt vmcnt(0)
  s_barrier
  s_cmp_lg_u32 s30, 0
  s_cbranch_scc1 pjf_75
  v_mov_b32 v10, s45
  v_mov_b32 v11, 64
  s_mov_b64 exec, 1
  buffer_store_dword v11, v10, s[8:11], 0 offen sc1
  s_mov_b64 exec, -1
pjf_75:
  s_branch L_end
L_att:
  s_lshl_b32 s34, s41, 3
  s_add_u32 s34, s34, s30
  s_and_b32 s42, s34, 31
  s_lshr_b32 s40, s34, 5
  s_mov_b32 s78, 0x3e0293ee
  s_mov_b32 s79, 0xbe0293ee
  v_lshlrev_b32 v2, 4, v1
  s_lshl_b32 s34, s42, 13
  v_add_u32 v3, s34, v2
  s_mul_i32 s34, s42, 6144
  v_add_u32 v4, s34, v2
  v_cmp_gt_u32 vcc, 32, v1
  v_mov_b32 v10, 0
  v_mov_b32 v11, 0xf149f2ca
  v_cndmask_b32 v136, v10, v11, vcc
  v_mov_b32 v137, v136
  v_mov_b32 v138, v136
  v_mov_b32 v139, v136
  v_lshrrev_b32 v12, 4, v1
  v_lshlrev_b32 v12, 2, v12
  v_and_b32 v13, 15, v1
  v_add_u32 v14, 0, v12
  v_cmp_gt_u32 vcc, v14, v13
s_nop 1
  v_cndmask_b32 v140, v10, v11, vcc
  v_add_u32 v14, 1, v12
  v_cmp_gt_u32 vcc, v14, v13
s_nop 1
  v_cndmask_b32 v141, v10, v11, vcc
  v_add_u32 v14, 2, v12
  v_cmp_gt_u32 vcc, v14, v13
s_nop 1
  v_cndmask_b32 v142, v10, v11, vcc
  v_add_u32 v14, 3, v12
  v_cmp_gt_u32 vcc, v14, v13
s_nop 1
  v_cndmask_b32 v143, v10, v11, vcc
  v_lshlrev_b32 v10, 2, v1
  v_mov_b32 v11, 0
  ds_write_b32 v10, v11 offset:1024
  s_waitcnt lgkmcnt(0)
  s_barrier
  s_cmp_lg_u32 s31, 0
  s_cbranch_scc1 valok_78
  v_lshlrev_b32 v10, 2, v1
  s_mov_b32 s39, 0
val_76:
  buffer_load_dword v11, v10, s[12:15], 0 offen sc1
  s_waitcnt vmcnt(0)
  v_cmp_eq_u32 vcc, 32, v11
s_nop 3
  s_and_b32 s34, vcc_lo, vcc_hi
  s_and_b32 s34, s34, 0x5555
  s_cmp_eq_u32 s34, 0x5555
  s_cbranch_scc0 valg_77_s
  v_readlane_b32 s32, v11, 1
  s_mov_b32 s34, 0
  s_cmp_eq_u32 s34, 0
  s_cbranch_scc1 valg_77
valg_77_s:
  s_mov_b32 s36, 0
  s_mov_b32 s37, 0
  s_mov_b32 s38, 0
  s_mov_b32 s34, 0
  v_readlane_b32 s35, v11, 2
s_nop 3
  s_add_u32 s38, s38, s35
  v_readlane_b32 s35, v11, 0
s_nop 3
  s_add_u32 s36, s36, s35
  s_cmp_eq_u32 s35, 32
  s_cselect_b32 s97, 0, 1
  s_or_b32 s34, s34, s97
  s_cmp_gt_u32 s98, 0
  s_cselect_b32 s35, s35, 0
  s_add_u32 s37, s37, s35
  v_readlane_b32 s35, v11, 6
s_nop 3
  s_add_u32 s38, s38, s35
  v_readlane_b32 s35, v11, 4
s_nop 3
  s_add_u32 s36, s36, s35
  s_cmp_eq_u32 s35, 32
  s_cselect_b32 s97, 0, 1
  s_or_b32 s34, s34, s97
  s_cmp_gt_u32 s98, 1
  s_cselect_b32 s35, s35, 0
  s_add_u32 s37, s37, s35
  v_readlane_b32 s35, v11, 10
s_nop 3
  s_add_u32 s38, s38, s35
  v_readlane_b32 s35, v11, 8
s_nop 3
  s_add_u32 s36, s36, s35
  s_cmp_eq_u32 s35, 32
  s_cselect_b32 s97, 0, 1
  s_or_b32 s34, s34, s97
  s_cmp_gt_u32 s98, 2
  s_cselect_b32 s35, s35, 0
  s_add_u32 s37, s37, s35
  v_readlane_b32 s35, v11, 14
s_nop 3
  s_add_u32 s38, s38, s35
  v_readlane_b32 s35, v11, 12
s_nop 3
  s_add_u32 s36, s36, s35
  s_cmp_eq_u32 s35, 32
  s_cselect_b32 s97, 0, 1
  s_or_b32 s34, s34, s97
  s_cmp_gt_u32 s98, 3
  s_cselect_b32 s35, s35, 0
  s_add_u32 s37, s37, s35
  v_readlane_b32 s35, v11, 34
s_nop 3
  s_add_u32 s38, s38, s35
  v_readlane_b32 s35, v11, 32
s_nop 3
  s_add_u32 s36, s36, s35
  s_cmp_eq_u32 s35, 32
  s_cselect_b32 s97, 0, 1
  s_or_b32 s34, s34, s97
  s_cmp_gt_u32 s98, 4
  s_cselect_b32 s35, s35, 0
  s_add_u32 s37, s37, s35
  v_readlane_b32 s35, v11, 38
s_nop 3
  s_add_u32 s38, s38, s35
  v_readlane_b32 s35, v11, 36
s_nop 3
  s_add_u32 s36, s36, s35
  s_cmp_eq_u32 s35, 32
  s_cselect_b32 s97, 0, 1
  s_or_b32 s34, s34, s97
  s_cmp_gt_u32 s98, 5
  s_cselect_b32 s35, s35, 0
  s_add_u32 s37, s37, s35
  v_readlane_b32 s35, v11, 42
s_nop 3
  s_add_u32 s38, s38, s35
  v_readlane_b32 s35, v11, 40
s_nop 3
  s_add_u32 s36, s36, s35
  s_cmp_eq_u32 s35, 32
  s_cselect_b32 s97, 0, 1
  s_or_b32 s34, s34, s97
  s_cmp_gt_u32 s98, 6
  s_cselect_b32 s35, s35, 0
  s_add_u32 s37, s37, s35
  v_readlane_b32 s35, v11, 46
s_nop 3
  s_add_u32 s38, s38, s35
  v_readlane_b32 s35, v11, 44
s_nop 3
  s_add_u32 s36, s36, s35
  s_cmp_eq_u32 s35, 32
  s_cselect_b32 s97, 0, 1
  s_or_b32 s34, s34, s97
  s_cmp_gt_u32 s98, 7
  s_cselect_b32 s35, s35, 0
  s_add_u32 s37, s37, s35
  v_readlane_b32 s35, v11, 18
s_nop 3
  s_add_u32 s38, s38, s35
  v_readlane_b32 s35, v11, 16
s_nop 3
  s_add_u32 s36, s36, s35
  s_cmp_eq_u32 s35, 0
  s_cselect_b32 s97, 0, 1
  s_or_b32 s34, s34, s97
  s_cmp_gt_u32 s98, 8
  s_cselect_b32 s35, s35, 0
  s_add_u32 s37, s37, s35
  v_readlane_b32 s35, v11, 22
s_nop 3
  s_add_u32 s38, s38, s35
  v_readlane_b32 s35, v11, 20
s_nop 3
  s_add_u32 s36, s36, s35
  s_cmp_eq_u32 s35, 0
  s_cselect_b32 s97, 0, 1
  s_or_b32 s34, s34, s97
  s_cmp_gt_u32 s98, 9
  s_cselect_b32 s35, s35, 0
  s_add_u32 s37, s37, s35
  v_readlane_b32 s35, v11, 26
s_nop 3
  s_add_u32 s38, s38, s35
  v_readlane_b32 s35, v11, 24
s_nop 3
  s_add_u32 s36, s36, s35
  s_cmp_eq_u32 s35, 0
  s_cselect_b32 s97, 0, 1
  s_or_b32 s34, s34, s97
  s_cmp_gt_u32 s98, 10
  s_cselect_b32 s35, s35, 0
  s_add_u32 s37, s37, s35
  v_readlane_b32 s35, v11, 30
s_nop 3
  s_add_u32 s38, s38, s35
  v_readlane_b32 s35, v11, 28
s_nop 3
  s_add_u32 s36, s36, s35
  s_cmp_eq_u32 s35, 0
  s_cselect_b32 s97, 0, 1
  s_or_b32 s34, s34, s97
  s_cmp_gt_u32 s98, 11
  s_cselect_b32 s35, s35, 0
  s_add_u32 s37, s37, s35
  v_readlane_b32 s35, v11, 50
s_nop 3
  s_add_u32 s38, s38, s35
  v_readlane_b32 s35, v11, 48
s_nop 3
  s_add_u32 s36, s36, s35
  s_cmp_eq_u32 s35, 0
  s_cselect_b32 s97, 0, 1
  s_or_b32 s34, s34, s97
  s_cmp_gt_u32 s98, 12
  s_cselect_b32 s35, s35, 0
  s_add_u32 s37, s37, s35
  v_readlane_b32 s35, v11, 54
s_nop 3
  s_add_u32 s38, s38, s35
  v_readlane_b32 s35, v11, 52
s_nop 3
  s_add_u32 s36, s36, s35
  s_cmp_eq_u32 s35, 0
  s_cselect_b32 s97, 0, 1
  s_or_b32 s34, s34, s97
  s_cmp_gt_u32 s98, 13
  s_cselect_b32 s35, s35, 0
  s_add_u32 s37, s37, s35
  v_readlane_b32 s35, v11, 58
s_nop 3
  s_add_u32 s38, s38, s35
  v_readlane_b32 s35, v11, 56
s_nop 3
  s_add_u32 s36, s36, s35
  s_cmp_eq_u32 s35, 0
  s_cselect_b32 s97, 0, 1
  s_or_b32 s34, s34, s97
  s_cmp_gt_u32 s98, 14
  s_cselect_b32 s35, s35, 0
  s_add_u32 s37, s37, s35
  v_readlane_b32 s35, v11, 62
s_nop 3
  s_add_u32 s38, s38, s35
  v_readlane_b32 s35, v11, 60
s_nop 3
  s_add_u32 s36, s36, s35
  s_cmp_eq_u32 s35, 0
  s_cselect_b32 s97, 0, 1
  s_or_b32 s34, s34, s97
  s_cmp_gt_u32 s98, 15
  s_cselect_b32 s35, s35, 0
  s_add_u32 s37, s37, s35
  v_readlane_b32 s32, v11, 1
  s_cmp_eq_u32 s36, 256
  s_cselect_b32 s35, s38, 0
  s_cmp_eq_u32 s35, 256
  s_cbranch_scc1 valg_77
  s_sleep 2
  s_add_u32 s39, s39, 1
  s_cmp_lt_u32 s39, s33
  s_cbranch_scc1 val_76
  s_mov_b32 s33, 0
valg_77:
s_nop 0
  s_and_b32 s32, s32, 2
  s_lshl_b32 s32, s32, 12
  s_cmp_eq_u32 s34, 0
  s_cbranch_scc1 valok_78
  s_mov_b32 s31, 1
  s_mov_b32 s32, 0
  s_add_u32 s37, s37, s99
  s_and_b32 s37, s37, 255
  s_lshr_b32 s28, s37, 5
  s_and_b32 s29, s37, 31
  s_barrier
  s_branch L_dispatch
valok_78:
  s_cmp_lg_u32 s41, 0
  s_cbranch_scc1 L_att_par
  s_mov_b64 exec, 1
  s_mov_b32 s36, -1
  s_mov_b32 s37, -1
  v_mov_b32 v9, -1
  s_mov_b32 s49, 0
L_cal:
  s_and_b32 s48, s49, 3
  s_lshl_b32 s38, s30, 2
  s_add_u32 s48, s48, s38
  s_lshl_b32 s38, s48, 8
  s_add_u32 s38, s38, 0x390000
  v_mov_b32 v8, s38
  buffer_store_dword v9, v8, s[8:11], 0 offen sc1
  s_waitcnt vmcnt(0)
  s_memtime s[44:45]
  s_waitcnt lgkmcnt(0)
  buffer_load_dword v9, v8, s[8:11], 0 offen sc1
  s_waitcnt vmcnt(0)
  s_memtime s[46:47]
  s_waitcnt lgkmcnt(0)
  s_sub_u32 s38, s46, s44
  s_min_u32 s36, s36, s38
  s_lshl_b32 s38, s48, 8
  s_add_u32 s38, s38, 0x392000
  v_mov_b32 v8, s38
  buffer_store_dword v9, v8, s[8:11], 0 offen sc1
  s_waitcnt vmcnt(0)
  s_memtime s[44:45]
  s_waitcnt lgkmcnt(0)
  buffer_load_dword v9, v8, s[8:11], 0 offen sc1
  s_waitcnt vmcnt(0)
  s_memtime s[46:47]
  s_waitcnt lgkmcnt(0)
  s_sub_u32 s38, s46, s44
  s_min_u32 s37, s37, s38
  s_add_u32 s49, s49, 1
  s_cmp_lt_u32 s49, 4
  s_cbranch_scc1 L_cal
  s_sub_u32 s38, s36, s37
  s_sub_u32 s39, s37, s36
  s_max_i32 s38, s38, s39
  s_cmp_ge_u32 s38, 128
  s_cbranch_scc1 L_cal_e
  s_cmp_lt_u32 s49, 8
  s_cbranch_scc1 L_cal
L_cal_e:
  v_mov_b32 v10, s36
  v_mov_b32 v11, s37
  s_lshl_b32 s38, s30, 3
  v_mov_b32 v8, s38
  ds_write_b64 v8, v[10:11]
  s_waitcnt lgkmcnt(0)
  s_mov_b64 exec, -1
  s_barrier
  s_cmp_lg_u32 s30, 0
  s_cbranch_scc1 L_cal_d
  v_lshlrev_b32 v8, 2, v1
  ds_read_b32 v9, v8
  s_waitcnt lgkmcnt(0)
  s_mov_b32 s36, -1
  s_mov_b32 s37, -1
  v_readlane_b32 s38, v9, 0
s_nop 3
  s_min_u32 s36, s36, s38
  v_readlane_b32 s38, v9, 1
s_nop 3
  s_min_u32 s37, s37, s38
  v_readlane_b32 s38, v9, 2
s_nop 3
  s_min_u32 s36, s36, s38
  v_readlane_b32 s38, v9, 3
s_nop 3
  s_min_u32 s37, s37, s38
  v_readlane_b32 s38, v9, 4
s_nop 3
  s_min_u32 s36, s36, s38
  v_readlane_b32 s38, v9, 5
s_nop 3
  s_min_u32 s37, s37, s38
  v_readlane_b32 s38, v9, 6
s_nop 3
  s_min_u32 s36, s36, s38
  v_readlane_b32 s38, v9, 7
s_nop 3
  s_min_u32 s37, s37, s38
  v_readlane_b32 s38, v9, 8
s_nop 3
  s_min_u32 s36, s36, s38
  v_readlane_b32 s38, v9, 9
s_nop 3
  s_min_u32 s37, s37, s38
  v_readlane_b32 s38, v9, 10
s_nop 3
  s_min_u32 s36, s36, s38
  v_readlane_b32 s38, v9, 11
s_nop 3
  s_min_u32 s37, s37, s38
  v_readlane_b32 s38, v9, 12
s_nop 3
  s_min_u32 s36, s36, s38
  v_readlane_b32 s38, v9, 13
s_nop 3
  s_min_u32 s37, s37, s38
  v_readlane_b32 s38, v9, 14
s_nop 3
  s_min_u32 s36, s36, s38
  v_readlane_b32 s38, v9, 15
s_nop 3
  s_min_u32 s37, s37, s38
  s_cmp_lt_u32 s36, s37
  s_cselect_b32 s38, 0, 1
  s_cmp_ge_u32 s98, 4
  s_cselect_b32 s39, 1, 0
  s_xor_b32 s38, s38, s39
  s_add_u32 s38, s38, 1
  v_mov_b32 v9, s38
  v_mov_b32 v8, 4
  s_mov_b64 exec, 1
  buffer_store_dword v9, v8, s[12:15], 0 offen sc1
  s_waitcnt vmcnt(0)
  s_mov_b64 exec, -1
L_cal_d:
L_att_par:
  s_cmp_lg_u32 s31, 0
  s_cbranch_scc1 pwd_80
  s_mov_b32 s39, 0
  v_mov_b32 v13, 4
pw_79:
  buffer_load_dword v12, v13, s[12:15], 0 offen sc1
  s_waitcnt vmcnt(0)
  v_readfirstlane_b32 s32, v12
s_nop 3
  s_cmp_lg_u32 s32, 0
  s_cbranch_scc1 pw_79_g
  s_sleep 2
  s_add_u32 s39, s39, 1
  s_cmp_lt_u32 s39, s33
  s_cbranch_scc1 pw_79
  s_mov_b32 s33, 0
pw_79_g:
  s_and_b32 s32, s32, 2
  s_lshl_b32 s32, s32, 12
pwd_80:
  s_xor_b32 s100, s32, 8192
  s_add_u32 s101, s100, 3817472
  s_add_u32 s100, s100, 3801088
  s_lshr_b32 s34, s42, 1
  v_lshlrev_b32 v5, 4, v1
  v_add_u32 v5, s34, v5
  v_lshlrev_b32 v5, 7, v5
  v_add_u32 v5, 32768, v5
  v_add_u32 v5, s100, v5
  s_lshl_b32 s34, s42, 7
  s_add_u32 s34, s34, 4096
  s_add_u32 s34, s34, s100
  v_mov_b32 v6, s34
L_att_warm:
L_att_task:
  s_add_u32 s45, s40, 1
  s_mov_b32 s39, 0
  s_mov_b64 s[70:71], exec
  s_mov_b32 exec_lo, 0x7
  s_mov_b32 exec_hi, 0x0
atw_81:
  buffer_load_dword v13, v5, s[8:11], 0 offen sc1
  s_waitcnt vmcnt(0)
  v_cmp_gt_u32 vcc, s45, v13
  s_cbranch_vccz atwd_82
  s_sleep 8
  s_add_u32 s39, s39, 1
  s_cmp_lt_u32 s39, s33
  s_cbranch_scc1 atw_81
  s_mov_b32 s33, 0
atwd_82:
  s_mov_b64 exec, s[70:71]
  s_lshl_b32 s34, s40, 18
  s_add_u32 s35, s34, 50331648
  s_add_u32 s36, s34, 16777216
  s_add_u32 s37, s34, 33554432
  buffer_load_dwordx4 v[16:19], v3, s[8:11], s35 offen offset:0 sc1
  buffer_load_dwordx4 v[20:23], v3, s[8:11], s35 offen offset:1024 sc1
  buffer_load_dwordx4 v[24:27], v3, s[8:11], s35 offen offset:2048 sc1
  buffer_load_dwordx4 v[28:31], v3, s[8:11], s35 offen offset:3072 sc1
  s_add_u32 s35, s35, 4096
  buffer_load_dwordx4 v[32:35], v3, s[8:11], s35 offen offset:0 sc1
  buffer_load_dwordx4 v[36:39], v3, s[8:11], s35 offen offset:1024 sc1
  buffer_load_dwordx4 v[40:43], v3, s[8:11], s35 offen offset:2048 sc1
  buffer_load_dwordx4 v[44:47], v3, s[8:11], s35 offen offset:3072 sc1
  buffer_load_dwordx4 v[48:51], v3, s[8:11], s36 offen offset:0 sc1
  buffer_load_dwordx4 v[52:55], v3, s[8:11], s36 offen offset:1024 sc1
  buffer_load_dwordx4 v[56:59], v3, s[8:11], s36 offen offset:2048 sc1
  buffer_load_dwordx4 v[60:63], v3, s[8:11], s36 offen offset:3072 sc1
  s_add_u32 s36, s36, 4096
  buffer_load_dwordx4 v[64:67], v3, s[8:11], s36 offen offset:0 sc1
  buffer_load_dwordx4 v[68:71], v3, s[8:11], s36 offen offset:1024 sc1
  buffer_load_dwordx4 v[72:75], v3, s[8:11], s36 offen offset:2048 sc1
  buffer_load_dwordx4 v[76:79], v3, s[8:11], s36 offen offset:3072 sc1
  buffer_load_dwordx4 v[80:83], v3, s[8:11], s37 offen offset:0 sc1
  buffer_load_dwordx4 v[84:87], v3, s[8:11], s37 offen offset:1024 sc1
  buffer_load_dwordx4 v[88:91], v3, s[8:11], s37 offen offset:2048 sc1
  buffer_load_dwordx4 v[92:95], v3, s[8:11], s37 offen offset:3072 sc1
  s_add_u32 s37, s37, 4096
  buffer_load_dwordx4 v[96:99], v3, s[8:11], s37 offen offset:0 sc1
  buffer_load_dwordx4 v[100:103], v3, s[8:11], s37 offen offset:1024 sc1
  buffer_load_dwordx4 v[104:107], v3, s[8:11], s37 offen offset:2048 sc1
  buffer_load_dwordx4 v[108:111], v3, s[8:11], s37 offen offset:3072 sc1
  s_mov_b32 s39, 0
  s_mov_b64 s[70:71], exec
  s_mov_b32 exec_lo, 0x1
  s_mov_b32 exec_hi, 0x0
atm_83:
  buffer_load_dword v13, v6, s[8:11], 0 offen sc1
  s_waitcnt vmcnt(0)
  v_cmp_gt_u32 vcc, s45, v13
  s_cbranch_vccz atmd_84
  s_sleep 2
  s_add_u32 s39, s39, 1
  s_cmp_lt_u32 s39, s33
  s_cbranch_scc1 atm_83
  s_mov_b32 s33, 0
atmd_84:
  s_mov_b64 exec, s[70:71]
  s_mul_i32 s38, s40, 196608
  s_add_u32 s38, s38, 83886080
  buffer_load_dwordx4 v[112:115], v4, s[8:11], s38 offen offset:0 sc1
  buffer_load_dwordx4 v[116:119], v4, s[8:11], s38 offen offset:1024 sc1
  buffer_load_dwordx4 v[120:123], v4, s[8:11], s38 offen offset:2048 sc1
  buffer_load_dwordx4 v[124:127], v4, s[8:11], s38 offen offset:3072 sc1
  s_add_u32 s38, s38, 4096
  buffer_load_dwordx4 v[128:131], v4, s[8:11], s38 offen offset:0 sc1
  buffer_load_dwordx4 v[132:135], v4, s[8:11], s38 offen offset:1024 sc1
  s_lshl_b32 s44, s40, 18
  s_add_u32 s44, s44, 67108864
  s_waitcnt vmcnt(2)
  v_mfma_f32_16x16x32_bf16 v[144:147], v[48:51], v[16:19], v[140:143]
  v_mfma_f32_16x16x32_bf16 v[152:155], v[112:115], v[16:19], v[136:139]
  v_mfma_f32_16x16x32_bf16 v[144:147], v[52:55], v[20:23], v[144:147]
  v_mfma_f32_16x16x32_bf16 v[152:155], v[116:119], v[20:23], v[152:155]
  v_mfma_f32_16x16x32_bf16 v[144:147], v[56:59], v[24:27], v[144:147]
  v_mfma_f32_16x16x32_bf16 v[152:155], v[120:123], v[24:27], v[152:155]
  v_mfma_f32_16x16x32_bf16 v[144:147], v[60:63], v[28:31], v[144:147]
  v_mfma_f32_16x16x32_bf16 v[152:155], v[124:127], v[28:31], v[152:155]
s_nop 6
  v_max3_f32 v200, v144, v145, v146
  v_max3_f32 v200, v200, v147, v152
  v_max3_f32 v200, v200, v153, v154
  v_max_f32 v200, v200, v155
  v_mov_b32 v201, v200
s_nop 1
  v_permlane16_swap_b32 v200, v201
  v_max_f32 v200, v200, v201
  v_mov_b32 v201, v200
s_nop 1
  v_permlane32_swap_b32 v200, v201
  v_max_f32 v200, v200, v201
  v_mul_f32 v200, s79, v200
  v_fma_f32 v144, v144, s78, v200
  v_fma_f32 v145, v145, s78, v200
  v_fma_f32 v146, v146, s78, v200
  v_fma_f32 v147, v147, s78, v200
  v_fma_f32 v152, v152, s78, v200
  v_fma_f32 v153, v153, s78, v200
  v_fma_f32 v154, v154, s78, v200
  v_fma_f32 v155, v155, s78, v200
  v_exp_f32 v144, v144
  v_exp_f32 v145, v145
  v_exp_f32 v146, v146
  v_exp_f32 v147, v147
  v_exp_f32 v152, v152
  v_exp_f32 v153, v153
  v_exp_f32 v154, v154
  v_exp_f32 v155, v155
  v_add_f32 v200, v144, v145
  v_add_f32 v200, v200, v146
  v_add_f32 v200, v200, v147
  v_add_f32 v200, v200, v152
  v_add_f32 v200, v200, v153
  v_add_f32 v200, v200, v154
  v_add_f32 v200, v200, v155
  v_mov_b32 v201, v200
s_nop 1
  v_permlane16_swap_b32 v200, v201
  v_add_f32 v200, v200, v201
  v_mov_b32 v201, v200
s_nop 1
  v_permlane32_swap_b32 v200, v201
  v_add_f32 v200, v200, v201
  v_rcp_f32 v200, v200
s_nop 0
  v_mul_f32 v144, v144, v200
  v_mul_f32 v145, v145, v200
  v_mul_f32 v146, v146, v200
  v_mul_f32 v147, v147, v200
  v_mul_f32 v152, v152, v200
  v_mul_f32 v153, v153, v200
  v_mul_f32 v154, v154, v200
  v_mul_f32 v155, v155, v200
  v_cvt_pk_bf16_f32 v156, v144, v145
  v_cvt_pk_bf16_f32 v157, v146, v147
  v_mov_b32 v158, 0
  v_mov_b32 v159, 0
  v_cvt_pk_bf16_f32 v160, v152, v154
  v_cvt_pk_bf16_f32 v161, v153, v155
  v_mov_b32 v202, v160
  v_mov_b32 v203, v161
  v_mov_b32 v162, 0
  v_mov_b32 v163, 0
s_nop 0
  v_permlane32_swap_b32 v202, v162
  v_permlane32_swap_b32 v203, v163
  s_waitcnt vmcnt(0)
  v_mfma_f32_16x16x32_bf16 v[168:171], v[80:83], v[156:159], 0
  v_mfma_f32_16x16x32_bf16 v[172:175], v[84:87], v[156:159], 0
  v_mfma_f32_16x16x32_bf16 v[176:179], v[88:91], v[156:159], 0
  v_mfma_f32_16x16x32_bf16 v[180:183], v[92:95], v[156:159], 0
  v_mfma_f32_16x16x32_bf16 v[184:187], v[96:99], v[156:159], 0
  v_mfma_f32_16x16x32_bf16 v[188:191], v[100:103], v[156:159], 0
  v_mfma_f32_16x16x32_bf16 v[192:195], v[104:107], v[156:159], 0
  v_mfma_f32_16x16x32_bf16 v[196:199], v[108:111], v[156:159], 0
  v_mfma_f32_16x16x16_bf16 v[168:171], v[128:129], v[160:161], v[168:171]
  v_mfma_f32_16x16x16_bf16 v[172:175], v[128:129], v[162:163], v[172:175]
  v_mfma_f32_16x16x16_bf16 v[176:179], v[130:131], v[160:161], v[176:179]
  v_mfma_f32_16x16x16_bf16 v[180:183], v[130:131], v[162:163], v[180:183]
  v_mfma_f32_16x16x16_bf16 v[184:187], v[132:133], v[160:161], v[184:187]
  v_mfma_f32_16x16x16_bf16 v[188:191], v[132:133], v[162:163], v[188:191]
  v_mfma_f32_16x16x16_bf16 v[192:195], v[134:135], v[160:161], v[192:195]
  v_mfma_f32_16x16x16_bf16 v[196:199], v[134:135], v[162:163], v[196:199]
s_nop 0
  v_cvt_pk_bf16_f32 v204, v168, v169
  v_cvt_pk_bf16_f32 v205, v170, v171
  v_cvt_pk_bf16_f32 v206, v172, v173
  v_cvt_pk_bf16_f32 v207, v174, v175
  buffer_store_dwordx4 v[204:207], v3, s[8:11], s44 offen offset:0 sc1
  v_cvt_pk_bf16_f32 v208, v176, v177
  v_cvt_pk_bf16_f32 v209, v178, v179
  v_cvt_pk_bf16_f32 v210, v180, v181
  v_cvt_pk_bf16_f32 v211, v182, v183
  buffer_store_dwordx4 v[208:211], v3, s[8:11], s44 offen offset:1024 sc1
  v_cvt_pk_bf16_f32 v212, v184, v185
  v_cvt_pk_bf16_f32 v213, v186, v187
  v_cvt_pk_bf16_f32 v214, v188, v189
  v_cvt_pk_bf16_f32 v215, v190, v191
  buffer_store_dwordx4 v[212:215], v3, s[8:11], s44 offen offset:2048 sc1
  v_cvt_pk_bf16_f32 v216, v192, v193
  v_cvt_pk_bf16_f32 v217, v194, v195
  v_cvt_pk_bf16_f32 v218, v196, v197
  v_cvt_pk_bf16_f32 v219, v198, v199
  buffer_store_dwordx4 v[216:219], v3, s[8:11], s44 offen offset:3072 sc1
  s_add_u32 s44, s44, 4096
  v_mfma_f32_16x16x32_bf16 v[144:147], v[48:51], v[32:35], 0
  v_mfma_f32_16x16x32_bf16 v[148:151], v[64:67], v[32:35], v[140:143]
  v_mfma_f32_16x16x32_bf16 v[152:155], v[112:115], v[32:35], v[136:139]
  v_mfma_f32_16x16x32_bf16 v[144:147], v[52:55], v[36:39], v[144:147]
  v_mfma_f32_16x16x32_bf16 v[148:151], v[68:71], v[36:39], v[148:151]
  v_mfma_f32_16x16x32_bf16 v[152:155], v[116:119], v[36:39], v[152:155]
  v_mfma_f32_16x16x32_bf16 v[144:147], v[56:59], v[40:43], v[144:147]
  v_mfma_f32_16x16x32_bf16 v[148:151], v[72:75], v[40:43], v[148:151]
  v_mfma_f32_16x16x32_bf16 v[152:155], v[120:123], v[40:43], v[152:155]
  v_mfma_f32_16x16x32_bf16 v[144:147], v[60:63], v[44:47], v[144:147]
  v_mfma_f32_16x16x32_bf16 v[148:151], v[76:79], v[44:47], v[148:151]
  v_mfma_f32_16x16x32_bf16 v[152:155], v[124:127], v[44:47], v[152:155]
s_nop 5
  v_max3_f32 v200, v144, v145, v146
  v_max3_f32 v200, v200, v147, v148
  v_max3_f32 v200, v200, v149, v150
  v_max3_f32 v200, v200, v151, v152
  v_max3_f32 v200, v200, v153, v154
  v_max_f32 v200, v200, v155
  v_mov_b32 v201, v200
s_nop 1
  v_permlane16_swap_b32 v200, v201
  v_max_f32 v200, v200, v201
  v_mov_b32 v201, v200
s_nop 1
  v_permlane32_swap_b32 v200, v201
  v_max_f32 v200, v200, v201
  v_mul_f32 v200, s79, v200
  v_fma_f32 v144, v144, s78, v200
  v_fma_f32 v145, v145, s78, v200
  v_fma_f32 v146, v146, s78, v200
  v_fma_f32 v147, v147, s78, v200
  v_fma_f32 v148, v148, s78, v200
  v_fma_f32 v149, v149, s78, v200
  v_fma_f32 v150, v150, s78, v200
  v_fma_f32 v151, v151, s78, v200
  v_fma_f32 v152, v152, s78, v200
  v_fma_f32 v153, v153, s78, v200
  v_fma_f32 v154, v154, s78, v200
  v_fma_f32 v155, v155, s78, v200
  v_exp_f32 v144, v144
  v_exp_f32 v145, v145
  v_exp_f32 v146, v146
  v_exp_f32 v147, v147
  v_exp_f32 v148, v148
  v_exp_f32 v149, v149
  v_exp_f32 v150, v150
  v_exp_f32 v151, v151
  v_exp_f32 v152, v152
  v_exp_f32 v153, v153
  v_exp_f32 v154, v154
  v_exp_f32 v155, v155
  v_add_f32 v200, v144, v145
  v_add_f32 v200, v200, v146
  v_add_f32 v200, v200, v147
  v_add_f32 v200, v200, v148
  v_add_f32 v200, v200, v149
  v_add_f32 v200, v200, v150
  v_add_f32 v200, v200, v151
  v_add_f32 v200, v200, v152
  v_add_f32 v200, v200, v153
  v_add_f32 v200, v200, v154
  v_add_f32 v200, v200, v155
  v_mov_b32 v201, v200
s_nop 1
  v_permlane16_swap_b32 v200, v201
  v_add_f32 v200, v200, v201
  v_mov_b32 v201, v200
s_nop 1
  v_permlane32_swap_b32 v200, v201
  v_add_f32 v200, v200, v201
  v_rcp_f32 v200, v200
s_nop 0
  v_mul_f32 v144, v144, v200
  v_mul_f32 v145, v145, v200
  v_mul_f32 v146, v146, v200
  v_mul_f32 v147, v147, v200
  v_mul_f32 v148, v148, v200
  v_mul_f32 v149, v149, v200
  v_mul_f32 v150, v150, v200
  v_mul_f32 v151, v151, v200
  v_mul_f32 v152, v152, v200
  v_mul_f32 v153, v153, v200
  v_mul_f32 v154, v154, v200
  v_mul_f32 v155, v155, v200
  v_cvt_pk_bf16_f32 v156, v144, v145
  v_cvt_pk_bf16_f32 v157, v146, v147
  v_cvt_pk_bf16_f32 v158, v148, v149
  v_cvt_pk_bf16_f32 v159, v150, v151
  v_cvt_pk_bf16_f32 v160, v152, v154
  v_cvt_pk_bf16_f32 v161, v153, v155
  v_mov_b32 v202, v160
  v_mov_b32 v203, v161
  v_mov_b32 v162, 0
  v_mov_b32 v163, 0
s_nop 0
  v_permlane32_swap_b32 v202, v162
  v_permlane32_swap_b32 v203, v163
  v_mfma_f32_16x16x32_bf16 v[168:171], v[80:83], v[156:159], 0
  v_mfma_f32_16x16x32_bf16 v[172:175], v[84:87], v[156:159], 0
  v_mfma_f32_16x16x32_bf16 v[176:179], v[88:91], v[156:159], 0
  v_mfma_f32_16x16x32_bf16 v[180:183], v[92:95], v[156:159], 0
  v_mfma_f32_16x16x32_bf16 v[184:187], v[96:99], v[156:159], 0
  v_mfma_f32_16x16x32_bf16 v[188:191], v[100:103], v[156:159], 0
  v_mfma_f32_16x16x32_bf16 v[192:195], v[104:107], v[156:159], 0
  v_mfma_f32_16x16x32_bf16 v[196:199], v[108:111], v[156:159], 0
  v_mfma_f32_16x16x16_bf16 v[168:171], v[128:129], v[160:161], v[168:171]
  v_mfma_f32_16x16x16_bf16 v[172:175], v[128:129], v[162:163], v[172:175]
  v_mfma_f32_16x16x16_bf16 v[176:179], v[130:131], v[160:161], v[176:179]
  v_mfma_f32_16x16x16_bf16 v[180:183], v[130:131], v[162:163], v[180:183]
  v_mfma_f32_16x16x16_bf16 v[184:187], v[132:133], v[160:161], v[184:187]
  v_mfma_f32_16x16x16_bf16 v[188:191], v[132:133], v[162:163], v[188:191]
  v_mfma_f32_16x16x16_bf16 v[192:195], v[134:135], v[160:161], v[192:195]
  v_mfma_f32_16x16x16_bf16 v[196:199], v[134:135], v[162:163], v[196:199]
s_nop 0
  v_cvt_pk_bf16_f32 v204, v168, v169
  v_cvt_pk_bf16_f32 v205, v170, v171
  v_cvt_pk_bf16_f32 v206, v172, v173
  v_cvt_pk_bf16_f32 v207, v174, v175
  buffer_store_dwordx4 v[204:207], v3, s[8:11], s44 offen offset:0 sc1
  v_cvt_pk_bf16_f32 v208, v176, v177
  v_cvt_pk_bf16_f32 v209, v178, v179
  v_cvt_pk_bf16_f32 v210, v180, v181
  v_cvt_pk_bf16_f32 v211, v182, v183
  buffer_store_dwordx4 v[208:211], v3, s[8:11], s44 offen offset:1024 sc1
  v_cvt_pk_bf16_f32 v212, v184, v185
  v_cvt_pk_bf16_f32 v213, v186, v187
  v_cvt_pk_bf16_f32 v214, v188, v189
  v_cvt_pk_bf16_f32 v215, v190, v191
  buffer_store_dwordx4 v[212:215], v3, s[8:11], s44 offen offset:2048 sc1
  v_cvt_pk_bf16_f32 v216, v192, v193
  v_cvt_pk_bf16_f32 v217, v194, v195
  v_cvt_pk_bf16_f32 v218, v196, v197
  v_cvt_pk_bf16_f32 v219, v198, v199
  buffer_store_dwordx4 v[216:219], v3, s[8:11], s44 offen offset:3072 sc1
  s_add_u32 s44, s44, 4096
  s_waitcnt vmcnt(0)
  s_lshl_b32 s34, s40, 2
  s_add_u32 s34, s34, 1024
  v_mov_b32 v10, s34
  v_mov_b32 v11, 1
  s_mov_b64 exec, 1
  ds_add_rtn_u32 v11, v10, v11
  s_waitcnt lgkmcnt(0)
  v_readfirstlane_b32 s35, v11
s_nop 3
  s_cmp_lg_u32 s35, 7
  s_cbranch_scc1 L_att_nf
  s_lshl_b32 s34, s40, 7
  s_lshr_b32 s35, s42, 3
  s_lshl_b32 s35, s35, 2
  s_add_u32 s34, s34, s35
  s_add_u32 s34, s34, s101
  v_mov_b32 v10, s34
  v_mov_b32 v11, 1
  buffer_store_dword v11, v10, s[8:11], 0 offen sc1
L_att_nf:
  s_mov_b64 exec, -1
  s_add_u32 s40, s40, 2
  s_cmp_lt_u32 s40, 64
  s_cbranch_scc1 L_att_task
  s_branch L_end
L_out:
  s_cmp_ge_u32 s41, 32
  s_cbranch_scc1 L_o_nomini
  s_add_u32 s44, s41, 32
  s_lshr_b32 s42, s44, 1
  s_and_b32 s43, s44, 1
  s_add_u32 s43, s43, 1
  s_lshl_b32 s34, s43, 3
  s_add_u32 s34, s34, 16
  s_load_dwordx2 s[4:5], s[0:1], s34
  s_load_dwordx2 s[6:7], s[0:1], 0
  s_waitcnt lgkmcnt(0)
  s_mov_b32 s16, s4
  s_and_b32 s17, s5, 0xffff
  s_mov_b32 s18, 0x500000
  s_mov_b32 s19, 0x20000
  s_mov_b32 s20, s6
  s_and_b32 s21, s7, 0xffff
  s_mov_b32 s22, 0x280000
  s_mov_b32 s23, 0x20000
  v_lshlrev_b32 v2, 4, v0
  s_mov_b32 s34, 0
  buffer_load_dwordx4 v[136:139], v2, s[20:23], s34 offen
  s_mov_b32 s34, 8192
  buffer_load_dwordx4 v[140:143], v2, s[20:23], s34 offen
  s_mov_b32 s34, 16384
  buffer_load_dwordx4 v[144:147], v2, s[20:23], s34 offen
  s_mov_b32 s34, 24576
  buffer_load_dwordx4 v[148:151], v2, s[20:23], s34 offen
  s_mov_b32 s34, 32768
  buffer_load_dwordx4 v[152:155], v2, s[20:23], s34 offen
  v_lshrrev_b32 v10, 4, v0
  v_and_b32 v11, 15, v0
  v_lshlrev_b32 v12, 13, v10
  v_lshl_add_u32 v12, v11, 4, v12
  s_lshl_b32 s34, s42, 8
  v_add_u32 v12, s34, v12
  s_mov_b32 s34, 0
  buffer_load_dwordx4 v[176:179], v12, s[16:19], s34 offen
  s_mov_b32 s34, 262144
  buffer_load_dwordx4 v[180:183], v12, s[16:19], s34 offen
  s_mov_b32 s34, 524288
  buffer_load_dwordx4 v[184:187], v12, s[16:19], s34 offen
  s_mov_b32 s34, 786432
  buffer_load_dwordx4 v[188:191], v12, s[16:19], s34 offen
  s_mov_b32 s34, 1048576
  buffer_load_dwordx4 v[192:195], v12, s[16:19], s34 offen
  s_mov_b32 s34, 1310720
  buffer_load_dwordx4 v[196:199], v12, s[16:19], s34 offen
  s_mov_b32 s34, 1572864
  buffer_load_dwordx4 v[200:203], v12, s[16:19], s34 offen
  s_mov_b32 s34, 1835008
  buffer_load_dwordx4 v[204:207], v12, s[16:19], s34 offen
  s_mov_b32 s34, 2097152
  buffer_load_dwordx4 v[208:211], v12, s[16:19], s34 offen
  s_mov_b32 s34, 2359296
  buffer_load_dwordx4 v[212:215], v12, s[16:19], s34 offen
  s_mov_b32 s34, 2621440
  buffer_load_dwordx4 v[216:219], v12, s[16:19], s34 offen
  s_mov_b32 s34, 2883584
  buffer_load_dwordx4 v[220:223], v12, s[16:19], s34 offen
  s_mov_b32 s34, 3145728
  buffer_load_dwordx4 v[224:227], v12, s[16:19], s34 offen
  s_mov_b32 s34, 3407872
  buffer_load_dwordx4 v[228:231], v12, s[16:19], s34 offen
  s_mov_b32 s34, 3670016
  buffer_load_dwordx4 v[232:235], v12, s[16:19], s34 offen
  s_mov_b32 s34, 3932160
  buffer_load_dwordx4 v[236:239], v12, s[16:19], s34 offen
  s_mov_b32 s34, 4194304
  buffer_load_dwordx4 v[240:243], v12, s[16:19], s34 offen
  s_mov_b32 s34, 4456448
  buffer_load_dwordx4 v[244:247], v12, s[16:19], s34 offen
  s_mov_b32 s34, 4718592
  buffer_load_dwordx4 v[248:251], v12, s[16:19], s34 offen
  s_mov_b32 s34, 4980736
  buffer_load_dwordx4 v[252:255], v12, s[16:19], s34 offen
  s_mov_b32 s34, 40960
  buffer_load_dwordx4 v[156:159], v2, s[20:23], s34 offen
  s_mov_b32 s34, 49152
  buffer_load_dwordx4 v[160:163], v2, s[20:23], s34 offen
  s_mov_b32 s34, 57344
  buffer_load_dwordx4 v[164:167], v2, s[20:23], s34 offen
  s_mov_b32 s34, 65536
  buffer_load_dwordx4 v[168:171], v2, s[20:23], s34 offen
  s_mov_b32 s34, 73728
  buffer_load_dwordx4 v[172:175], v2, s[20:23], s34 offen
  v_and_b32 v13, 3, v10
  v_lshlrev_b32 v13, 1, v13
  v_bfe_u32 v14, v10, 3, 1
  v_add_u32 v13, v13, v14
  v_lshrrev_b32 v14, 1, v11
  v_add_u32 v13, v13, v14
  v_and_b32 v13, 7, v13
  v_lshlrev_b32 v13, 5, v13
  v_and_b32 v14, 1, v11
  v_lshl_add_u32 v13, v14, 4, v13
  v_lshl_add_u32 v13, v10, 8, v13
  v_add_u32 v13, 83968, v13
  v_lshrrev_b32 v10, 4, v1
  v_lshrrev_b32 v11, 1, v10
  v_and_b32 v10, 1, v10
  v_bfe_u32 v14, v1, 2, 2
  v_lshl_add_u32 v12, v11, 3, v14
  v_lshlrev_b32 v12, 8, v12
  v_lshl_add_u32 v10, v14, 1, v10
  v_add_u32 v10, v10, v11
  s_and_b32 s34, s30, 3
  s_lshl_b32 s34, s34, 1
  v_add_u32 v10, s34, v10
  v_and_b32 v10, 7, v10
  v_lshl_add_u32 v14, v10, 5, v12
  v_and_b32 v10, 3, v1
  v_lshl_add_u32 v14, v10, 3, v14
  v_add_u32 v14, 83968, v14
  v_and_b32 v10, 31, v1
  v_mul_u32_u24 v10, 1296, v10
  v_lshrrev_b32 v11, 5, v1
  v_lshl_add_u32 v3, v11, 4, v10
  s_waitcnt vmcnt(25)
  v_add_u32 v10, 0, v0
  v_mul_u32_u24 v11, 52429, v10
  v_lshrrev_b32 v11, 22, v11
  v_add_u32 v11, v11, v10
  v_lshlrev_b32 v11, 4, v11
  ds_write_b128 v11, v[136:139] offset:0
  v_add_u32 v10, 512, v0
  v_mul_u32_u24 v11, 52429, v10
  v_lshrrev_b32 v11, 22, v11
  v_add_u32 v11, v11, v10
  v_lshlrev_b32 v11, 4, v11
  ds_write_b128 v11, v[140:143] offset:0
  v_add_u32 v10, 1024, v0
  v_mul_u32_u24 v11, 52429, v10
  v_lshrrev_b32 v11, 22, v11
  v_add_u32 v11, v11, v10
  v_lshlrev_b32 v11, 4, v11
  ds_write_b128 v11, v[144:147] offset:0
  v_add_u32 v10, 1536, v0
  v_mul_u32_u24 v11, 52429, v10
  v_lshrrev_b32 v11, 22, v11
  v_add_u32 v11, v11, v10
  v_lshlrev_b32 v11, 4, v11
  ds_write_b128 v11, v[148:151] offset:0
  v_add_u32 v10, 2048, v0
  v_mul_u32_u24 v11, 52429, v10
  v_lshrrev_b32 v11, 22, v11
  v_add_u32 v11, v11, v10
  v_lshlrev_b32 v11, 4, v11
  ds_write_b128 v11, v[152:155] offset:0
  s_waitcnt vmcnt(21)
  ds_write_b128 v13, v[176:179] offset:0
  ds_write_b128 v13, v[180:183] offset:8192
  ds_write_b128 v13, v[184:187] offset:16384
  ds_write_b128 v13, v[188:191] offset:24576
  s_waitcnt lgkmcnt(0)
  s_barrier
  ds_read_b64_tr_b16 v[16:17], v14 offset:0
  ds_read_b64_tr_b16 v[18:19], v14 offset:1024
  ds_read_b64_tr_b16 v[20:21], v14 offset:4096
  ds_read_b64_tr_b16 v[22:23], v14 offset:5120
  ds_read_b64_tr_b16 v[24:25], v14 offset:8192
  ds_read_b64_tr_b16 v[26:27], v14 offset:9216
  ds_read_b64_tr_b16 v[28:29], v14 offset:12288
  ds_read_b64_tr_b16 v[30:31], v14 offset:13312
  s_waitcnt lgkmcnt(0)
  ds_read_b64_tr_b16 v[32:33], v14 offset:16384
  ds_read_b64_tr_b16 v[34:35], v14 offset:17408
  ds_read_b64_tr_b16 v[36:37], v14 offset:20480
  ds_read_b64_tr_b16 v[38:39], v14 offset:21504
  ds_read_b64_tr_b16 v[40:41], v14 offset:24576
  ds_read_b64_tr_b16 v[42:43], v14 offset:25600
  ds_read_b64_tr_b16 v[44:45], v14 offset:28672
  ds_read_b64_tr_b16 v[46:47], v14 offset:29696
  s_waitcnt lgkmcnt(0)
  s_waitcnt lgkmcnt(0)
  s_cmp_ge_u32 s30, 4
  s_cbranch_scc1 mpi_85
  ds_read_b128 v[4:7], v3 offset:0
  ds_read_b128 v[8:11], v3 offset:32
  s_waitcnt lgkmcnt(0)
  s_cmp_eq_u32 s43, 2
  s_cbranch_scc1 mpv_86
  v_mfma_f32_32x32x16_bf16 v[176:191], v[16:19], v[4:7], 0
  v_mfma_f32_32x32x16_bf16 v[176:191], v[20:23], v[8:11], v[176:191]
  s_branch mpd_87
mpv_86:
  v_mfma_f32_32x32x16_bf16 v[176:191], v[4:7], v[16:19], 0
  v_mfma_f32_32x32x16_bf16 v[176:191], v[8:11], v[20:23], v[176:191]
mpd_87:
  ds_read_b128 v[4:7], v3 offset:64
  ds_read_b128 v[8:11], v3 offset:96
  s_waitcnt lgkmcnt(0)
  s_cmp_eq_u32 s43, 2
  s_cbranch_scc1 mpv_88
  v_mfma_f32_32x32x16_bf16 v[176:191], v[24:27], v[4:7], v[176:191]
  v_mfma_f32_32x32x16_bf16 v[176:191], v[28:31], v[8:11], v[176:191]
  s_branch mpd_89
mpv_88:
  v_mfma_f32_32x32x16_bf16 v[176:191], v[4:7], v[24:27], v[176:191]
  v_mfma_f32_32x32x16_bf16 v[176:191], v[8:11], v[28:31], v[176:191]
mpd_89:
  ds_read_b128 v[4:7], v3 offset:128
  ds_read_b128 v[8:11], v3 offset:160
  s_waitcnt lgkmcnt(0)
  s_cmp_eq_u32 s43, 2
  s_cbranch_scc1 mpv_90
  v_mfma_f32_32x32x16_bf16 v[176:191], v[32:35], v[4:7], v[176:191]
  v_mfma_f32_32x32x16_bf16 v[176:191], v[36:39], v[8:11], v[176:191]
  s_branch mpd_91
mpv_90:
  v_mfma_f32_32x32x16_bf16 v[176:191], v[4:7], v[32:35], v[176:191]
  v_mfma_f32_32x32x16_bf16 v[176:191], v[8:11], v[36:39], v[176:191]
mpd_91:
  ds_read_b128 v[4:7], v3 offset:192
  ds_read_b128 v[8:11], v3 offset:224
  s_waitcnt lgkmcnt(0)
  s_cmp_eq_u32 s43, 2
  s_cbranch_scc1 mpv_92
  v_mfma_f32_32x32x16_bf16 v[176:191], v[40:43], v[4:7], v[176:191]
  v_mfma_f32_32x32x16_bf16 v[176:191], v[44:47], v[8:11], v[176:191]
  s_branch mpd_93
mpv_92:
  v_mfma_f32_32x32x16_bf16 v[176:191], v[4:7], v[40:43], v[176:191]
  v_mfma_f32_32x32x16_bf16 v[176:191], v[8:11], v[44:47], v[176:191]
mpd_93:
mpi_85:
  s_waitcnt vmcnt(17)
  ds_write_b128 v13, v[192:195] offset:32768
  ds_write_b128 v13, v[196:199] offset:40960
  ds_write_b128 v13, v[200:203] offset:49152
  ds_write_b128 v13, v[204:207] offset:57344
  s_waitcnt lgkmcnt(0)
  s_barrier
  ds_read_b64_tr_b16 v[48:49], v14 offset:32768
  ds_read_b64_tr_b16 v[50:51], v14 offset:33792
  ds_read_b64_tr_b16 v[52:53], v14 offset:36864
  ds_read_b64_tr_b16 v[54:55], v14 offset:37888
  ds_read_b64_tr_b16 v[56:57], v14 offset:40960
  ds_read_b64_tr_b16 v[58:59], v14 offset:41984
  ds_read_b64_tr_b16 v[60:61], v14 offset:45056
  ds_read_b64_tr_b16 v[62:63], v14 offset:46080
  s_waitcnt lgkmcnt(0)
  ds_read_b64_tr_b16 v[64:65], v14 offset:49152
  ds_read_b64_tr_b16 v[66:67], v14 offset:50176
  ds_read_b64_tr_b16 v[68:69], v14 offset:53248
  ds_read_b64_tr_b16 v[70:71], v14 offset:54272
  ds_read_b64_tr_b16 v[72:73], v14 offset:57344
  ds_read_b64_tr_b16 v[74:75], v14 offset:58368
  ds_read_b64_tr_b16 v[76:77], v14 offset:61440
  ds_read_b64_tr_b16 v[78:79], v14 offset:62464
  s_waitcnt lgkmcnt(0)
  s_waitcnt lgkmcnt(0)
  s_cmp_ge_u32 s30, 4
  s_cbranch_scc1 mpi_94
  ds_read_b128 v[4:7], v3 offset:256
  ds_read_b128 v[8:11], v3 offset:288
  s_waitcnt lgkmcnt(0)
  s_cmp_eq_u32 s43, 2
  s_cbranch_scc1 mpv_95
  v_mfma_f32_32x32x16_bf16 v[176:191], v[48:51], v[4:7], v[176:191]
  v_mfma_f32_32x32x16_bf16 v[176:191], v[52:55], v[8:11], v[176:191]
  s_branch mpd_96
mpv_95:
  v_mfma_f32_32x32x16_bf16 v[176:191], v[4:7], v[48:51], v[176:191]
  v_mfma_f32_32x32x16_bf16 v[176:191], v[8:11], v[52:55], v[176:191]
mpd_96:
  ds_read_b128 v[4:7], v3 offset:320
  ds_read_b128 v[8:11], v3 offset:352
  s_waitcnt lgkmcnt(0)
  s_cmp_eq_u32 s43, 2
  s_cbranch_scc1 mpv_97
  v_mfma_f32_32x32x16_bf16 v[176:191], v[56:59], v[4:7], v[176:191]
  v_mfma_f32_32x32x16_bf16 v[176:191], v[60:63], v[8:11], v[176:191]
  s_branch mpd_98
mpv_97:
  v_mfma_f32_32x32x16_bf16 v[176:191], v[4:7], v[56:59], v[176:191]
  v_mfma_f32_32x32x16_bf16 v[176:191], v[8:11], v[60:63], v[176:191]
mpd_98:
  ds_read_b128 v[4:7], v3 offset:384
  ds_read_b128 v[8:11], v3 offset:416
  s_waitcnt lgkmcnt(0)
  s_cmp_eq_u32 s43, 2
  s_cbranch_scc1 mpv_99
  v_mfma_f32_32x32x16_bf16 v[176:191], v[64:67], v[4:7], v[176:191]
  v_mfma_f32_32x32x16_bf16 v[176:191], v[68:71], v[8:11], v[176:191]
  s_branch mpd_100
mpv_99:
  v_mfma_f32_32x32x16_bf16 v[176:191], v[4:7], v[64:67], v[176:191]
  v_mfma_f32_32x32x16_bf16 v[176:191], v[8:11], v[68:71], v[176:191]
mpd_100:
  ds_read_b128 v[4:7], v3 offset:448
  ds_read_b128 v[8:11], v3 offset:480
  s_waitcnt lgkmcnt(0)
  s_cmp_eq_u32 s43, 2
  s_cbranch_scc1 mpv_101
  v_mfma_f32_32x32x16_bf16 v[176:191], v[72:75], v[4:7], v[176:191]
  v_mfma_f32_32x32x16_bf16 v[176:191], v[76:79], v[8:11], v[176:191]
  s_branch mpd_102
mpv_101:
  v_mfma_f32_32x32x16_bf16 v[176:191], v[4:7], v[72:75], v[176:191]
  v_mfma_f32_32x32x16_bf16 v[176:191], v[8:11], v[76:79], v[176:191]
mpd_102:
mpi_94:
  s_waitcnt vmcnt(13)
  ds_write_b128 v13, v[208:211] offset:0
  ds_write_b128 v13, v[212:215] offset:8192
  ds_write_b128 v13, v[216:219] offset:16384
  ds_write_b128 v13, v[220:223] offset:24576
  s_waitcnt lgkmcnt(0)
  s_mov_b32 s34, 81920
  buffer_load_dwordx4 v[192:195], v2, s[20:23], s34 offen
  s_mov_b32 s34, 90112
  buffer_load_dwordx4 v[196:199], v2, s[20:23], s34 offen
  s_mov_b32 s34, 98304
  buffer_load_dwordx4 v[200:203], v2, s[20:23], s34 offen
  s_mov_b32 s34, 106496
  buffer_load_dwordx4 v[204:207], v2, s[20:23], s34 offen
  s_mov_b32 s34, 114688
  buffer_load_dwordx4 v[208:211], v2, s[20:23], s34 offen
  s_barrier
  ds_read_b64_tr_b16 v[80:81], v14 offset:0
  ds_read_b64_tr_b16 v[82:83], v14 offset:1024
  ds_read_b64_tr_b16 v[84:85], v14 offset:4096
  ds_read_b64_tr_b16 v[86:87], v14 offset:5120
  ds_read_b64_tr_b16 v[88:89], v14 offset:8192
  ds_read_b64_tr_b16 v[90:91], v14 offset:9216
  ds_read_b64_tr_b16 v[92:93], v14 offset:12288
  ds_read_b64_tr_b16 v[94:95], v14 offset:13312
  s_waitcnt lgkmcnt(0)
  ds_read_b64_tr_b16 v[96:97], v14 offset:16384
  ds_read_b64_tr_b16 v[98:99], v14 offset:17408
  ds_read_b64_tr_b16 v[100:101], v14 offset:20480
  ds_read_b64_tr_b16 v[102:103], v14 offset:21504
  ds_read_b64_tr_b16 v[104:105], v14 offset:24576
  ds_read_b64_tr_b16 v[106:107], v14 offset:25600
  ds_read_b64_tr_b16 v[108:109], v14 offset:28672
  ds_read_b64_tr_b16 v[110:111], v14 offset:29696
  s_waitcnt lgkmcnt(0)
  s_waitcnt lgkmcnt(0)
  s_cmp_ge_u32 s30, 4
  s_cbranch_scc1 mpi_103
  ds_read_b128 v[4:7], v3 offset:512
  ds_read_b128 v[8:11], v3 offset:544
  s_waitcnt lgkmcnt(0)
  s_cmp_eq_u32 s43, 2
  s_cbranch_scc1 mpv_104
  v_mfma_f32_32x32x16_bf16 v[176:191], v[80:83], v[4:7], v[176:191]
  v_mfma_f32_32x32x16_bf16 v[176:191], v[84:87], v[8:11], v[176:191]
  s_branch mpd_105
mpv_104:
  v_mfma_f32_32x32x16_bf16 v[176:191], v[4:7], v[80:83], v[176:191]
  v_mfma_f32_32x32x16_bf16 v[176:191], v[8:11], v[84:87], v[176:191]
mpd_105:
  ds_read_b128 v[4:7], v3 offset:576
  ds_read_b128 v[8:11], v3 offset:608
  s_waitcnt lgkmcnt(0)
  s_cmp_eq_u32 s43, 2
  s_cbranch_scc1 mpv_106
  v_mfma_f32_32x32x16_bf16 v[176:191], v[88:91], v[4:7], v[176:191]
  v_mfma_f32_32x32x16_bf16 v[176:191], v[92:95], v[8:11], v[176:191]
  s_branch mpd_107
mpv_106:
  v_mfma_f32_32x32x16_bf16 v[176:191], v[4:7], v[88:91], v[176:191]
  v_mfma_f32_32x32x16_bf16 v[176:191], v[8:11], v[92:95], v[176:191]
mpd_107:
  ds_read_b128 v[4:7], v3 offset:640
  ds_read_b128 v[8:11], v3 offset:672
  s_waitcnt lgkmcnt(0)
  s_cmp_eq_u32 s43, 2
  s_cbranch_scc1 mpv_108
  v_mfma_f32_32x32x16_bf16 v[176:191], v[96:99], v[4:7], v[176:191]
  v_mfma_f32_32x32x16_bf16 v[176:191], v[100:103], v[8:11], v[176:191]
  s_branch mpd_109
mpv_108:
  v_mfma_f32_32x32x16_bf16 v[176:191], v[4:7], v[96:99], v[176:191]
  v_mfma_f32_32x32x16_bf16 v[176:191], v[8:11], v[100:103], v[176:191]
mpd_109:
  ds_read_b128 v[4:7], v3 offset:704
  ds_read_b128 v[8:11], v3 offset:736
  s_waitcnt lgkmcnt(0)
  s_cmp_eq_u32 s43, 2
  s_cbranch_scc1 mpv_110
  v_mfma_f32_32x32x16_bf16 v[176:191], v[104:107], v[4:7], v[176:191]
  v_mfma_f32_32x32x16_bf16 v[176:191], v[108:111], v[8:11], v[176:191]
  s_branch mpd_111
mpv_110:
  v_mfma_f32_32x32x16_bf16 v[176:191], v[4:7], v[104:107], v[176:191]
  v_mfma_f32_32x32x16_bf16 v[176:191], v[8:11], v[108:111], v[176:191]
mpd_111:
mpi_103:
  s_waitcnt vmcnt(14)
  ds_write_b128 v13, v[224:227] offset:32768
  ds_write_b128 v13, v[228:231] offset:40960
  ds_write_b128 v13, v[232:235] offset:49152
  ds_write_b128 v13, v[236:239] offset:57344
  s_waitcnt lgkmcnt(0)
  s_barrier
  ds_read_b64_tr_b16 v[112:113], v14 offset:32768
  ds_read_b64_tr_b16 v[114:115], v14 offset:33792
  ds_read_b64_tr_b16 v[116:117], v14 offset:36864
  ds_read_b64_tr_b16 v[118:119], v14 offset:37888
  ds_read_b64_tr_b16 v[120:121], v14 offset:40960
  ds_read_b64_tr_b16 v[122:123], v14 offset:41984
  ds_read_b64_tr_b16 v[124:125], v14 offset:45056
  ds_read_b64_tr_b16 v[126:127], v14 offset:46080
  s_waitcnt lgkmcnt(0)
  ds_read_b64_tr_b16 v[128:129], v14 offset:49152
  ds_read_b64_tr_b16 v[130:131], v14 offset:50176
  ds_read_b64_tr_b16 v[132:133], v14 offset:53248
  ds_read_b64_tr_b16 v[134:135], v14 offset:54272
  ds_read_b64_tr_b16 v[136:137], v14 offset:57344
  ds_read_b64_tr_b16 v[138:139], v14 offset:58368
  ds_read_b64_tr_b16 v[140:141], v14 offset:61440
  ds_read_b64_tr_b16 v[142:143], v14 offset:62464
  s_waitcnt lgkmcnt(0)
  s_waitcnt lgkmcnt(0)
  s_cmp_ge_u32 s30, 4
  s_cbranch_scc1 mpi_112
  ds_read_b128 v[4:7], v3 offset:768
  ds_read_b128 v[8:11], v3 offset:800
  s_waitcnt lgkmcnt(0)
  s_cmp_eq_u32 s43, 2
  s_cbranch_scc1 mpv_113
  v_mfma_f32_32x32x16_bf16 v[176:191], v[112:115], v[4:7], v[176:191]
  v_mfma_f32_32x32x16_bf16 v[176:191], v[116:119], v[8:11], v[176:191]
  s_branch mpd_114
mpv_113:
  v_mfma_f32_32x32x16_bf16 v[176:191], v[4:7], v[112:115], v[176:191]
  v_mfma_f32_32x32x16_bf16 v[176:191], v[8:11], v[116:119], v[176:191]
mpd_114:
  ds_read_b128 v[4:7], v3 offset:832
  ds_read_b128 v[8:11], v3 offset:864
  s_waitcnt lgkmcnt(0)
  s_cmp_eq_u32 s43, 2
  s_cbranch_scc1 mpv_115
  v_mfma_f32_32x32x16_bf16 v[176:191], v[120:123], v[4:7], v[176:191]
  v_mfma_f32_32x32x16_bf16 v[176:191], v[124:127], v[8:11], v[176:191]
  s_branch mpd_116
mpv_115:
  v_mfma_f32_32x32x16_bf16 v[176:191], v[4:7], v[120:123], v[176:191]
  v_mfma_f32_32x32x16_bf16 v[176:191], v[8:11], v[124:127], v[176:191]
mpd_116:
  ds_read_b128 v[4:7], v3 offset:896
  ds_read_b128 v[8:11], v3 offset:928
  s_waitcnt lgkmcnt(0)
  s_cmp_eq_u32 s43, 2
  s_cbranch_scc1 mpv_117
  v_mfma_f32_32x32x16_bf16 v[176:191], v[128:131], v[4:7], v[176:191]
  v_mfma_f32_32x32x16_bf16 v[176:191], v[132:135], v[8:11], v[176:191]
  s_branch mpd_118
mpv_117:
  v_mfma_f32_32x32x16_bf16 v[176:191], v[4:7], v[128:131], v[176:191]
  v_mfma_f32_32x32x16_bf16 v[176:191], v[8:11], v[132:135], v[176:191]
mpd_118:
  ds_read_b128 v[4:7], v3 offset:960
  ds_read_b128 v[8:11], v3 offset:992
  s_waitcnt lgkmcnt(0)
  s_cmp_eq_u32 s43, 2
  s_cbranch_scc1 mpv_119
  v_mfma_f32_32x32x16_bf16 v[176:191], v[136:139], v[4:7], v[176:191]
  v_mfma_f32_32x32x16_bf16 v[176:191], v[140:143], v[8:11], v[176:191]
  s_branch mpd_120
mpv_119:
  v_mfma_f32_32x32x16_bf16 v[176:191], v[4:7], v[136:139], v[176:191]
  v_mfma_f32_32x32x16_bf16 v[176:191], v[8:11], v[140:143], v[176:191]
mpd_120:
mpi_112:
  s_waitcnt vmcnt(10)
  ds_write_b128 v13, v[240:243] offset:0
  ds_write_b128 v13, v[244:247] offset:8192
  ds_write_b128 v13, v[248:251] offset:16384
  ds_write_b128 v13, v[252:255] offset:24576
  s_waitcnt vmcnt(5)
  v_add_u32 v10, 0, v0
  v_mul_u32_u24 v11, 52429, v10
  v_lshrrev_b32 v11, 22, v11
  v_add_u32 v11, v11, v10
  v_lshlrev_b32 v11, 4, v11
  ds_write_b128 v11, v[156:159] offset:41472
  v_add_u32 v10, 512, v0
  v_mul_u32_u24 v11, 52429, v10
  v_lshrrev_b32 v11, 22, v11
  v_add_u32 v11, v11, v10
  v_lshlrev_b32 v11, 4, v11
  ds_write_b128 v11, v[160:163] offset:41472
  v_add_u32 v10, 1024, v0
  v_mul_u32_u24 v11, 52429, v10
  v_lshrrev_b32 v11, 22, v11
  v_add_u32 v11, v11, v10
  v_lshlrev_b32 v11, 4, v11
  ds_write_b128 v11, v[164:167] offset:41472
  v_add_u32 v10, 1536, v0
  v_mul_u32_u24 v11, 52429, v10
  v_lshrrev_b32 v11, 22, v11
  v_add_u32 v11, v11, v10
  v_lshlrev_b32 v11, 4, v11
  ds_write_b128 v11, v[168:171] offset:41472
  v_add_u32 v10, 2048, v0
  v_mul_u32_u24 v11, 52429, v10
  v_lshrrev_b32 v11, 22, v11
  v_add_u32 v11, v11, v10
  v_lshlrev_b32 v11, 4, v11
  ds_write_b128 v11, v[172:175] offset:41472
  s_waitcnt lgkmcnt(0)
  s_barrier
  ds_read_b64_tr_b16 v[144:145], v14 offset:0
  ds_read_b64_tr_b16 v[146:147], v14 offset:1024
  ds_read_b64_tr_b16 v[148:149], v14 offset:4096
  ds_read_b64_tr_b16 v[150:151], v14 offset:5120
  ds_read_b64_tr_b16 v[152:153], v14 offset:8192
  ds_read_b64_tr_b16 v[154:155], v14 offset:9216
  ds_read_b64_tr_b16 v[156:157], v14 offset:12288
  ds_read_b64_tr_b16 v[158:159], v14 offset:13312
  s_waitcnt lgkmcnt(0)
  ds_read_b64_tr_b16 v[160:161], v14 offset:16384
  ds_read_b64_tr_b16 v[162:163], v14 offset:17408
  ds_read_b64_tr_b16 v[164:165], v14 offset:20480
  ds_read_b64_tr_b16 v[166:167], v14 offset:21504
  ds_read_b64_tr_b16 v[168:169], v14 offset:24576
  ds_read_b64_tr_b16 v[170:171], v14 offset:25600
  ds_read_b64_tr_b16 v[172:173], v14 offset:28672
  ds_read_b64_tr_b16 v[174:175], v14 offset:29696
  s_waitcnt lgkmcnt(0)
  s_waitcnt lgkmcnt(0)
  s_cmp_ge_u32 s30, 4
  s_cbranch_scc1 mpi_121
  ds_read_b128 v[4:7], v3 offset:1024
  ds_read_b128 v[8:11], v3 offset:1056
  s_waitcnt lgkmcnt(0)
  s_cmp_eq_u32 s43, 2
  s_cbranch_scc1 mpv_122
  v_mfma_f32_32x32x16_bf16 v[176:191], v[144:147], v[4:7], v[176:191]
  v_mfma_f32_32x32x16_bf16 v[176:191], v[148:151], v[8:11], v[176:191]
  s_branch mpd_123
mpv_122:
  v_mfma_f32_32x32x16_bf16 v[176:191], v[4:7], v[144:147], v[176:191]
  v_mfma_f32_32x32x16_bf16 v[176:191], v[8:11], v[148:151], v[176:191]
mpd_123:
  ds_read_b128 v[4:7], v3 offset:1088
  ds_read_b128 v[8:11], v3 offset:1120
  s_waitcnt lgkmcnt(0)
  s_cmp_eq_u32 s43, 2
  s_cbranch_scc1 mpv_124
  v_mfma_f32_32x32x16_bf16 v[176:191], v[152:155], v[4:7], v[176:191]
  v_mfma_f32_32x32x16_bf16 v[176:191], v[156:159], v[8:11], v[176:191]
  s_branch mpd_125
mpv_124:
  v_mfma_f32_32x32x16_bf16 v[176:191], v[4:7], v[152:155], v[176:191]
  v_mfma_f32_32x32x16_bf16 v[176:191], v[8:11], v[156:159], v[176:191]
mpd_125:
  ds_read_b128 v[4:7], v3 offset:1152
  ds_read_b128 v[8:11], v3 offset:1184
  s_waitcnt lgkmcnt(0)
  s_cmp_eq_u32 s43, 2
  s_cbranch_scc1 mpv_126
  v_mfma_f32_32x32x16_bf16 v[176:191], v[160:163], v[4:7], v[176:191]
  v_mfma_f32_32x32x16_bf16 v[176:191], v[164:167], v[8:11], v[176:191]
  s_branch mpd_127
mpv_126:
  v_mfma_f32_32x32x16_bf16 v[176:191], v[4:7], v[160:163], v[176:191]
  v_mfma_f32_32x32x16_bf16 v[176:191], v[8:11], v[164:167], v[176:191]
mpd_127:
  ds_read_b128 v[4:7], v3 offset:1216
  ds_read_b128 v[8:11], v3 offset:1248
  s_waitcnt lgkmcnt(0)
  s_cmp_eq_u32 s43, 2
  s_cbranch_scc1 mpv_128
  v_mfma_f32_32x32x16_bf16 v[176:191], v[168:171], v[4:7], v[176:191]
  v_mfma_f32_32x32x16_bf16 v[176:191], v[172:175], v[8:11], v[176:191]
  s_branch mpd_129
mpv_128:
  v_mfma_f32_32x32x16_bf16 v[176:191], v[4:7], v[168:171], v[176:191]
  v_mfma_f32_32x32x16_bf16 v[176:191], v[8:11], v[172:175], v[176:191]
mpd_129:
mpi_121:
  s_cmp_lg_u32 s31, 0
  s_cbranch_scc1 valok_132
  v_lshlrev_b32 v10, 2, v1
  s_mov_b32 s39, 0
val_130:
  buffer_load_dword v11, v10, s[12:15], 0 offen sc1
  s_waitcnt vmcnt(0)
  v_cmp_eq_u32 vcc, 32, v11
s_nop 3
  s_and_b32 s34, vcc_lo, vcc_hi
  s_and_b32 s34, s34, 0x5555
  s_cmp_eq_u32 s34, 0x5555
  s_cbranch_scc0 valg_131_s
  v_readlane_b32 s32, v11, 1
  s_mov_b32 s34, 0
  s_cmp_eq_u32 s34, 0
  s_cbranch_scc1 valg_131
valg_131_s:
  s_mov_b32 s36, 0
  s_mov_b32 s37, 0
  s_mov_b32 s38, 0
  s_mov_b32 s34, 0
  v_readlane_b32 s35, v11, 2
s_nop 3
  s_add_u32 s38, s38, s35
  v_readlane_b32 s35, v11, 0
s_nop 3
  s_add_u32 s36, s36, s35
  s_cmp_eq_u32 s35, 32
  s_cselect_b32 s97, 0, 1
  s_or_b32 s34, s34, s97
  s_cmp_gt_u32 s98, 0
  s_cselect_b32 s35, s35, 0
  s_add_u32 s37, s37, s35
  v_readlane_b32 s35, v11, 6
s_nop 3
  s_add_u32 s38, s38, s35
  v_readlane_b32 s35, v11, 4
s_nop 3
  s_add_u32 s36, s36, s35
  s_cmp_eq_u32 s35, 32
  s_cselect_b32 s97, 0, 1
  s_or_b32 s34, s34, s97
  s_cmp_gt_u32 s98, 1
  s_cselect_b32 s35, s35, 0
  s_add_u32 s37, s37, s35
  v_readlane_b32 s35, v11, 10
s_nop 3
  s_add_u32 s38, s38, s35
  v_readlane_b32 s35, v11, 8
s_nop 3
  s_add_u32 s36, s36, s35
  s_cmp_eq_u32 s35, 32
  s_cselect_b32 s97, 0, 1
  s_or_b32 s34, s34, s97
  s_cmp_gt_u32 s98, 2
  s_cselect_b32 s35, s35, 0
  s_add_u32 s37, s37, s35
  v_readlane_b32 s35, v11, 14
s_nop 3
  s_add_u32 s38, s38, s35
  v_readlane_b32 s35, v11, 12
s_nop 3
  s_add_u32 s36, s36, s35
  s_cmp_eq_u32 s35, 32
  s_cselect_b32 s97, 0, 1
  s_or_b32 s34, s34, s97
  s_cmp_gt_u32 s98, 3
  s_cselect_b32 s35, s35, 0
  s_add_u32 s37, s37, s35
  v_readlane_b32 s35, v11, 34
s_nop 3
  s_add_u32 s38, s38, s35
  v_readlane_b32 s35, v11, 32
s_nop 3
  s_add_u32 s36, s36, s35
  s_cmp_eq_u32 s35, 32
  s_cselect_b32 s97, 0, 1
  s_or_b32 s34, s34, s97
  s_cmp_gt_u32 s98, 4
  s_cselect_b32 s35, s35, 0
  s_add_u32 s37, s37, s35
  v_readlane_b32 s35, v11, 38
s_nop 3
  s_add_u32 s38, s38, s35
  v_readlane_b32 s35, v11, 36
s_nop 3
  s_add_u32 s36, s36, s35
  s_cmp_eq_u32 s35, 32
  s_cselect_b32 s97, 0, 1
  s_or_b32 s34, s34, s97
  s_cmp_gt_u32 s98, 5
  s_cselect_b32 s35, s35, 0
  s_add_u32 s37, s37, s35
  v_readlane_b32 s35, v11, 42
s_nop 3
  s_add_u32 s38, s38, s35
  v_readlane_b32 s35, v11, 40
s_nop 3
  s_add_u32 s36, s36, s35
  s_cmp_eq_u32 s35, 32
  s_cselect_b32 s97, 0, 1
  s_or_b32 s34, s34, s97
  s_cmp_gt_u32 s98, 6
  s_cselect_b32 s35, s35, 0
  s_add_u32 s37, s37, s35
  v_readlane_b32 s35, v11, 46
s_nop 3
  s_add_u32 s38, s38, s35
  v_readlane_b32 s35, v11, 44
s_nop 3
  s_add_u32 s36, s36, s35
  s_cmp_eq_u32 s35, 32
  s_cselect_b32 s97, 0, 1
  s_or_b32 s34, s34, s97
  s_cmp_gt_u32 s98, 7
  s_cselect_b32 s35, s35, 0
  s_add_u32 s37, s37, s35
  v_readlane_b32 s35, v11, 18
s_nop 3
  s_add_u32 s38, s38, s35
  v_readlane_b32 s35, v11, 16
s_nop 3
  s_add_u32 s36, s36, s35
  s_cmp_eq_u32 s35, 0
  s_cselect_b32 s97, 0, 1
  s_or_b32 s34, s34, s97
  s_cmp_gt_u32 s98, 8
  s_cselect_b32 s35, s35, 0
  s_add_u32 s37, s37, s35
  v_readlane_b32 s35, v11, 22
s_nop 3
  s_add_u32 s38, s38, s35
  v_readlane_b32 s35, v11, 20
s_nop 3
  s_add_u32 s36, s36, s35
  s_cmp_eq_u32 s35, 0
  s_cselect_b32 s97, 0, 1
  s_or_b32 s34, s34, s97
  s_cmp_gt_u32 s98, 9
  s_cselect_b32 s35, s35, 0
  s_add_u32 s37, s37, s35
  v_readlane_b32 s35, v11, 26
s_nop 3
  s_add_u32 s38, s38, s35
  v_readlane_b32 s35, v11, 24
s_nop 3
  s_add_u32 s36, s36, s35
  s_cmp_eq_u32 s35, 0
  s_cselect_b32 s97, 0, 1
  s_or_b32 s34, s34, s97
  s_cmp_gt_u32 s98, 10
  s_cselect_b32 s35, s35, 0
  s_add_u32 s37, s37, s35
  v_readlane_b32 s35, v11, 30
s_nop 3
  s_add_u32 s38, s38, s35
  v_readlane_b32 s35, v11, 28
s_nop 3
  s_add_u32 s36, s36, s35
  s_cmp_eq_u32 s35, 0
  s_cselect_b32 s97, 0, 1
  s_or_b32 s34, s34, s97
  s_cmp_gt_u32 s98, 11
  s_cselect_b32 s35, s35, 0
  s_add_u32 s37, s37, s35
  v_readlane_b32 s35, v11, 50
s_nop 3
  s_add_u32 s38, s38, s35
  v_readlane_b32 s35, v11, 48
s_nop 3
  s_add_u32 s36, s36, s35
  s_cmp_eq_u32 s35, 0
  s_cselect_b32 s97, 0, 1
  s_or_b32 s34, s34, s97
  s_cmp_gt_u32 s98, 12
  s_cselect_b32 s35, s35, 0
  s_add_u32 s37, s37, s35
  v_readlane_b32 s35, v11, 54
s_nop 3
  s_add_u32 s38, s38, s35
  v_readlane_b32 s35, v11, 52
s_nop 3
  s_add_u32 s36, s36, s35
  s_cmp_eq_u32 s35, 0
  s_cselect_b32 s97, 0, 1
  s_or_b32 s34, s34, s97
  s_cmp_gt_u32 s98, 13
  s_cselect_b32 s35, s35, 0
  s_add_u32 s37, s37, s35
  v_readlane_b32 s35, v11, 58
s_nop 3
  s_add_u32 s38, s38, s35
  v_readlane_b32 s35, v11, 56
s_nop 3
  s_add_u32 s36, s36, s35
  s_cmp_eq_u32 s35, 0
  s_cselect_b32 s97, 0, 1
  s_or_b32 s34, s34, s97
  s_cmp_gt_u32 s98, 14
  s_cselect_b32 s35, s35, 0
  s_add_u32 s37, s37, s35
  v_readlane_b32 s35, v11, 62
s_nop 3
  s_add_u32 s38, s38, s35
  v_readlane_b32 s35, v11, 60
s_nop 3
  s_add_u32 s36, s36, s35
  s_cmp_eq_u32 s35, 0
  s_cselect_b32 s97, 0, 1
  s_or_b32 s34, s34, s97
  s_cmp_gt_u32 s98, 15
  s_cselect_b32 s35, s35, 0
  s_add_u32 s37, s37, s35
  v_readlane_b32 s32, v11, 1
  s_cmp_eq_u32 s36, 256
  s_cselect_b32 s35, s38, 0
  s_cmp_eq_u32 s35, 256
  s_cbranch_scc1 valg_131
  s_sleep 2
  s_add_u32 s39, s39, 1
  s_cmp_lt_u32 s39, s33
  s_cbranch_scc1 val_130
  s_mov_b32 s33, 0
valg_131:
s_nop 0
  s_and_b32 s32, s32, 2
  s_lshl_b32 s32, s32, 12
  s_cmp_eq_u32 s34, 0
  s_cbranch_scc1 valok_132
  s_mov_b32 s31, 1
  s_mov_b32 s32, 0
  s_add_u32 s37, s37, s99
  s_and_b32 s37, s37, 255
  s_lshr_b32 s28, s37, 5
  s_and_b32 s29, s37, 31
  s_barrier
  s_branch L_dispatch
valok_132:
  s_cmp_lg_u32 s31, 0
  s_cbranch_scc1 pwd_134
  s_mov_b32 s39, 0
  v_mov_b32 v13, 4
pw_133:
  buffer_load_dword v12, v13, s[12:15], 0 offen sc1
  s_waitcnt vmcnt(0)
  v_readfirstlane_b32 s32, v12
s_nop 3
  s_cmp_lg_u32 s32, 0
  s_cbranch_scc1 pw_133_g
  s_sleep 2
  s_add_u32 s39, s39, 1
  s_cmp_lt_u32 s39, s33
  s_cbranch_scc1 pw_133
  s_mov_b32 s33, 0
pw_133_g:
  s_and_b32 s32, s32, 2
  s_lshl_b32 s32, s32, 12
pwd_134:
  s_xor_b32 s100, s32, 8192
  s_add_u32 s101, s100, 3817472
  s_add_u32 s100, s100, 3801088
  s_cmp_ge_u32 s30, 4
  s_cbranch_scc1 mpq_135
  s_lshl_b32 s34, s42, 13
  s_and_b32 s35, s30, 3
  v_lshrrev_b32 v10, 5, v1
  v_and_b32 v11, 15, v1
  v_lshl_add_u32 v11, v10, 4, v11
  v_lshlrev_b32 v11, 4, v11
  v_bfe_u32 v10, v1, 4, 1
  s_lshr_b32 s36, s30, 2
  s_sub_u32 s36, 0, s36
  s_mov_b32 s36, 0
  s_lshl_b32 s36, s36, 18
  s_lshl_b32 s37, s43, 24
  s_add_u32 s36, s36, s37
  s_cmp_eq_u32 s43, 2
  s_cbranch_scc1 L_mp_vo0
  s_lshl_b32 s35, s35, 10
  v_lshl_add_u32 v11, v10, 12, v11
  v_cvt_pk_bf16_f32 v176, v176, v177
  v_cvt_pk_bf16_f32 v177, v178, v179
  v_cvt_pk_bf16_f32 v178, v180, v181
  v_cvt_pk_bf16_f32 v179, v182, v183
  v_cvt_pk_bf16_f32 v180, v184, v185
  v_cvt_pk_bf16_f32 v181, v186, v187
  v_cvt_pk_bf16_f32 v182, v188, v189
  v_cvt_pk_bf16_f32 v183, v190, v191
  s_branch L_mp_so0
L_mp_vo0:
  s_lshl_b32 s35, s35, 11
  v_lshl_add_u32 v11, v10, 10, v11
  v_cvt_pk_bf16_f32 v176, v176, v177
  v_cvt_pk_bf16_f32 v177, v178, v179
  v_cvt_pk_bf16_f32 v178, v184, v185
  v_cvt_pk_bf16_f32 v179, v186, v187
  v_cvt_pk_bf16_f32 v180, v180, v181
  v_cvt_pk_bf16_f32 v181, v182, v183
  v_cvt_pk_bf16_f32 v182, v188, v189
  v_cvt_pk_bf16_f32 v183, v190, v191
L_mp_so0:
  s_add_u32 s34, s34, s35
  v_add_u32 v11, s34, v11
  buffer_store_dwordx4 v[176:179], v11, s[8:11], s36 offen sc1
  buffer_store_dwordx4 v[180:183], v11, s[8:11], s36 offen offset:512 sc1
mpq_135:
  s_waitcnt vmcnt(0)
  s_barrier
  v_add_u32 v10, 0, v0
  v_mul_u32_u24 v11, 52429, v10
  v_lshrrev_b32 v11, 22, v11
  v_add_u32 v11, v11, v10
  v_lshlrev_b32 v11, 4, v11
  ds_write_b128 v11, v[192:195] offset:0
  v_add_u32 v10, 512, v0
  v_mul_u32_u24 v11, 52429, v10
  v_lshrrev_b32 v11, 22, v11
  v_add_u32 v11, v11, v10
  v_lshlrev_b32 v11, 4, v11
  ds_write_b128 v11, v[196:199] offset:0
  v_add_u32 v10, 1024, v0
  v_mul_u32_u24 v11, 52429, v10
  v_lshrrev_b32 v11, 22, v11
  v_add_u32 v11, v11, v10
  v_lshlrev_b32 v11, 4, v11
  ds_write_b128 v11, v[200:203] offset:0
  v_add_u32 v10, 1536, v0
  v_mul_u32_u24 v11, 52429, v10
  v_lshrrev_b32 v11, 22, v11
  v_add_u32 v11, v11, v10
  v_lshlrev_b32 v11, 4, v11
  ds_write_b128 v11, v[204:207] offset:0
  v_add_u32 v10, 2048, v0
  v_mul_u32_u24 v11, 52429, v10
  v_lshrrev_b32 v11, 22, v11
  v_add_u32 v11, v11, v10
  v_lshlrev_b32 v11, 4, v11
  ds_write_b128 v11, v[208:211] offset:0
  s_waitcnt lgkmcnt(0)
  s_waitcnt vmcnt(0)
  s_barrier
  s_cmp_lg_u32 s30, 0
  s_cbranch_scc1 mpf_136
  s_lshl_b32 s34, s44, 2
  s_add_u32 s34, s34, 1024
  s_add_u32 s34, s34, s100
  v_mov_b32 v10, s34
  v_mov_b32 v11, 1
  s_mov_b64 exec, 1
  buffer_store_dword v11, v10, s[8:11], 0 offen sc1
  s_mov_b64 exec, -1
mpf_136:
  s_lshr_b32 s34, s30, 2
  s_mul_i32 s34, s34, 41472
  v_add_u32 v3, s34, v3
  s_cmp_eq_u32 s43, 2
  s_cbranch_scc1 mpv_137
  ds_read_b128 v[4:7], v3
  ds_read_b128 v[8:11], v3 offset:32
  s_waitcnt lgkmcnt(1)
  v_mfma_f32_32x32x16_bf16 v[176:191], v[16:19], v[4:7], 0
  ds_read_b128 v[4:7], v3 offset:64
  s_waitcnt lgkmcnt(1)
  v_mfma_f32_32x32x16_bf16 v[176:191], v[20:23], v[8:11], v[176:191]
  ds_read_b128 v[8:11], v3 offset:96
  s_waitcnt lgkmcnt(1)
  v_mfma_f32_32x32x16_bf16 v[176:191], v[24:27], v[4:7], v[176:191]
  ds_read_b128 v[4:7], v3 offset:128
  s_waitcnt lgkmcnt(1)
  v_mfma_f32_32x32x16_bf16 v[176:191], v[28:31], v[8:11], v[176:191]
  ds_read_b128 v[8:11], v3 offset:160
  s_waitcnt lgkmcnt(1)
  v_mfma_f32_32x32x16_bf16 v[176:191], v[32:35], v[4:7], v[176:191]
  ds_read_b128 v[4:7], v3 offset:192
  s_waitcnt lgkmcnt(1)
  v_mfma_f32_32x32x16_bf16 v[176:191], v[36:39], v[8:11], v[176:191]
  ds_read_b128 v[8:11], v3 offset:224
  s_waitcnt lgkmcnt(1)
  v_mfma_f32_32x32x16_bf16 v[176:191], v[40:43], v[4:7], v[176:191]
  ds_read_b128 v[4:7], v3 offset:256
  s_waitcnt lgkmcnt(1)
  v_mfma_f32_32x32x16_bf16 v[176:191], v[44:47], v[8:11], v[176:191]
  ds_read_b128 v[8:11], v3 offset:288
  s_waitcnt lgkmcnt(1)
  v_mfma_f32_32x32x16_bf16 v[176:191], v[48:51], v[4:7], v[176:191]
  ds_read_b128 v[4:7], v3 offset:320
  s_waitcnt lgkmcnt(1)
  v_mfma_f32_32x32x16_bf16 v[176:191], v[52:55], v[8:11], v[176:191]
  ds_read_b128 v[8:11], v3 offset:352
  s_waitcnt lgkmcnt(1)
  v_mfma_f32_32x32x16_bf16 v[176:191], v[56:59], v[4:7], v[176:191]
  ds_read_b128 v[4:7], v3 offset:384
  s_waitcnt lgkmcnt(1)
  v_mfma_f32_32x32x16_bf16 v[176:191], v[60:63], v[8:11], v[176:191]
  ds_read_b128 v[8:11], v3 offset:416
  s_waitcnt lgkmcnt(1)
  v_mfma_f32_32x32x16_bf16 v[176:191], v[64:67], v[4:7], v[176:191]
  ds_read_b128 v[4:7], v3 offset:448
  s_waitcnt lgkmcnt(1)
  v_mfma_f32_32x32x16_bf16 v[176:191], v[68:71], v[8:11], v[176:191]
  ds_read_b128 v[8:11], v3 offset:480
  s_waitcnt lgkmcnt(1)
  v_mfma_f32_32x32x16_bf16 v[176:191], v[72:75], v[4:7], v[176:191]
  ds_read_b128 v[4:7], v3 offset:512
  s_waitcnt lgkmcnt(1)
  v_mfma_f32_32x32x16_bf16 v[176:191], v[76:79], v[8:11], v[176:191]
  ds_read_b128 v[8:11], v3 offset:544
  s_waitcnt lgkmcnt(1)
  v_mfma_f32_32x32x16_bf16 v[176:191], v[80:83], v[4:7], v[176:191]
  ds_read_b128 v[4:7], v3 offset:576
  s_waitcnt lgkmcnt(1)
  v_mfma_f32_32x32x16_bf16 v[176:191], v[84:87], v[8:11], v[176:191]
  ds_read_b128 v[8:11], v3 offset:608
  s_waitcnt lgkmcnt(1)
  v_mfma_f32_32x32x16_bf16 v[176:191], v[88:91], v[4:7], v[176:191]
  ds_read_b128 v[4:7], v3 offset:640
  s_waitcnt lgkmcnt(1)
  v_mfma_f32_32x32x16_bf16 v[176:191], v[92:95], v[8:11], v[176:191]
  ds_read_b128 v[8:11], v3 offset:672
  s_waitcnt lgkmcnt(1)
  v_mfma_f32_32x32x16_bf16 v[176:191], v[96:99], v[4:7], v[176:191]
  ds_read_b128 v[4:7], v3 offset:704
  s_waitcnt lgkmcnt(1)
  v_mfma_f32_32x32x16_bf16 v[176:191], v[100:103], v[8:11], v[176:191]
  ds_read_b128 v[8:11], v3 offset:736
  s_waitcnt lgkmcnt(1)
  v_mfma_f32_32x32x16_bf16 v[176:191], v[104:107], v[4:7], v[176:191]
  ds_read_b128 v[4:7], v3 offset:768
  s_waitcnt lgkmcnt(1)
  v_mfma_f32_32x32x16_bf16 v[176:191], v[108:111], v[8:11], v[176:191]
  ds_read_b128 v[8:11], v3 offset:800
  s_waitcnt lgkmcnt(1)
  v_mfma_f32_32x32x16_bf16 v[176:191], v[112:115], v[4:7], v[176:191]
  ds_read_b128 v[4:7], v3 offset:832
  s_waitcnt lgkmcnt(1)
  v_mfma_f32_32x32x16_bf16 v[176:191], v[116:119], v[8:11], v[176:191]
  ds_read_b128 v[8:11], v3 offset:864
  s_waitcnt lgkmcnt(1)
  v_mfma_f32_32x32x16_bf16 v[176:191], v[120:123], v[4:7], v[176:191]
  ds_read_b128 v[4:7], v3 offset:896
  s_waitcnt lgkmcnt(1)
  v_mfma_f32_32x32x16_bf16 v[176:191], v[124:127], v[8:11], v[176:191]
  ds_read_b128 v[8:11], v3 offset:928
  s_waitcnt lgkmcnt(1)
  v_mfma_f32_32x32x16_bf16 v[176:191], v[128:131], v[4:7], v[176:191]
  ds_read_b128 v[4:7], v3 offset:960
  s_waitcnt lgkmcnt(1)
  v_mfma_f32_32x32x16_bf16 v[176:191], v[132:135], v[8:11], v[176:191]
  ds_read_b128 v[8:11], v3 offset:992
  s_waitcnt lgkmcnt(1)
  v_mfma_f32_32x32x16_bf16 v[176:191], v[136:139], v[4:7], v[176:191]
  ds_read_b128 v[4:7], v3 offset:1024
  s_waitcnt lgkmcnt(1)
  v_mfma_f32_32x32x16_bf16 v[176:191], v[140:143], v[8:11], v[176:191]
  ds_read_b128 v[8:11], v3 offset:1056
  s_waitcnt lgkmcnt(1)
  v_mfma_f32_32x32x16_bf16 v[176:191], v[144:147], v[4:7], v[176:191]
  ds_read_b128 v[4:7], v3 offset:1088
  s_waitcnt lgkmcnt(1)
  v_mfma_f32_32x32x16_bf16 v[176:191], v[148:151], v[8:11], v[176:191]
  ds_read_b128 v[8:11], v3 offset:1120
  s_waitcnt lgkmcnt(1)
  v_mfma_f32_32x32x16_bf16 v[176:191], v[152:155], v[4:7], v[176:191]
  ds_read_b128 v[4:7], v3 offset:1152
  s_waitcnt lgkmcnt(1)
  v_mfma_f32_32x32x16_bf16 v[176:191], v[156:159], v[8:11], v[176:191]
  ds_read_b128 v[8:11], v3 offset:1184
  s_waitcnt lgkmcnt(1)
  v_mfma_f32_32x32x16_bf16 v[176:191], v[160:163], v[4:7], v[176:191]
  ds_read_b128 v[4:7], v3 offset:1216
  s_waitcnt lgkmcnt(1)
  v_mfma_f32_32x32x16_bf16 v[176:191], v[164:167], v[8:11], v[176:191]
  ds_read_b128 v[8:11], v3 offset:1248
  s_waitcnt lgkmcnt(1)
  v_mfma_f32_32x32x16_bf16 v[176:191], v[168:171], v[4:7], v[176:191]
  s_waitcnt lgkmcnt(0)
  v_mfma_f32_32x32x16_bf16 v[176:191], v[172:175], v[8:11], v[176:191]
  s_branch mpd_138
mpv_137:
  ds_read_b128 v[4:7], v3
  ds_read_b128 v[8:11], v3 offset:32
  s_waitcnt lgkmcnt(1)
  v_mfma_f32_32x32x16_bf16 v[176:191], v[4:7], v[16:19], 0
  ds_read_b128 v[4:7], v3 offset:64
  s_waitcnt lgkmcnt(1)
  v_mfma_f32_32x32x16_bf16 v[176:191], v[8:11], v[20:23], v[176:191]
  ds_read_b128 v[8:11], v3 offset:96
  s_waitcnt lgkmcnt(1)
  v_mfma_f32_32x32x16_bf16 v[176:191], v[4:7], v[24:27], v[176:191]
  ds_read_b128 v[4:7], v3 offset:128
  s_waitcnt lgkmcnt(1)
  v_mfma_f32_32x32x16_bf16 v[176:191], v[8:11], v[28:31], v[176:191]
  ds_read_b128 v[8:11], v3 offset:160
  s_waitcnt lgkmcnt(1)
  v_mfma_f32_32x32x16_bf16 v[176:191], v[4:7], v[32:35], v[176:191]
  ds_read_b128 v[4:7], v3 offset:192
  s_waitcnt lgkmcnt(1)
  v_mfma_f32_32x32x16_bf16 v[176:191], v[8:11], v[36:39], v[176:191]
  ds_read_b128 v[8:11], v3 offset:224
  s_waitcnt lgkmcnt(1)
  v_mfma_f32_32x32x16_bf16 v[176:191], v[4:7], v[40:43], v[176:191]
  ds_read_b128 v[4:7], v3 offset:256
  s_waitcnt lgkmcnt(1)
  v_mfma_f32_32x32x16_bf16 v[176:191], v[8:11], v[44:47], v[176:191]
  ds_read_b128 v[8:11], v3 offset:288
  s_waitcnt lgkmcnt(1)
  v_mfma_f32_32x32x16_bf16 v[176:191], v[4:7], v[48:51], v[176:191]
  ds_read_b128 v[4:7], v3 offset:320
  s_waitcnt lgkmcnt(1)
  v_mfma_f32_32x32x16_bf16 v[176:191], v[8:11], v[52:55], v[176:191]
  ds_read_b128 v[8:11], v3 offset:352
  s_waitcnt lgkmcnt(1)
  v_mfma_f32_32x32x16_bf16 v[176:191], v[4:7], v[56:59], v[176:191]
  ds_read_b128 v[4:7], v3 offset:384
  s_waitcnt lgkmcnt(1)
  v_mfma_f32_32x32x16_bf16 v[176:191], v[8:11], v[60:63], v[176:191]
  ds_read_b128 v[8:11], v3 offset:416
  s_waitcnt lgkmcnt(1)
  v_mfma_f32_32x32x16_bf16 v[176:191], v[4:7], v[64:67], v[176:191]
  ds_read_b128 v[4:7], v3 offset:448
  s_waitcnt lgkmcnt(1)
  v_mfma_f32_32x32x16_bf16 v[176:191], v[8:11], v[68:71], v[176:191]
  ds_read_b128 v[8:11], v3 offset:480
  s_waitcnt lgkmcnt(1)
  v_mfma_f32_32x32x16_bf16 v[176:191], v[4:7], v[72:75], v[176:191]
  ds_read_b128 v[4:7], v3 offset:512
  s_waitcnt lgkmcnt(1)
  v_mfma_f32_32x32x16_bf16 v[176:191], v[8:11], v[76:79], v[176:191]
  ds_read_b128 v[8:11], v3 offset:544
  s_waitcnt lgkmcnt(1)
  v_mfma_f32_32x32x16_bf16 v[176:191], v[4:7], v[80:83], v[176:191]
  ds_read_b128 v[4:7], v3 offset:576
  s_waitcnt lgkmcnt(1)
  v_mfma_f32_32x32x16_bf16 v[176:191], v[8:11], v[84:87], v[176:191]
  ds_read_b128 v[8:11], v3 offset:608
  s_waitcnt lgkmcnt(1)
  v_mfma_f32_32x32x16_bf16 v[176:191], v[4:7], v[88:91], v[176:191]
  ds_read_b128 v[4:7], v3 offset:640
  s_waitcnt lgkmcnt(1)
  v_mfma_f32_32x32x16_bf16 v[176:191], v[8:11], v[92:95], v[176:191]
  ds_read_b128 v[8:11], v3 offset:672
  s_waitcnt lgkmcnt(1)
  v_mfma_f32_32x32x16_bf16 v[176:191], v[4:7], v[96:99], v[176:191]
  ds_read_b128 v[4:7], v3 offset:704
  s_waitcnt lgkmcnt(1)
  v_mfma_f32_32x32x16_bf16 v[176:191], v[8:11], v[100:103], v[176:191]
  ds_read_b128 v[8:11], v3 offset:736
  s_waitcnt lgkmcnt(1)
  v_mfma_f32_32x32x16_bf16 v[176:191], v[4:7], v[104:107], v[176:191]
  ds_read_b128 v[4:7], v3 offset:768
  s_waitcnt lgkmcnt(1)
  v_mfma_f32_32x32x16_bf16 v[176:191], v[8:11], v[108:111], v[176:191]
  ds_read_b128 v[8:11], v3 offset:800
  s_waitcnt lgkmcnt(1)
  v_mfma_f32_32x32x16_bf16 v[176:191], v[4:7], v[112:115], v[176:191]
  ds_read_b128 v[4:7], v3 offset:832
  s_waitcnt lgkmcnt(1)
  v_mfma_f32_32x32x16_bf16 v[176:191], v[8:11], v[116:119], v[176:191]
  ds_read_b128 v[8:11], v3 offset:864
  s_waitcnt lgkmcnt(1)
  v_mfma_f32_32x32x16_bf16 v[176:191], v[4:7], v[120:123], v[176:191]
  ds_read_b128 v[4:7], v3 offset:896
  s_waitcnt lgkmcnt(1)
  v_mfma_f32_32x32x16_bf16 v[176:191], v[8:11], v[124:127], v[176:191]
  ds_read_b128 v[8:11], v3 offset:928
  s_waitcnt lgkmcnt(1)
  v_mfma_f32_32x32x16_bf16 v[176:191], v[4:7], v[128:131], v[176:191]
  ds_read_b128 v[4:7], v3 offset:960
  s_waitcnt lgkmcnt(1)
  v_mfma_f32_32x32x16_bf16 v[176:191], v[8:11], v[132:135], v[176:191]
  ds_read_b128 v[8:11], v3 offset:992
  s_waitcnt lgkmcnt(1)
  v_mfma_f32_32x32x16_bf16 v[176:191], v[4:7], v[136:139], v[176:191]
  ds_read_b128 v[4:7], v3 offset:1024
  s_waitcnt lgkmcnt(1)
  v_mfma_f32_32x32x16_bf16 v[176:191], v[8:11], v[140:143], v[176:191]
  ds_read_b128 v[8:11], v3 offset:1056
  s_waitcnt lgkmcnt(1)
  v_mfma_f32_32x32x16_bf16 v[176:191], v[4:7], v[144:147], v[176:191]
  ds_read_b128 v[4:7], v3 offset:1088
  s_waitcnt lgkmcnt(1)
  v_mfma_f32_32x32x16_bf16 v[176:191], v[8:11], v[148:151], v[176:191]
  ds_read_b128 v[8:11], v3 offset:1120
  s_waitcnt lgkmcnt(1)
  v_mfma_f32_32x32x16_bf16 v[176:191], v[4:7], v[152:155], v[176:191]
  ds_read_b128 v[4:7], v3 offset:1152
  s_waitcnt lgkmcnt(1)
  v_mfma_f32_32x32x16_bf16 v[176:191], v[8:11], v[156:159], v[176:191]
  ds_read_b128 v[8:11], v3 offset:1184
  s_waitcnt lgkmcnt(1)
  v_mfma_f32_32x32x16_bf16 v[176:191], v[4:7], v[160:163], v[176:191]
  ds_read_b128 v[4:7], v3 offset:1216
  s_waitcnt lgkmcnt(1)
  v_mfma_f32_32x32x16_bf16 v[176:191], v[8:11], v[164:167], v[176:191]
  ds_read_b128 v[8:11], v3 offset:1248
  s_waitcnt lgkmcnt(1)
  v_mfma_f32_32x32x16_bf16 v[176:191], v[4:7], v[168:171], v[176:191]
  s_waitcnt lgkmcnt(0)
  v_mfma_f32_32x32x16_bf16 v[176:191], v[8:11], v[172:175], v[176:191]
mpd_138:
  s_lshl_b32 s34, s42, 13
  s_and_b32 s35, s30, 3
  v_lshrrev_b32 v10, 5, v1
  v_and_b32 v11, 15, v1
  v_lshl_add_u32 v11, v10, 4, v11
  v_lshlrev_b32 v11, 4, v11
  v_bfe_u32 v10, v1, 4, 1
  s_lshr_b32 s36, s30, 2
  s_sub_u32 s36, 2, s36
  s_lshl_b32 s36, s36, 18
  s_lshl_b32 s37, s43, 24
  s_add_u32 s36, s36, s37
  s_cmp_eq_u32 s43, 2
  s_cbranch_scc1 L_mp_vo1
  s_lshl_b32 s35, s35, 10
  v_lshl_add_u32 v11, v10, 12, v11
  v_cvt_pk_bf16_f32 v176, v176, v177
  v_cvt_pk_bf16_f32 v177, v178, v179
  v_cvt_pk_bf16_f32 v178, v180, v181
  v_cvt_pk_bf16_f32 v179, v182, v183
  v_cvt_pk_bf16_f32 v180, v184, v185
  v_cvt_pk_bf16_f32 v181, v186, v187
  v_cvt_pk_bf16_f32 v182, v188, v189
  v_cvt_pk_bf16_f32 v183, v190, v191
  s_branch L_mp_so1
L_mp_vo1:
  s_lshl_b32 s35, s35, 11
  v_lshl_add_u32 v11, v10, 10, v11
  v_cvt_pk_bf16_f32 v176, v176, v177
  v_cvt_pk_bf16_f32 v177, v178, v179
  v_cvt_pk_bf16_f32 v178, v184, v185
  v_cvt_pk_bf16_f32 v179, v186, v187
  v_cvt_pk_bf16_f32 v180, v180, v181
  v_cvt_pk_bf16_f32 v181, v182, v183
  v_cvt_pk_bf16_f32 v182, v188, v189
  v_cvt_pk_bf16_f32 v183, v190, v191
L_mp_so1:
  s_add_u32 s34, s34, s35
  v_add_u32 v11, s34, v11
  buffer_store_dwordx4 v[176:179], v11, s[8:11], s36 offen sc1
  buffer_store_dwordx4 v[180:183], v11, s[8:11], s36 offen offset:512 sc1
  s_waitcnt vmcnt(0)
  s_barrier
  s_cmp_lg_u32 s30, 0
  s_cbranch_scc1 mpf_139
  s_lshl_b32 s34, s44, 2
  s_add_u32 s34, s34, 1024
  s_add_u32 s34, s34, s100
  v_mov_b32 v10, s34
  v_mov_b32 v11, 3
  s_mov_b64 exec, 1
  buffer_store_dword v11, v10, s[8:11], 0 offen sc1
  s_mov_b64 exec, -1
mpf_139:
  s_barrier
L_o_nomini:
  s_cmp_ge_u32 s41, 20
  s_cselect_b32 s43, 1, 0
  s_mul_i32 s34, s43, 20
  s_sub_u32 s42, s41, s34
  s_load_dwordx2 s[4:5], s[0:1], 40
  s_load_dwordx2 s[6:7], s[0:1], 80
  s_waitcnt lgkmcnt(0)
  s_mov_b32 s16, s4
  s_and_b32 s17, s5, 0xffff
  s_mov_b32 s18, 0x500000
  s_mov_b32 s19, 0x20000
  s_mov_b32 s20, s6
  s_and_b32 s21, s7, 0xffff
  s_mov_b32 s22, 0x500000
  s_mov_b32 s23, 0x20000
  v_lshrrev_b32 v10, 2, v1
  v_and_b32 v11, 3, v1
  v_mul_u32_u24 v12, 1280, v10
  v_lshl_add_u32 v12, v11, 4, v12
  s_lshl_b32 s34, s30, 9
  s_mul_i32 s34, s34, 1280
  s_lshl_b32 s35, s42, 6
  s_add_u32 s34, s34, s35
  v_add_u32 v12, s34, v12
  s_lshl_b32 s34, s30, 13
  v_lshl_add_u32 v13, v1, 4, s34
  v_lshrrev_b32 v10, 4, v1
  v_bfe_u32 v11, v1, 2, 2
  v_lshl_add_u32 v10, v10, 2, v11
  v_lshlrev_b32 v10, 6, v10
  v_and_b32 v11, 3, v1
  v_lshl_add_u32 v10, v11, 3, v10
  v_add_u32 v14, s34, v10
  s_mov_b32 s34, 0
  buffer_load_dwordx4 v[144:147], v12, s[16:19], s34 offen
  s_mov_b32 s34, 20480
  buffer_load_dwordx4 v[148:151], v12, s[16:19], s34 offen
  s_mov_b32 s34, 40960
  buffer_load_dwordx4 v[152:155], v12, s[16:19], s34 offen
  s_mov_b32 s34, 61440
  buffer_load_dwordx4 v[156:159], v12, s[16:19], s34 offen
  s_mov_b32 s34, 81920
  buffer_load_dwordx4 v[160:163], v12, s[16:19], s34 offen
  s_mov_b32 s34, 102400
  buffer_load_dwordx4 v[164:167], v12, s[16:19], s34 offen
  s_mov_b32 s34, 122880
  buffer_load_dwordx4 v[168:171], v12, s[16:19], s34 offen
  s_mov_b32 s34, 143360
  buffer_load_dwordx4 v[172:175], v12, s[16:19], s34 offen
  s_mov_b32 s34, 163840
  buffer_load_dwordx4 v[176:179], v12, s[16:19], s34 offen
  s_mov_b32 s34, 184320
  buffer_load_dwordx4 v[180:183], v12, s[16:19], s34 offen
  s_mov_b32 s34, 204800
  buffer_load_dwordx4 v[184:187], v12, s[16:19], s34 offen
  s_mov_b32 s34, 225280
  buffer_load_dwordx4 v[188:191], v12, s[16:19], s34 offen
  s_mov_b32 s34, 245760
  buffer_load_dwordx4 v[192:195], v12, s[16:19], s34 offen
  s_mov_b32 s34, 266240
  buffer_load_dwordx4 v[196:199], v12, s[16:19], s34 offen
  s_mov_b32 s34, 286720
  buffer_load_dwordx4 v[200:203], v12, s[16:19], s34 offen
  s_mov_b32 s34, 307200
  buffer_load_dwordx4 v[204:207], v12, s[16:19], s34 offen
  s_waitcnt vmcnt(8)
  ds_write_b128 v13, v[144:147] offset:0
  ds_write_b128 v13, v[148:151] offset:1024
  ds_write_b128 v13, v[152:155] offset:2048
  ds_write_b128 v13, v[156:159] offset:3072
  ds_write_b128 v13, v[160:163] offset:4096
  ds_write_b128 v13, v[164:167] offset:5120
  ds_write_b128 v13, v[168:171] offset:6144
  ds_write_b128 v13, v[172:175] offset:7168
  s_waitcnt lgkmcnt(0)
  s_mov_b32 s34, 327680
  buffer_load_dwordx4 v[144:147], v12, s[16:19], s34 offen
  s_mov_b32 s34, 348160
  buffer_load_dwordx4 v[148:151], v12, s[16:19], s34 offen
  s_mov_b32 s34, 368640
  buffer_load_dwordx4 v[152:155], v12, s[16:19], s34 offen
  s_mov_b32 s34, 389120
  buffer_load_dwordx4 v[156:159], v12, s[16:19], s34 offen
  s_mov_b32 s34, 409600
  buffer_load_dwordx4 v[160:163], v12, s[16:19], s34 offen
  s_mov_b32 s34, 430080
  buffer_load_dwordx4 v[164:167], v12, s[16:19], s34 offen
  s_mov_b32 s34, 450560
  buffer_load_dwordx4 v[168:171], v12, s[16:19], s34 offen
  s_mov_b32 s34, 471040
  buffer_load_dwordx4 v[172:175], v12, s[16:19], s34 offen
  ds_read_b64_tr_b16 v[16:17], v14 offset:0
  ds_read_b64_tr_b16 v[18:19], v14 offset:1024
  ds_read_b64_tr_b16 v[20:21], v14 offset:2048
  ds_read_b64_tr_b16 v[22:23], v14 offset:3072
  ds_read_b64_tr_b16 v[24:25], v14 offset:4096
  ds_read_b64_tr_b16 v[26:27], v14 offset:5120
  ds_read_b64_tr_b16 v[28:29], v14 offset:6144
  ds_read_b64_tr_b16 v[30:31], v14 offset:7168
  s_waitcnt lgkmcnt(0)
  ds_read_b64_tr_b16 v[80:81], v14 offset:32
  ds_read_b64_tr_b16 v[82:83], v14 offset:1056
  ds_read_b64_tr_b16 v[84:85], v14 offset:2080
  ds_read_b64_tr_b16 v[86:87], v14 offset:3104
  ds_read_b64_tr_b16 v[88:89], v14 offset:4128
  ds_read_b64_tr_b16 v[90:91], v14 offset:5152
  ds_read_b64_tr_b16 v[92:93], v14 offset:6176
  ds_read_b64_tr_b16 v[94:95], v14 offset:7200
  s_waitcnt lgkmcnt(0)
  s_waitcnt vmcnt(8)
  ds_write_b128 v13, v[176:179] offset:0
  ds_write_b128 v13, v[180:183] offset:1024
  ds_write_b128 v13, v[184:187] offset:2048
  ds_write_b128 v13, v[188:191] offset:3072
  ds_write_b128 v13, v[192:195] offset:4096
  ds_write_b128 v13, v[196:199] offset:5120
  ds_write_b128 v13, v[200:203] offset:6144
  ds_write_b128 v13, v[204:207] offset:7168
  s_waitcnt lgkmcnt(0)
  s_mov_b32 s34, 491520
  buffer_load_dwordx4 v[176:179], v12, s[16:19], s34 offen
  s_mov_b32 s34, 512000
  buffer_load_dwordx4 v[180:183], v12, s[16:19], s34 offen
  s_mov_b32 s34, 532480
  buffer_load_dwordx4 v[184:187], v12, s[16:19], s34 offen
  s_mov_b32 s34, 552960
  buffer_load_dwordx4 v[188:191], v12, s[16:19], s34 offen
  s_mov_b32 s34, 573440
  buffer_load_dwordx4 v[192:195], v12, s[16:19], s34 offen
  s_mov_b32 s34, 593920
  buffer_load_dwordx4 v[196:199], v12, s[16:19], s34 offen
  s_mov_b32 s34, 614400
  buffer_load_dwordx4 v[200:203], v12, s[16:19], s34 offen
  s_mov_b32 s34, 634880
  buffer_load_dwordx4 v[204:207], v12, s[16:19], s34 offen
  ds_read_b64_tr_b16 v[32:33], v14 offset:0
  ds_read_b64_tr_b16 v[34:35], v14 offset:1024
  ds_read_b64_tr_b16 v[36:37], v14 offset:2048
  ds_read_b64_tr_b16 v[38:39], v14 offset:3072
  ds_read_b64_tr_b16 v[40:41], v14 offset:4096
  ds_read_b64_tr_b16 v[42:43], v14 offset:5120
  ds_read_b64_tr_b16 v[44:45], v14 offset:6144
  ds_read_b64_tr_b16 v[46:47], v14 offset:7168
  s_waitcnt lgkmcnt(0)
  ds_read_b64_tr_b16 v[96:97], v14 offset:32
  ds_read_b64_tr_b16 v[98:99], v14 offset:1056
  ds_read_b64_tr_b16 v[100:101], v14 offset:2080
  ds_read_b64_tr_b16 v[102:103], v14 offset:3104
  ds_read_b64_tr_b16 v[104:105], v14 offset:4128
  ds_read_b64_tr_b16 v[106:107], v14 offset:5152
  ds_read_b64_tr_b16 v[108:109], v14 offset:6176
  ds_read_b64_tr_b16 v[110:111], v14 offset:7200
  s_waitcnt lgkmcnt(0)
  s_waitcnt vmcnt(8)
  ds_write_b128 v13, v[144:147] offset:0
  ds_write_b128 v13, v[148:151] offset:1024
  ds_write_b128 v13, v[152:155] offset:2048
  ds_write_b128 v13, v[156:159] offset:3072
  ds_write_b128 v13, v[160:163] offset:4096
  ds_write_b128 v13, v[164:167] offset:5120
  ds_write_b128 v13, v[168:171] offset:6144
  ds_write_b128 v13, v[172:175] offset:7168
  s_waitcnt lgkmcnt(0)
  ds_read_b64_tr_b16 v[48:49], v14 offset:0
  ds_read_b64_tr_b16 v[50:51], v14 offset:1024
  ds_read_b64_tr_b16 v[52:53], v14 offset:2048
  ds_read_b64_tr_b16 v[54:55], v14 offset:3072
  ds_read_b64_tr_b16 v[56:57], v14 offset:4096
  ds_read_b64_tr_b16 v[58:59], v14 offset:5120
  ds_read_b64_tr_b16 v[60:61], v14 offset:6144
  ds_read_b64_tr_b16 v[62:63], v14 offset:7168
  s_waitcnt lgkmcnt(0)
  ds_read_b64_tr_b16 v[112:113], v14 offset:32
  ds_read_b64_tr_b16 v[114:115], v14 offset:1056
  ds_read_b64_tr_b16 v[116:117], v14 offset:2080
  ds_read_b64_tr_b16 v[118:119], v14 offset:3104
  ds_read_b64_tr_b16 v[120:121], v14 offset:4128
  ds_read_b64_tr_b16 v[122:123], v14 offset:5152
  ds_read_b64_tr_b16 v[124:125], v14 offset:6176
  ds_read_b64_tr_b16 v[126:127], v14 offset:7200
  s_waitcnt lgkmcnt(0)
  s_waitcnt vmcnt(0)
  ds_write_b128 v13, v[176:179] offset:0
  ds_write_b128 v13, v[180:183] offset:1024
  ds_write_b128 v13, v[184:187] offset:2048
  ds_write_b128 v13, v[188:191] offset:3072
  ds_write_b128 v13, v[192:195] offset:4096
  ds_write_b128 v13, v[196:199] offset:5120
  ds_write_b128 v13, v[200:203] offset:6144
  ds_write_b128 v13, v[204:207] offset:7168
  s_waitcnt lgkmcnt(0)
  ds_read_b64_tr_b16 v[64:65], v14 offset:0
  ds_read_b64_tr_b16 v[66:67], v14 offset:1024
  ds_read_b64_tr_b16 v[68:69], v14 offset:2048
  ds_read_b64_tr_b16 v[70:71], v14 offset:3072
  ds_read_b64_tr_b16 v[72:73], v14 offset:4096
  ds_read_b64_tr_b16 v[74:75], v14 offset:5120
  ds_read_b64_tr_b16 v[76:77], v14 offset:6144
  ds_read_b64_tr_b16 v[78:79], v14 offset:7168
  s_waitcnt lgkmcnt(0)
  ds_read_b64_tr_b16 v[128:129], v14 offset:32
  ds_read_b64_tr_b16 v[130:131], v14 offset:1056
  ds_read_b64_tr_b16 v[132:133], v14 offset:2080
  ds_read_b64_tr_b16 v[134:135], v14 offset:3104
  ds_read_b64_tr_b16 v[136:137], v14 offset:4128
  ds_read_b64_tr_b16 v[138:139], v14 offset:5152
  ds_read_b64_tr_b16 v[140:141], v14 offset:6176
  ds_read_b64_tr_b16 v[142:143], v14 offset:7200
  s_waitcnt lgkmcnt(0)
  s_barrier
  v_lshlrev_b32 v2, 4, v1
  s_lshl_b32 s34, s30, 15
  s_lshl_b32 s35, s43, 12
  s_add_u32 s34, s34, s35
  v_add_u32 v3, s34, v2
  s_lshl_b32 s34, s30, 11
  v_add_u32 v6, s34, v2
  v_lshrrev_b32 v10, 2, v1
  v_and_b32 v11, 3, v1
  v_lshrrev_b32 v12, 1, v11
  v_and_b32 v13, 1, v11
  v_lshlrev_b32 v13, 5, v13
  v_add_u32 v13, v13, v10
  v_lshlrev_b32 v13, 4, v13
  v_lshl_add_u32 v7, v12, 10, v13
  s_lshl_b32 s34, s43, 4
  v_add_u32 v10, s34, v10
  v_mul_u32_u24 v10, 2560, v10
  v_lshl_add_u32 v10, v11, 4, v10
  s_lshl_b32 s34, s42, 6
  v_add_u32 v8, s34, v10
  s_mov_b32 s45, 1
  s_mov_b32 s46, 0
  s_mov_b32 s40, 0
  s_cmp_lg_u32 s31, 0
  s_cbranch_scc1 valok_142
  v_lshlrev_b32 v10, 2, v1
  s_mov_b32 s39, 0
val_140:
  buffer_load_dword v11, v10, s[12:15], 0 offen sc1
  s_waitcnt vmcnt(0)
  v_cmp_eq_u32 vcc, 32, v11
s_nop 3
  s_and_b32 s34, vcc_lo, vcc_hi
  s_and_b32 s34, s34, 0x5555
  s_cmp_eq_u32 s34, 0x5555
  s_cbranch_scc0 valg_141_s
  v_readlane_b32 s32, v11, 1
  s_mov_b32 s34, 0
  s_cmp_eq_u32 s34, 0
  s_cbranch_scc1 valg_141
valg_141_s:
  s_mov_b32 s36, 0
  s_mov_b32 s37, 0
  s_mov_b32 s38, 0
  s_mov_b32 s34, 0
  v_readlane_b32 s35, v11, 2
s_nop 3
  s_add_u32 s38, s38, s35
  v_readlane_b32 s35, v11, 0
s_nop 3
  s_add_u32 s36, s36, s35
  s_cmp_eq_u32 s35, 32
  s_cselect_b32 s97, 0, 1
  s_or_b32 s34, s34, s97
  s_cmp_gt_u32 s98, 0
  s_cselect_b32 s35, s35, 0
  s_add_u32 s37, s37, s35
  v_readlane_b32 s35, v11, 6
s_nop 3
  s_add_u32 s38, s38, s35
  v_readlane_b32 s35, v11, 4
s_nop 3
  s_add_u32 s36, s36, s35
  s_cmp_eq_u32 s35, 32
  s_cselect_b32 s97, 0, 1
  s_or_b32 s34, s34, s97
  s_cmp_gt_u32 s98, 1
  s_cselect_b32 s35, s35, 0
  s_add_u32 s37, s37, s35
  v_readlane_b32 s35, v11, 10
s_nop 3
  s_add_u32 s38, s38, s35
  v_readlane_b32 s35, v11, 8
s_nop 3
  s_add_u32 s36, s36, s35
  s_cmp_eq_u32 s35, 32
  s_cselect_b32 s97, 0, 1
  s_or_b32 s34, s34, s97
  s_cmp_gt_u32 s98, 2
  s_cselect_b32 s35, s35, 0
  s_add_u32 s37, s37, s35
  v_readlane_b32 s35, v11, 14
s_nop 3
  s_add_u32 s38, s38, s35
  v_readlane_b32 s35, v11, 12
s_nop 3
  s_add_u32 s36, s36, s35
  s_cmp_eq_u32 s35, 32
  s_cselect_b32 s97, 0, 1
  s_or_b32 s34, s34, s97
  s_cmp_gt_u32 s98, 3
  s_cselect_b32 s35, s35, 0
  s_add_u32 s37, s37, s35
  v_readlane_b32 s35, v11, 34
s_nop 3
  s_add_u32 s38, s38, s35
  v_readlane_b32 s35, v11, 32
s_nop 3
  s_add_u32 s36, s36, s35
  s_cmp_eq_u32 s35, 32
  s_cselect_b32 s97, 0, 1
  s_or_b32 s34, s34, s97
  s_cmp_gt_u32 s98, 4
  s_cselect_b32 s35, s35, 0
  s_add_u32 s37, s37, s35
  v_readlane_b32 s35, v11, 38
s_nop 3
  s_add_u32 s38, s38, s35
  v_readlane_b32 s35, v11, 36
s_nop 3
  s_add_u32 s36, s36, s35
  s_cmp_eq_u32 s35, 32
  s_cselect_b32 s97, 0, 1
  s_or_b32 s34, s34, s97
  s_cmp_gt_u32 s98, 5
  s_cselect_b32 s35, s35, 0
  s_add_u32 s37, s37, s35
  v_readlane_b32 s35, v11, 42
s_nop 3
  s_add_u32 s38, s38, s35
  v_readlane_b32 s35, v11, 40
s_nop 3
  s_add_u32 s36, s36, s35
  s_cmp_eq_u32 s35, 32
  s_cselect_b32 s97, 0, 1
  s_or_b32 s34, s34, s97
  s_cmp_gt_u32 s98, 6
  s_cselect_b32 s35, s35, 0
  s_add_u32 s37, s37, s35
  v_readlane_b32 s35, v11, 46
s_nop 3
  s_add_u32 s38, s38, s35
  v_readlane_b32 s35, v11, 44
s_nop 3
  s_add_u32 s36, s36, s35
  s_cmp_eq_u32 s35, 32
  s_cselect_b32 s97, 0, 1
  s_or_b32 s34, s34, s97
  s_cmp_gt_u32 s98, 7
  s_cselect_b32 s35, s35, 0
  s_add_u32 s37, s37, s35
  v_readlane_b32 s35, v11, 18
s_nop 3
  s_add_u32 s38, s38, s35
  v_readlane_b32 s35, v11, 16
s_nop 3
  s_add_u32 s36, s36, s35
  s_cmp_eq_u32 s35, 0
  s_cselect_b32 s97, 0, 1
  s_or_b32 s34, s34, s97
  s_cmp_gt_u32 s98, 8
  s_cselect_b32 s35, s35, 0
  s_add_u32 s37, s37, s35
  v_readlane_b32 s35, v11, 22
s_nop 3
  s_add_u32 s38, s38, s35
  v_readlane_b32 s35, v11, 20
s_nop 3
  s_add_u32 s36, s36, s35
  s_cmp_eq_u32 s35, 0
  s_cselect_b32 s97, 0, 1
  s_or_b32 s34, s34, s97
  s_cmp_gt_u32 s98, 9
  s_cselect_b32 s35, s35, 0
  s_add_u32 s37, s37, s35
  v_readlane_b32 s35, v11, 26
s_nop 3
  s_add_u32 s38, s38, s35
  v_readlane_b32 s35, v11, 24
s_nop 3
  s_add_u32 s36, s36, s35
  s_cmp_eq_u32 s35, 0
  s_cselect_b32 s97, 0, 1
  s_or_b32 s34, s34, s97
  s_cmp_gt_u32 s98, 10
  s_cselect_b32 s35, s35, 0
  s_add_u32 s37, s37, s35
  v_readlane_b32 s35, v11, 30
s_nop 3
  s_add_u32 s38, s38, s35
  v_readlane_b32 s35, v11, 28
s_nop 3
  s_add_u32 s36, s36, s35
  s_cmp_eq_u32 s35, 0
  s_cselect_b32 s97, 0, 1
  s_or_b32 s34, s34, s97
  s_cmp_gt_u32 s98, 11
  s_cselect_b32 s35, s35, 0
  s_add_u32 s37, s37, s35
  v_readlane_b32 s35, v11, 50
s_nop 3
  s_add_u32 s38, s38, s35
  v_readlane_b32 s35, v11, 48
s_nop 3
  s_add_u32 s36, s36, s35
  s_cmp_eq_u32 s35, 0
  s_cselect_b32 s97, 0, 1
  s_or_b32 s34, s34, s97
  s_cmp_gt_u32 s98, 12
  s_cselect_b32 s35, s35, 0
  s_add_u32 s37, s37, s35
  v_readlane_b32 s35, v11, 54
s_nop 3
  s_add_u32 s38, s38, s35
  v_readlane_b32 s35, v11, 52
s_nop 3
  s_add_u32 s36, s36, s35
  s_cmp_eq_u32 s35, 0
  s_cselect_b32 s97, 0, 1
  s_or_b32 s34, s34, s97
  s_cmp_gt_u32 s98, 13
  s_cselect_b32 s35, s35, 0
  s_add_u32 s37, s37, s35
  v_readlane_b32 s35, v11, 58
s_nop 3
  s_add_u32 s38, s38, s35
  v_readlane_b32 s35, v11, 56
s_nop 3
  s_add_u32 s36, s36, s35
  s_cmp_eq_u32 s35, 0
  s_cselect_b32 s97, 0, 1
  s_or_b32 s34, s34, s97
  s_cmp_gt_u32 s98, 14
  s_cselect_b32 s35, s35, 0
  s_add_u32 s37, s37, s35
  v_readlane_b32 s35, v11, 62
s_nop 3
  s_add_u32 s38, s38, s35
  v_readlane_b32 s35, v11, 60
s_nop 3
  s_add_u32 s36, s36, s35
  s_cmp_eq_u32 s35, 0
  s_cselect_b32 s97, 0, 1
  s_or_b32 s34, s34, s97
  s_cmp_gt_u32 s98, 15
  s_cselect_b32 s35, s35, 0
  s_add_u32 s37, s37, s35
  v_readlane_b32 s32, v11, 1
  s_cmp_eq_u32 s36, 256
  s_cselect_b32 s35, s38, 0
  s_cmp_eq_u32 s35, 256
  s_cbranch_scc1 valg_141
  s_sleep 2
  s_add_u32 s39, s39, 1
  s_cmp_lt_u32 s39, s33
  s_cbranch_scc1 val_140
  s_mov_b32 s33, 0
valg_141:
s_nop 0
  s_and_b32 s32, s32, 2
  s_lshl_b32 s32, s32, 12
  s_cmp_eq_u32 s34, 0
  s_cbranch_scc1 valok_142
  s_mov_b32 s31, 1
  s_mov_b32 s32, 0
  s_add_u32 s37, s37, s99
  s_and_b32 s37, s37, 255
  s_lshr_b32 s28, s37, 5
  s_and_b32 s29, s37, 31
  s_barrier
  s_branch L_dispatch
valok_142:
  s_cmp_lg_u32 s31, 0
  s_cbranch_scc1 pwd_144
  s_mov_b32 s39, 0
  v_mov_b32 v13, 4
pw_143:
  buffer_load_dword v12, v13, s[12:15], 0 offen sc1
  s_waitcnt vmcnt(0)
  v_readfirstlane_b32 s32, v12
s_nop 3
  s_cmp_lg_u32 s32, 0
  s_cbranch_scc1 pw_143_g
  s_sleep 2
  s_add_u32 s39, s39, 1
  s_cmp_lt_u32 s39, s33
  s_cbranch_scc1 pw_143
  s_mov_b32 s33, 0
pw_143_g:
  s_and_b32 s32, s32, 2
  s_lshl_b32 s32, s32, 12
pwd_144:
  s_xor_b32 s100, s32, 8192
  s_add_u32 s101, s100, 3817472
  s_add_u32 s100, s100, 3801088
  v_lshlrev_b32 v5, 2, v1
  v_add_u32 v5, s101, v5
L_out_seg:
  s_lshl_b32 s37, s40, 7
  s_cmp_lg_u32 s30, 7
  s_cbranch_scc1 L_out_go
  s_mov_b32 s39, 0
  s_mov_b64 s[70:71], exec
  s_mov_b32 exec_lo, 0xf
  s_mov_b32 exec_hi, 0x0
otw_145:
  buffer_load_dword v13, v5, s[8:11], s37 offen sc1
  s_waitcnt vmcnt(0)
  v_cmp_gt_u32 vcc, s45, v13
  s_cbranch_vccz otwd_146
  s_sleep 3
  s_add_u32 s39, s39, 1
  s_cmp_lt_u32 s39, s33
  s_cbranch_scc1 otw_145
  s_mov_b32 s33, 0
otwd_146:
  s_mov_b64 exec, s[70:71]
L_out_go:
  s_barrier
  s_lshl_b32 s34, s40, 18
  s_add_u32 s34, s34, 67108864
  s_add_u32 s35, s34, 0
  buffer_load_dwordx4 v[144:147], v3, s[8:11], s35 offen offset:0 sc1
  buffer_load_dwordx4 v[148:151], v3, s[8:11], s35 offen offset:1024 sc1
  buffer_load_dwordx4 v[152:155], v3, s[8:11], s35 offen offset:2048 sc1
  buffer_load_dwordx4 v[156:159], v3, s[8:11], s35 offen offset:3072 sc1
  s_add_u32 s35, s34, 8192
  buffer_load_dwordx4 v[160:163], v3, s[8:11], s35 offen offset:0 sc1
  buffer_load_dwordx4 v[164:167], v3, s[8:11], s35 offen offset:1024 sc1
  buffer_load_dwordx4 v[168:171], v3, s[8:11], s35 offen offset:2048 sc1
  buffer_load_dwordx4 v[172:175], v3, s[8:11], s35 offen offset:3072 sc1
  s_add_u32 s35, s34, 16384
  buffer_load_dwordx4 v[176:179], v3, s[8:11], s35 offen offset:0 sc1
  buffer_load_dwordx4 v[180:183], v3, s[8:11], s35 offen offset:1024 sc1
  buffer_load_dwordx4 v[184:187], v3, s[8:11], s35 offen offset:2048 sc1
  buffer_load_dwordx4 v[188:191], v3, s[8:11], s35 offen offset:3072 sc1
  s_add_u32 s35, s34, 24576
  buffer_load_dwordx4 v[192:195], v3, s[8:11], s35 offen offset:0 sc1
  buffer_load_dwordx4 v[196:199], v3, s[8:11], s35 offen offset:1024 sc1
  buffer_load_dwordx4 v[200:203], v3, s[8:11], s35 offen offset:2048 sc1
  buffer_load_dwordx4 v[204:207], v3, s[8:11], s35 offen offset:3072 sc1
  s_waitcnt vmcnt(12)
  v_mfma_f32_16x16x32_bf16 v[240:243], v[16:19], v[144:147], 0
  v_mfma_f32_16x16x32_bf16 v[244:247], v[80:83], v[144:147], 0
  v_mfma_f32_16x16x32_bf16 v[240:243], v[20:23], v[148:151], v[240:243]
  v_mfma_f32_16x16x32_bf16 v[244:247], v[84:87], v[148:151], v[244:247]
  v_mfma_f32_16x16x32_bf16 v[240:243], v[24:27], v[152:155], v[240:243]
  v_mfma_f32_16x16x32_bf16 v[244:247], v[88:91], v[152:155], v[244:247]
  v_mfma_f32_16x16x32_bf16 v[240:243], v[28:31], v[156:159], v[240:243]
  v_mfma_f32_16x16x32_bf16 v[244:247], v[92:95], v[156:159], v[244:247]
  s_waitcnt vmcnt(8)
  v_mfma_f32_16x16x32_bf16 v[240:243], v[32:35], v[160:163], v[240:243]
  v_mfma_f32_16x16x32_bf16 v[244:247], v[96:99], v[160:163], v[244:247]
  v_mfma_f32_16x16x32_bf16 v[240:243], v[36:39], v[164:167], v[240:243]
  v_mfma_f32_16x16x32_bf16 v[244:247], v[100:103], v[164:167], v[244:247]
  v_mfma_f32_16x16x32_bf16 v[240:243], v[40:43], v[168:171], v[240:243]
  v_mfma_f32_16x16x32_bf16 v[244:247], v[104:107], v[168:171], v[244:247]
  v_mfma_f32_16x16x32_bf16 v[240:243], v[44:47], v[172:175], v[240:243]
  v_mfma_f32_16x16x32_bf16 v[244:247], v[108:111], v[172:175], v[244:247]
  s_waitcnt vmcnt(4)
  v_mfma_f32_16x16x32_bf16 v[240:243], v[48:51], v[176:179], v[240:243]
  v_mfma_f32_16x16x32_bf16 v[244:247], v[112:115], v[176:179], v[244:247]
  v_mfma_f32_16x16x32_bf16 v[240:243], v[52:55], v[180:183], v[240:243]
  v_mfma_f32_16x16x32_bf16 v[244:247], v[116:119], v[180:183], v[244:247]
  v_mfma_f32_16x16x32_bf16 v[240:243], v[56:59], v[184:187], v[240:243]
  v_mfma_f32_16x16x32_bf16 v[244:247], v[120:123], v[184:187], v[244:247]
  v_mfma_f32_16x16x32_bf16 v[240:243], v[60:63], v[188:191], v[240:243]
  v_mfma_f32_16x16x32_bf16 v[244:247], v[124:127], v[188:191], v[244:247]
  s_waitcnt vmcnt(0)
  v_mfma_f32_16x16x32_bf16 v[240:243], v[64:67], v[192:195], v[240:243]
  v_mfma_f32_16x16x32_bf16 v[244:247], v[128:131], v[192:195], v[244:247]
  v_mfma_f32_16x16x32_bf16 v[240:243], v[68:71], v[196:199], v[240:243]
  v_mfma_f32_16x16x32_bf16 v[244:247], v[132:135], v[196:199], v[244:247]
  v_mfma_f32_16x16x32_bf16 v[240:243], v[72:75], v[200:203], v[240:243]
  v_mfma_f32_16x16x32_bf16 v[244:247], v[136:139], v[200:203], v[244:247]
  v_mfma_f32_16x16x32_bf16 v[240:243], v[76:79], v[204:207], v[240:243]
  v_mfma_f32_16x16x32_bf16 v[244:247], v[140:143], v[204:207], v[244:247]
  v_add_u32 v10, s46, v6
s_nop 5
  ds_write_b128 v10, v[240:243] offset:0
  ds_write_b128 v10, v[244:247] offset:1024
  s_waitcnt lgkmcnt(0)
  s_barrier
  s_cmp_ge_u32 s30, 1
  s_cbranch_scc1 L_out_nx
  v_add_u32 v10, s46, v7
  ds_read_b128 v[144:147], v10 offset:0
  ds_read_b128 v[148:151], v10 offset:2048
  ds_read_b128 v[152:155], v10 offset:4096
  ds_read_b128 v[156:159], v10 offset:6144
  ds_read_b128 v[160:163], v10 offset:8192
  ds_read_b128 v[164:167], v10 offset:10240
  ds_read_b128 v[168:171], v10 offset:12288
  ds_read_b128 v[172:175], v10 offset:14336
  s_waitcnt lgkmcnt(0)
  v_pk_add_f32 v[144:145], v[144:145], v[148:149]
  v_pk_add_f32 v[146:147], v[146:147], v[150:151]
  v_pk_add_f32 v[152:153], v[152:153], v[156:157]
  v_pk_add_f32 v[154:155], v[154:155], v[158:159]
  v_pk_add_f32 v[160:161], v[160:161], v[164:165]
  v_pk_add_f32 v[162:163], v[162:163], v[166:167]
  v_pk_add_f32 v[168:169], v[168:169], v[172:173]
  v_pk_add_f32 v[170:171], v[170:171], v[174:175]
  v_pk_add_f32 v[144:145], v[144:145], v[152:153]
  v_pk_add_f32 v[146:147], v[146:147], v[154:155]
  v_pk_add_f32 v[160:161], v[160:161], v[168:169]
  v_pk_add_f32 v[162:163], v[162:163], v[170:171]
  v_pk_add_f32 v[144:145], v[144:145], v[160:161]
  v_pk_add_f32 v[146:147], v[146:147], v[162:163]
  v_cvt_pk_bf16_f32 v224, v144, v145
  v_cvt_pk_bf16_f32 v225, v146, v147
  ds_read_b128 v[176:179], v10 offset:256
  ds_read_b128 v[180:183], v10 offset:2304
  ds_read_b128 v[184:187], v10 offset:4352
  ds_read_b128 v[188:191], v10 offset:6400
  ds_read_b128 v[192:195], v10 offset:8448
  ds_read_b128 v[196:199], v10 offset:10496
  ds_read_b128 v[200:203], v10 offset:12544
  ds_read_b128 v[204:207], v10 offset:14592
  s_waitcnt lgkmcnt(0)
  v_pk_add_f32 v[176:177], v[176:177], v[180:181]
  v_pk_add_f32 v[178:179], v[178:179], v[182:183]
  v_pk_add_f32 v[184:185], v[184:185], v[188:189]
  v_pk_add_f32 v[186:187], v[186:187], v[190:191]
  v_pk_add_f32 v[192:193], v[192:193], v[196:197]
  v_pk_add_f32 v[194:195], v[194:195], v[198:199]
  v_pk_add_f32 v[200:201], v[200:201], v[204:205]
  v_pk_add_f32 v[202:203], v[202:203], v[206:207]
  v_pk_add_f32 v[176:177], v[176:177], v[184:185]
  v_pk_add_f32 v[178:179], v[178:179], v[186:187]
  v_pk_add_f32 v[192:193], v[192:193], v[200:201]
  v_pk_add_f32 v[194:195], v[194:195], v[202:203]
  v_pk_add_f32 v[176:177], v[176:177], v[192:193]
  v_pk_add_f32 v[178:179], v[178:179], v[194:195]
  v_cvt_pk_bf16_f32 v226, v176, v177
  v_cvt_pk_bf16_f32 v227, v178, v179
  s_mul_i32 s34, s40, 81920
  buffer_store_dwordx4 v[224:227], v8, s[20:23], s34 offen nt
L_out_nx:
  s_xor_b32 s46, s46, 0x4000
  s_add_u32 s40, s40, 1
  s_cmp_lt_u32 s40, 64
  s_cbranch_scc1 L_out_seg
  s_branch L_end
L_brole:
  s_cmp_ge_u32 s41, 32
  s_cbranch_scc1 L_b_nomini
  s_lshr_b32 s42, s41, 1
  s_and_b32 s43, s41, 1
  s_add_u32 s43, s43, 1
  s_lshl_b32 s34, s43, 3
  s_add_u32 s34, s34, 16
  s_load_dwordx2 s[4:5], s[0:1], s34
  s_load_dwordx2 s[6:7], s[0:1], 0
  s_waitcnt lgkmcnt(0)
  s_mov_b32 s16, s4
  s_and_b32 s17, s5, 0xffff
  s_mov_b32 s18, 0x500000
  s_mov_b32 s19, 0x20000
  s_mov_b32 s20, s6
  s_and_b32 s21, s7, 0xffff
  s_mov_b32 s22, 0x280000
  s_mov_b32 s23, 0x20000
  v_lshlrev_b32 v2, 4, v0
  s_mov_b32 s34, 0
  buffer_load_dwordx4 v[136:139], v2, s[20:23], s34 offen
  s_mov_b32 s34, 8192
  buffer_load_dwordx4 v[140:143], v2, s[20:23], s34 offen
  s_mov_b32 s34, 16384
  buffer_load_dwordx4 v[144:147], v2, s[20:23], s34 offen
  s_mov_b32 s34, 24576
  buffer_load_dwordx4 v[148:151], v2, s[20:23], s34 offen
  s_mov_b32 s34, 32768
  buffer_load_dwordx4 v[152:155], v2, s[20:23], s34 offen
  v_lshrrev_b32 v10, 4, v0
  v_and_b32 v11, 15, v0
  v_lshlrev_b32 v12, 13, v10
  v_lshl_add_u32 v12, v11, 4, v12
  s_lshl_b32 s34, s42, 8
  v_add_u32 v12, s34, v12
  s_mov_b32 s34, 0
  buffer_load_dwordx4 v[176:179], v12, s[16:19], s34 offen
  s_mov_b32 s34, 262144
  buffer_load_dwordx4 v[180:183], v12, s[16:19], s34 offen
  s_mov_b32 s34, 524288
  buffer_load_dwordx4 v[184:187], v12, s[16:19], s34 offen
  s_mov_b32 s34, 786432
  buffer_load_dwordx4 v[188:191], v12, s[16:19], s34 offen
  s_mov_b32 s34, 1048576
  buffer_load_dwordx4 v[192:195], v12, s[16:19], s34 offen
  s_mov_b32 s34, 1310720
  buffer_load_dwordx4 v[196:199], v12, s[16:19], s34 offen
  s_mov_b32 s34, 1572864
  buffer_load_dwordx4 v[200:203], v12, s[16:19], s34 offen
  s_mov_b32 s34, 1835008
  buffer_load_dwordx4 v[204:207], v12, s[16:19], s34 offen
  s_mov_b32 s34, 2097152
  buffer_load_dwordx4 v[208:211], v12, s[16:19], s34 offen
  s_mov_b32 s34, 2359296
  buffer_load_dwordx4 v[212:215], v12, s[16:19], s34 offen
  s_mov_b32 s34, 2621440
  buffer_load_dwordx4 v[216:219], v12, s[16:19], s34 offen
  s_mov_b32 s34, 2883584
  buffer_load_dwordx4 v[220:223], v12, s[16:19], s34 offen
  s_mov_b32 s34, 3145728
  buffer_load_dwordx4 v[224:227], v12, s[16:19], s34 offen
  s_mov_b32 s34, 3407872
  buffer_load_dwordx4 v[228:231], v12, s[16:19], s34 offen
  s_mov_b32 s34, 3670016
  buffer_load_dwordx4 v[232:235], v12, s[16:19], s34 offen
  s_mov_b32 s34, 3932160
  buffer_load_dwordx4 v[236:239], v12, s[16:19], s34 offen
  s_mov_b32 s34, 4194304
  buffer_load_dwordx4 v[240:243], v12, s[16:19], s34 offen
  s_mov_b32 s34, 4456448
  buffer_load_dwordx4 v[244:247], v12, s[16:19], s34 offen
  s_mov_b32 s34, 4718592
  buffer_load_dwordx4 v[248:251], v12, s[16:19], s34 offen
  s_mov_b32 s34, 4980736
  buffer_load_dwordx4 v[252:255], v12, s[16:19], s34 offen
  s_mov_b32 s34, 40960
  buffer_load_dwordx4 v[156:159], v2, s[20:23], s34 offen
  s_mov_b32 s34, 49152
  buffer_load_dwordx4 v[160:163], v2, s[20:23], s34 offen
  s_mov_b32 s34, 57344
  buffer_load_dwordx4 v[164:167], v2, s[20:23], s34 offen
  s_mov_b32 s34, 65536
  buffer_load_dwordx4 v[168:171], v2, s[20:23], s34 offen
  s_mov_b32 s34, 73728
  buffer_load_dwordx4 v[172:175], v2, s[20:23], s34 offen
  v_and_b32 v13, 3, v10
  v_lshlrev_b32 v13, 1, v13
  v_bfe_u32 v14, v10, 3, 1
  v_add_u32 v13, v13, v14
  v_lshrrev_b32 v14, 1, v11
  v_add_u32 v13, v13, v14
  v_and_b32 v13, 7, v13
  v_lshlrev_b32 v13, 5, v13
  v_and_b32 v14, 1, v11
  v_lshl_add_u32 v13, v14, 4, v13
  v_lshl_add_u32 v13, v10, 8, v13
  v_add_u32 v13, 83968, v13
  v_lshrrev_b32 v10, 4, v1
  v_lshrrev_b32 v11, 1, v10
  v_and_b32 v10, 1, v10
  v_bfe_u32 v14, v1, 2, 2
  v_lshl_add_u32 v12, v11, 3, v14
  v_lshlrev_b32 v12, 8, v12
  v_lshl_add_u32 v10, v14, 1, v10
  v_add_u32 v10, v10, v11
  s_and_b32 s34, s30, 3
  s_lshl_b32 s34, s34, 1
  v_add_u32 v10, s34, v10
  v_and_b32 v10, 7, v10
  v_lshl_add_u32 v14, v10, 5, v12
  v_and_b32 v10, 3, v1
  v_lshl_add_u32 v14, v10, 3, v14
  v_add_u32 v14, 83968, v14
  v_and_b32 v10, 31, v1
  v_mul_u32_u24 v10, 1296, v10
  v_lshrrev_b32 v11, 5, v1
  v_lshl_add_u32 v3, v11, 4, v10
  s_waitcnt vmcnt(25)
  v_add_u32 v10, 0, v0
  v_mul_u32_u24 v11, 52429, v10
  v_lshrrev_b32 v11, 22, v11
  v_add_u32 v11, v11, v10
  v_lshlrev_b32 v11, 4, v11
  ds_write_b128 v11, v[136:139] offset:0
  v_add_u32 v10, 512, v0
  v_mul_u32_u24 v11, 52429, v10
  v_lshrrev_b32 v11, 22, v11
  v_add_u32 v11, v11, v10
  v_lshlrev_b32 v11, 4, v11
  ds_write_b128 v11, v[140:143] offset:0
  v_add_u32 v10, 1024, v0
  v_mul_u32_u24 v11, 52429, v10
  v_lshrrev_b32 v11, 22, v11
  v_add_u32 v11, v11, v10
  v_lshlrev_b32 v11, 4, v11
  ds_write_b128 v11, v[144:147] offset:0
  v_add_u32 v10, 1536, v0
  v_mul_u32_u24 v11, 52429, v10
  v_lshrrev_b32 v11, 22, v11
  v_add_u32 v11, v11, v10
  v_lshlrev_b32 v11, 4, v11
  ds_write_b128 v11, v[148:151] offset:0
  v_add_u32 v10, 2048, v0
  v_mul_u32_u24 v11, 52429, v10
  v_lshrrev_b32 v11, 22, v11
  v_add_u32 v11, v11, v10
  v_lshlrev_b32 v11, 4, v11
  ds_write_b128 v11, v[152:155] offset:0
  s_waitcnt vmcnt(21)
  ds_write_b128 v13, v[176:179] offset:0
  ds_write_b128 v13, v[180:183] offset:8192
  ds_write_b128 v13, v[184:187] offset:16384
  ds_write_b128 v13, v[188:191] offset:24576
  s_waitcnt lgkmcnt(0)
  s_barrier
  ds_read_b64_tr_b16 v[16:17], v14 offset:0
  ds_read_b64_tr_b16 v[18:19], v14 offset:1024
  ds_read_b64_tr_b16 v[20:21], v14 offset:4096
  ds_read_b64_tr_b16 v[22:23], v14 offset:5120
  ds_read_b64_tr_b16 v[24:25], v14 offset:8192
  ds_read_b64_tr_b16 v[26:27], v14 offset:9216
  ds_read_b64_tr_b16 v[28:29], v14 offset:12288
  ds_read_b64_tr_b16 v[30:31], v14 offset:13312
  s_waitcnt lgkmcnt(0)
  ds_read_b64_tr_b16 v[32:33], v14 offset:16384
  ds_read_b64_tr_b16 v[34:35], v14 offset:17408
  ds_read_b64_tr_b16 v[36:37], v14 offset:20480
  ds_read_b64_tr_b16 v[38:39], v14 offset:21504
  ds_read_b64_tr_b16 v[40:41], v14 offset:24576
  ds_read_b64_tr_b16 v[42:43], v14 offset:25600
  ds_read_b64_tr_b16 v[44:45], v14 offset:28672
  ds_read_b64_tr_b16 v[46:47], v14 offset:29696
  s_waitcnt lgkmcnt(0)
  s_waitcnt lgkmcnt(0)
  s_cmp_ge_u32 s30, 4
  s_cbranch_scc1 mpi_147
  ds_read_b128 v[4:7], v3 offset:0
  ds_read_b128 v[8:11], v3 offset:32
  s_waitcnt lgkmcnt(0)
  s_cmp_eq_u32 s43, 2
  s_cbranch_scc1 mpv_148
  v_mfma_f32_32x32x16_bf16 v[176:191], v[16:19], v[4:7], 0
  v_mfma_f32_32x32x16_bf16 v[176:191], v[20:23], v[8:11], v[176:191]
  s_branch mpd_149
mpv_148:
  v_mfma_f32_32x32x16_bf16 v[176:191], v[4:7], v[16:19], 0
  v_mfma_f32_32x32x16_bf16 v[176:191], v[8:11], v[20:23], v[176:191]
mpd_149:
  ds_read_b128 v[4:7], v3 offset:64
  ds_read_b128 v[8:11], v3 offset:96
  s_waitcnt lgkmcnt(0)
  s_cmp_eq_u32 s43, 2
  s_cbranch_scc1 mpv_150
  v_mfma_f32_32x32x16_bf16 v[176:191], v[24:27], v[4:7], v[176:191]
  v_mfma_f32_32x32x16_bf16 v[176:191], v[28:31], v[8:11], v[176:191]
  s_branch mpd_151
mpv_150:
  v_mfma_f32_32x32x16_bf16 v[176:191], v[4:7], v[24:27], v[176:191]
  v_mfma_f32_32x32x16_bf16 v[176:191], v[8:11], v[28:31], v[176:191]
mpd_151:
  ds_read_b128 v[4:7], v3 offset:128
  ds_read_b128 v[8:11], v3 offset:160
  s_waitcnt lgkmcnt(0)
  s_cmp_eq_u32 s43, 2
  s_cbranch_scc1 mpv_152
  v_mfma_f32_32x32x16_bf16 v[176:191], v[32:35], v[4:7], v[176:191]
  v_mfma_f32_32x32x16_bf16 v[176:191], v[36:39], v[8:11], v[176:191]
  s_branch mpd_153
mpv_152:
  v_mfma_f32_32x32x16_bf16 v[176:191], v[4:7], v[32:35], v[176:191]
  v_mfma_f32_32x32x16_bf16 v[176:191], v[8:11], v[36:39], v[176:191]
mpd_153:
  ds_read_b128 v[4:7], v3 offset:192
  ds_read_b128 v[8:11], v3 offset:224
  s_waitcnt lgkmcnt(0)
  s_cmp_eq_u32 s43, 2
  s_cbranch_scc1 mpv_154
  v_mfma_f32_32x32x16_bf16 v[176:191], v[40:43], v[4:7], v[176:191]
  v_mfma_f32_32x32x16_bf16 v[176:191], v[44:47], v[8:11], v[176:191]
  s_branch mpd_155
mpv_154:
  v_mfma_f32_32x32x16_bf16 v[176:191], v[4:7], v[40:43], v[176:191]
  v_mfma_f32_32x32x16_bf16 v[176:191], v[8:11], v[44:47], v[176:191]
mpd_155:
mpi_147:
  s_waitcnt vmcnt(17)
  ds_write_b128 v13, v[192:195] offset:32768
  ds_write_b128 v13, v[196:199] offset:40960
  ds_write_b128 v13, v[200:203] offset:49152
  ds_write_b128 v13, v[204:207] offset:57344
  s_waitcnt lgkmcnt(0)
  s_barrier
  ds_read_b64_tr_b16 v[48:49], v14 offset:32768
  ds_read_b64_tr_b16 v[50:51], v14 offset:33792
  ds_read_b64_tr_b16 v[52:53], v14 offset:36864
  ds_read_b64_tr_b16 v[54:55], v14 offset:37888
  ds_read_b64_tr_b16 v[56:57], v14 offset:40960
  ds_read_b64_tr_b16 v[58:59], v14 offset:41984
  ds_read_b64_tr_b16 v[60:61], v14 offset:45056
  ds_read_b64_tr_b16 v[62:63], v14 offset:46080
  s_waitcnt lgkmcnt(0)
  ds_read_b64_tr_b16 v[64:65], v14 offset:49152
  ds_read_b64_tr_b16 v[66:67], v14 offset:50176
  ds_read_b64_tr_b16 v[68:69], v14 offset:53248
  ds_read_b64_tr_b16 v[70:71], v14 offset:54272
  ds_read_b64_tr_b16 v[72:73], v14 offset:57344
  ds_read_b64_tr_b16 v[74:75], v14 offset:58368
  ds_read_b64_tr_b16 v[76:77], v14 offset:61440
  ds_read_b64_tr_b16 v[78:79], v14 offset:62464
  s_waitcnt lgkmcnt(0)
  s_waitcnt lgkmcnt(0)
  s_cmp_ge_u32 s30, 4
  s_cbranch_scc1 mpi_156
  ds_read_b128 v[4:7], v3 offset:256
  ds_read_b128 v[8:11], v3 offset:288
  s_waitcnt lgkmcnt(0)
  s_cmp_eq_u32 s43, 2
  s_cbranch_scc1 mpv_157
  v_mfma_f32_32x32x16_bf16 v[176:191], v[48:51], v[4:7], v[176:191]
  v_mfma_f32_32x32x16_bf16 v[176:191], v[52:55], v[8:11], v[176:191]
  s_branch mpd_158
mpv_157:
  v_mfma_f32_32x32x16_bf16 v[176:191], v[4:7], v[48:51], v[176:191]
  v_mfma_f32_32x32x16_bf16 v[176:191], v[8:11], v[52:55], v[176:191]
mpd_158:
  ds_read_b128 v[4:7], v3 offset:320
  ds_read_b128 v[8:11], v3 offset:352
  s_waitcnt lgkmcnt(0)
  s_cmp_eq_u32 s43, 2
  s_cbranch_scc1 mpv_159
  v_mfma_f32_32x32x16_bf16 v[176:191], v[56:59], v[4:7], v[176:191]
  v_mfma_f32_32x32x16_bf16 v[176:191], v[60:63], v[8:11], v[176:191]
  s_branch mpd_160
mpv_159:
  v_mfma_f32_32x32x16_bf16 v[176:191], v[4:7], v[56:59], v[176:191]
  v_mfma_f32_32x32x16_bf16 v[176:191], v[8:11], v[60:63], v[176:191]
mpd_160:
  ds_read_b128 v[4:7], v3 offset:384
  ds_read_b128 v[8:11], v3 offset:416
  s_waitcnt lgkmcnt(0)
  s_cmp_eq_u32 s43, 2
  s_cbranch_scc1 mpv_161
  v_mfma_f32_32x32x16_bf16 v[176:191], v[64:67], v[4:7], v[176:191]
  v_mfma_f32_32x32x16_bf16 v[176:191], v[68:71], v[8:11], v[176:191]
  s_branch mpd_162
mpv_161:
  v_mfma_f32_32x32x16_bf16 v[176:191], v[4:7], v[64:67], v[176:191]
  v_mfma_f32_32x32x16_bf16 v[176:191], v[8:11], v[68:71], v[176:191]
mpd_162:
  ds_read_b128 v[4:7], v3 offset:448
  ds_read_b128 v[8:11], v3 offset:480
  s_waitcnt lgkmcnt(0)
  s_cmp_eq_u32 s43, 2
  s_cbranch_scc1 mpv_163
  v_mfma_f32_32x32x16_bf16 v[176:191], v[72:75], v[4:7], v[176:191]
  v_mfma_f32_32x32x16_bf16 v[176:191], v[76:79], v[8:11], v[176:191]
  s_branch mpd_164
mpv_163:
  v_mfma_f32_32x32x16_bf16 v[176:191], v[4:7], v[72:75], v[176:191]
  v_mfma_f32_32x32x16_bf16 v[176:191], v[8:11], v[76:79], v[176:191]
mpd_164:
mpi_156:
  s_waitcnt vmcnt(13)
  ds_write_b128 v13, v[208:211] offset:0
  ds_write_b128 v13, v[212:215] offset:8192
  ds_write_b128 v13, v[216:219] offset:16384
  ds_write_b128 v13, v[220:223] offset:24576
  s_waitcnt lgkmcnt(0)
  s_mov_b32 s34, 81920
  buffer_load_dwordx4 v[192:195], v2, s[20:23], s34 offen
  s_mov_b32 s34, 90112
  buffer_load_dwordx4 v[196:199], v2, s[20:23], s34 offen
  s_mov_b32 s34, 98304
  buffer_load_dwordx4 v[200:203], v2, s[20:23], s34 offen
  s_mov_b32 s34, 106496
  buffer_load_dwordx4 v[204:207], v2, s[20:23], s34 offen
  s_mov_b32 s34, 114688
  buffer_load_dwordx4 v[208:211], v2, s[20:23], s34 offen
  s_barrier
  ds_read_b64_tr_b16 v[80:81], v14 offset:0
  ds_read_b64_tr_b16 v[82:83], v14 offset:1024
  ds_read_b64_tr_b16 v[84:85], v14 offset:4096
  ds_read_b64_tr_b16 v[86:87], v14 offset:5120
  ds_read_b64_tr_b16 v[88:89], v14 offset:8192
  ds_read_b64_tr_b16 v[90:91], v14 offset:9216
  ds_read_b64_tr_b16 v[92:93], v14 offset:12288
  ds_read_b64_tr_b16 v[94:95], v14 offset:13312
  s_waitcnt lgkmcnt(0)
  ds_read_b64_tr_b16 v[96:97], v14 offset:16384
  ds_read_b64_tr_b16 v[98:99], v14 offset:17408
  ds_read_b64_tr_b16 v[100:101], v14 offset:20480
  ds_read_b64_tr_b16 v[102:103], v14 offset:21504
  ds_read_b64_tr_b16 v[104:105], v14 offset:24576
  ds_read_b64_tr_b16 v[106:107], v14 offset:25600
  ds_read_b64_tr_b16 v[108:109], v14 offset:28672
  ds_read_b64_tr_b16 v[110:111], v14 offset:29696
  s_waitcnt lgkmcnt(0)
  s_waitcnt lgkmcnt(0)
  s_cmp_ge_u32 s30, 4
  s_cbranch_scc1 mpi_165
  ds_read_b128 v[4:7], v3 offset:512
  ds_read_b128 v[8:11], v3 offset:544
  s_waitcnt lgkmcnt(0)
  s_cmp_eq_u32 s43, 2
  s_cbranch_scc1 mpv_166
  v_mfma_f32_32x32x16_bf16 v[176:191], v[80:83], v[4:7], v[176:191]
  v_mfma_f32_32x32x16_bf16 v[176:191], v[84:87], v[8:11], v[176:191]
  s_branch mpd_167
mpv_166:
  v_mfma_f32_32x32x16_bf16 v[176:191], v[4:7], v[80:83], v[176:191]
  v_mfma_f32_32x32x16_bf16 v[176:191], v[8:11], v[84:87], v[176:191]
mpd_167:
  ds_read_b128 v[4:7], v3 offset:576
  ds_read_b128 v[8:11], v3 offset:608
  s_waitcnt lgkmcnt(0)
  s_cmp_eq_u32 s43, 2
  s_cbranch_scc1 mpv_168
  v_mfma_f32_32x32x16_bf16 v[176:191], v[88:91], v[4:7], v[176:191]
  v_mfma_f32_32x32x16_bf16 v[176:191], v[92:95], v[8:11], v[176:191]
  s_branch mpd_169
mpv_168:
  v_mfma_f32_32x32x16_bf16 v[176:191], v[4:7], v[88:91], v[176:191]
  v_mfma_f32_32x32x16_bf16 v[176:191], v[8:11], v[92:95], v[176:191]
mpd_169:
  ds_read_b128 v[4:7], v3 offset:640
  ds_read_b128 v[8:11], v3 offset:672
  s_waitcnt lgkmcnt(0)
  s_cmp_eq_u32 s43, 2
  s_cbranch_scc1 mpv_170
  v_mfma_f32_32x32x16_bf16 v[176:191], v[96:99], v[4:7], v[176:191]
  v_mfma_f32_32x32x16_bf16 v[176:191], v[100:103], v[8:11], v[176:191]
  s_branch mpd_171
mpv_170:
  v_mfma_f32_32x32x16_bf16 v[176:191], v[4:7], v[96:99], v[176:191]
  v_mfma_f32_32x32x16_bf16 v[176:191], v[8:11], v[100:103], v[176:191]
mpd_171:
  ds_read_b128 v[4:7], v3 offset:704
  ds_read_b128 v[8:11], v3 offset:736
  s_waitcnt lgkmcnt(0)
  s_cmp_eq_u32 s43, 2
  s_cbranch_scc1 mpv_172
  v_mfma_f32_32x32x16_bf16 v[176:191], v[104:107], v[4:7], v[176:191]
  v_mfma_f32_32x32x16_bf16 v[176:191], v[108:111], v[8:11], v[176:191]
  s_branch mpd_173
mpv_172:
  v_mfma_f32_32x32x16_bf16 v[176:191], v[4:7], v[104:107], v[176:191]
  v_mfma_f32_32x32x16_bf16 v[176:191], v[8:11], v[108:111], v[176:191]
mpd_173:
mpi_165:
  s_waitcnt vmcnt(14)
  ds_write_b128 v13, v[224:227] offset:32768
  ds_write_b128 v13, v[228:231] offset:40960
  ds_write_b128 v13, v[232:235] offset:49152
  ds_write_b128 v13, v[236:239] offset:57344
  s_waitcnt lgkmcnt(0)
  s_barrier
  ds_read_b64_tr_b16 v[112:113], v14 offset:32768
  ds_read_b64_tr_b16 v[114:115], v14 offset:33792
  ds_read_b64_tr_b16 v[116:117], v14 offset:36864
  ds_read_b64_tr_b16 v[118:119], v14 offset:37888
  ds_read_b64_tr_b16 v[120:121], v14 offset:40960
  ds_read_b64_tr_b16 v[122:123], v14 offset:41984
  ds_read_b64_tr_b16 v[124:125], v14 offset:45056
  ds_read_b64_tr_b16 v[126:127], v14 offset:46080
  s_waitcnt lgkmcnt(0)
  ds_read_b64_tr_b16 v[128:129], v14 offset:49152
  ds_read_b64_tr_b16 v[130:131], v14 offset:50176
  ds_read_b64_tr_b16 v[132:133], v14 offset:53248
  ds_read_b64_tr_b16 v[134:135], v14 offset:54272
  ds_read_b64_tr_b16 v[136:137], v14 offset:57344
  ds_read_b64_tr_b16 v[138:139], v14 offset:58368
  ds_read_b64_tr_b16 v[140:141], v14 offset:61440
  ds_read_b64_tr_b16 v[142:143], v14 offset:62464
  s_waitcnt lgkmcnt(0)
  s_waitcnt lgkmcnt(0)
  s_cmp_ge_u32 s30, 4
  s_cbranch_scc1 mpi_174
  ds_read_b128 v[4:7], v3 offset:768
  ds_read_b128 v[8:11], v3 offset:800
  s_waitcnt lgkmcnt(0)
  s_cmp_eq_u32 s43, 2
  s_cbranch_scc1 mpv_175
  v_mfma_f32_32x32x16_bf16 v[176:191], v[112:115], v[4:7], v[176:191]
  v_mfma_f32_32x32x16_bf16 v[176:191], v[116:119], v[8:11], v[176:191]
  s_branch mpd_176
mpv_175:
  v_mfma_f32_32x32x16_bf16 v[176:191], v[4:7], v[112:115], v[176:191]
  v_mfma_f32_32x32x16_bf16 v[176:191], v[8:11], v[116:119], v[176:191]
mpd_176:
  ds_read_b128 v[4:7], v3 offset:832
  ds_read_b128 v[8:11], v3 offset:864
  s_waitcnt lgkmcnt(0)
  s_cmp_eq_u32 s43, 2
  s_cbranch_scc1 mpv_177
  v_mfma_f32_32x32x16_bf16 v[176:191], v[120:123], v[4:7], v[176:191]
  v_mfma_f32_32x32x16_bf16 v[176:191], v[124:127], v[8:11], v[176:191]
  s_branch mpd_178
mpv_177:
  v_mfma_f32_32x32x16_bf16 v[176:191], v[4:7], v[120:123], v[176:191]
  v_mfma_f32_32x32x16_bf16 v[176:191], v[8:11], v[124:127], v[176:191]
mpd_178:
  ds_read_b128 v[4:7], v3 offset:896
  ds_read_b128 v[8:11], v3 offset:928
  s_waitcnt lgkmcnt(0)
  s_cmp_eq_u32 s43, 2
  s_cbranch_scc1 mpv_179
  v_mfma_f32_32x32x16_bf16 v[176:191], v[128:131], v[4:7], v[176:191]
  v_mfma_f32_32x32x16_bf16 v[176:191], v[132:135], v[8:11], v[176:191]
  s_branch mpd_180
mpv_179:
  v_mfma_f32_32x32x16_bf16 v[176:191], v[4:7], v[128:131], v[176:191]
  v_mfma_f32_32x32x16_bf16 v[176:191], v[8:11], v[132:135], v[176:191]
mpd_180:
  ds_read_b128 v[4:7], v3 offset:960
  ds_read_b128 v[8:11], v3 offset:992
  s_waitcnt lgkmcnt(0)
  s_cmp_eq_u32 s43, 2
  s_cbranch_scc1 mpv_181
  v_mfma_f32_32x32x16_bf16 v[176:191], v[136:139], v[4:7], v[176:191]
  v_mfma_f32_32x32x16_bf16 v[176:191], v[140:143], v[8:11], v[176:191]
  s_branch mpd_182
mpv_181:
  v_mfma_f32_32x32x16_bf16 v[176:191], v[4:7], v[136:139], v[176:191]
  v_mfma_f32_32x32x16_bf16 v[176:191], v[8:11], v[140:143], v[176:191]
mpd_182:
mpi_174:
  s_waitcnt vmcnt(10)
  ds_write_b128 v13, v[240:243] offset:0
  ds_write_b128 v13, v[244:247] offset:8192
  ds_write_b128 v13, v[248:251] offset:16384
  ds_write_b128 v13, v[252:255] offset:24576
  s_waitcnt vmcnt(5)
  v_add_u32 v10, 0, v0
  v_mul_u32_u24 v11, 52429, v10
  v_lshrrev_b32 v11, 22, v11
  v_add_u32 v11, v11, v10
  v_lshlrev_b32 v11, 4, v11
  ds_write_b128 v11, v[156:159] offset:41472
  v_add_u32 v10, 512, v0
  v_mul_u32_u24 v11, 52429, v10
  v_lshrrev_b32 v11, 22, v11
  v_add_u32 v11, v11, v10
  v_lshlrev_b32 v11, 4, v11
  ds_write_b128 v11, v[160:163] offset:41472
  v_add_u32 v10, 1024, v0
  v_mul_u32_u24 v11, 52429, v10
  v_lshrrev_b32 v11, 22, v11
  v_add_u32 v11, v11, v10
  v_lshlrev_b32 v11, 4, v11
  ds_write_b128 v11, v[164:167] offset:41472
  v_add_u32 v10, 1536, v0
  v_mul_u32_u24 v11, 52429, v10
  v_lshrrev_b32 v11, 22, v11
  v_add_u32 v11, v11, v10
  v_lshlrev_b32 v11, 4, v11
  ds_write_b128 v11, v[168:171] offset:41472
  v_add_u32 v10, 2048, v0
  v_mul_u32_u24 v11, 52429, v10
  v_lshrrev_b32 v11, 22, v11
  v_add_u32 v11, v11, v10
  v_lshlrev_b32 v11, 4, v11
  ds_write_b128 v11, v[172:175] offset:41472
  s_waitcnt lgkmcnt(0)
  s_barrier
  ds_read_b64_tr_b16 v[144:145], v14 offset:0
  ds_read_b64_tr_b16 v[146:147], v14 offset:1024
  ds_read_b64_tr_b16 v[148:149], v14 offset:4096
  ds_read_b64_tr_b16 v[150:151], v14 offset:5120
  ds_read_b64_tr_b16 v[152:153], v14 offset:8192
  ds_read_b64_tr_b16 v[154:155], v14 offset:9216
  ds_read_b64_tr_b16 v[156:157], v14 offset:12288
  ds_read_b64_tr_b16 v[158:159], v14 offset:13312
  s_waitcnt lgkmcnt(0)
  ds_read_b64_tr_b16 v[160:161], v14 offset:16384
  ds_read_b64_tr_b16 v[162:163], v14 offset:17408
  ds_read_b64_tr_b16 v[164:165], v14 offset:20480
  ds_read_b64_tr_b16 v[166:167], v14 offset:21504
  ds_read_b64_tr_b16 v[168:169], v14 offset:24576
  ds_read_b64_tr_b16 v[170:171], v14 offset:25600
  ds_read_b64_tr_b16 v[172:173], v14 offset:28672
  ds_read_b64_tr_b16 v[174:175], v14 offset:29696
  s_waitcnt lgkmcnt(0)
  s_waitcnt lgkmcnt(0)
  s_cmp_ge_u32 s30, 4
  s_cbranch_scc1 mpi_183
  ds_read_b128 v[4:7], v3 offset:1024
  ds_read_b128 v[8:11], v3 offset:1056
  s_waitcnt lgkmcnt(0)
  s_cmp_eq_u32 s43, 2
  s_cbranch_scc1 mpv_184
  v_mfma_f32_32x32x16_bf16 v[176:191], v[144:147], v[4:7], v[176:191]
  v_mfma_f32_32x32x16_bf16 v[176:191], v[148:151], v[8:11], v[176:191]
  s_branch mpd_185
mpv_184:
  v_mfma_f32_32x32x16_bf16 v[176:191], v[4:7], v[144:147], v[176:191]
  v_mfma_f32_32x32x16_bf16 v[176:191], v[8:11], v[148:151], v[176:191]
mpd_185:
  ds_read_b128 v[4:7], v3 offset:1088
  ds_read_b128 v[8:11], v3 offset:1120
  s_waitcnt lgkmcnt(0)
  s_cmp_eq_u32 s43, 2
  s_cbranch_scc1 mpv_186
  v_mfma_f32_32x32x16_bf16 v[176:191], v[152:155], v[4:7], v[176:191]
  v_mfma_f32_32x32x16_bf16 v[176:191], v[156:159], v[8:11], v[176:191]
  s_branch mpd_187
mpv_186:
  v_mfma_f32_32x32x16_bf16 v[176:191], v[4:7], v[152:155], v[176:191]
  v_mfma_f32_32x32x16_bf16 v[176:191], v[8:11], v[156:159], v[176:191]
mpd_187:
  ds_read_b128 v[4:7], v3 offset:1152
  ds_read_b128 v[8:11], v3 offset:1184
  s_waitcnt lgkmcnt(0)
  s_cmp_eq_u32 s43, 2
  s_cbranch_scc1 mpv_188
  v_mfma_f32_32x32x16_bf16 v[176:191], v[160:163], v[4:7], v[176:191]
  v_mfma_f32_32x32x16_bf16 v[176:191], v[164:167], v[8:11], v[176:191]
  s_branch mpd_189
mpv_188:
  v_mfma_f32_32x32x16_bf16 v[176:191], v[4:7], v[160:163], v[176:191]
  v_mfma_f32_32x32x16_bf16 v[176:191], v[8:11], v[164:167], v[176:191]
mpd_189:
  ds_read_b128 v[4:7], v3 offset:1216
  ds_read_b128 v[8:11], v3 offset:1248
  s_waitcnt lgkmcnt(0)
  s_cmp_eq_u32 s43, 2
  s_cbranch_scc1 mpv_190
  v_mfma_f32_32x32x16_bf16 v[176:191], v[168:171], v[4:7], v[176:191]
  v_mfma_f32_32x32x16_bf16 v[176:191], v[172:175], v[8:11], v[176:191]
  s_branch mpd_191
mpv_190:
  v_mfma_f32_32x32x16_bf16 v[176:191], v[4:7], v[168:171], v[176:191]
  v_mfma_f32_32x32x16_bf16 v[176:191], v[8:11], v[172:175], v[176:191]
mpd_191:
mpi_183:
  s_cmp_lg_u32 s31, 0
  s_cbranch_scc1 valok_194
  v_lshlrev_b32 v10, 2, v1
  s_mov_b32 s39, 0
val_192:
  buffer_load_dword v11, v10, s[12:15], 0 offen sc1
  s_waitcnt vmcnt(0)
  v_cmp_eq_u32 vcc, 32, v11
s_nop 3
  s_and_b32 s34, vcc_lo, vcc_hi
  s_and_b32 s34, s34, 0x5555
  s_cmp_eq_u32 s34, 0x5555
  s_cbranch_scc0 valg_193_s
  v_readlane_b32 s32, v11, 1
  s_mov_b32 s34, 0
  s_cmp_eq_u32 s34, 0
  s_cbranch_scc1 valg_193
valg_193_s:
  s_mov_b32 s36, 0
  s_mov_b32 s37, 0
  s_mov_b32 s38, 0
  s_mov_b32 s34, 0
  v_readlane_b32 s35, v11, 2
s_nop 3
  s_add_u32 s38, s38, s35
  v_readlane_b32 s35, v11, 0
s_nop 3
  s_add_u32 s36, s36, s35
  s_cmp_eq_u32 s35, 32
  s_cselect_b32 s97, 0, 1
  s_or_b32 s34, s34, s97
  s_cmp_gt_u32 s98, 0
  s_cselect_b32 s35, s35, 0
  s_add_u32 s37, s37, s35
  v_readlane_b32 s35, v11, 6
s_nop 3
  s_add_u32 s38, s38, s35
  v_readlane_b32 s35, v11, 4
s_nop 3
  s_add_u32 s36, s36, s35
  s_cmp_eq_u32 s35, 32
  s_cselect_b32 s97, 0, 1
  s_or_b32 s34, s34, s97
  s_cmp_gt_u32 s98, 1
  s_cselect_b32 s35, s35, 0
  s_add_u32 s37, s37, s35
  v_readlane_b32 s35, v11, 10
s_nop 3
  s_add_u32 s38, s38, s35
  v_readlane_b32 s35, v11, 8
s_nop 3
  s_add_u32 s36, s36, s35
  s_cmp_eq_u32 s35, 32
  s_cselect_b32 s97, 0, 1
  s_or_b32 s34, s34, s97
  s_cmp_gt_u32 s98, 2
  s_cselect_b32 s35, s35, 0
  s_add_u32 s37, s37, s35
  v_readlane_b32 s35, v11, 14
s_nop 3
  s_add_u32 s38, s38, s35
  v_readlane_b32 s35, v11, 12
s_nop 3
  s_add_u32 s36, s36, s35
  s_cmp_eq_u32 s35, 32
  s_cselect_b32 s97, 0, 1
  s_or_b32 s34, s34, s97
  s_cmp_gt_u32 s98, 3
  s_cselect_b32 s35, s35, 0
  s_add_u32 s37, s37, s35
  v_readlane_b32 s35, v11, 34
s_nop 3
  s_add_u32 s38, s38, s35
  v_readlane_b32 s35, v11, 32
s_nop 3
  s_add_u32 s36, s36, s35
  s_cmp_eq_u32 s35, 32
  s_cselect_b32 s97, 0, 1
  s_or_b32 s34, s34, s97
  s_cmp_gt_u32 s98, 4
  s_cselect_b32 s35, s35, 0
  s_add_u32 s37, s37, s35
  v_readlane_b32 s35, v11, 38
s_nop 3
  s_add_u32 s38, s38, s35
  v_readlane_b32 s35, v11, 36
s_nop 3
  s_add_u32 s36, s36, s35
  s_cmp_eq_u32 s35, 32
  s_cselect_b32 s97, 0, 1
  s_or_b32 s34, s34, s97
  s_cmp_gt_u32 s98, 5
  s_cselect_b32 s35, s35, 0
  s_add_u32 s37, s37, s35
  v_readlane_b32 s35, v11, 42
s_nop 3
  s_add_u32 s38, s38, s35
  v_readlane_b32 s35, v11, 40
s_nop 3
  s_add_u32 s36, s36, s35
  s_cmp_eq_u32 s35, 32
  s_cselect_b32 s97, 0, 1
  s_or_b32 s34, s34, s97
  s_cmp_gt_u32 s98, 6
  s_cselect_b32 s35, s35, 0
  s_add_u32 s37, s37, s35
  v_readlane_b32 s35, v11, 46
s_nop 3
  s_add_u32 s38, s38, s35
  v_readlane_b32 s35, v11, 44
s_nop 3
  s_add_u32 s36, s36, s35
  s_cmp_eq_u32 s35, 32
  s_cselect_b32 s97, 0, 1
  s_or_b32 s34, s34, s97
  s_cmp_gt_u32 s98, 7
  s_cselect_b32 s35, s35, 0
  s_add_u32 s37, s37, s35
  v_readlane_b32 s35, v11, 18
s_nop 3
  s_add_u32 s38, s38, s35
  v_readlane_b32 s35, v11, 16
s_nop 3
  s_add_u32 s36, s36, s35
  s_cmp_eq_u32 s35, 0
  s_cselect_b32 s97, 0, 1
  s_or_b32 s34, s34, s97
  s_cmp_gt_u32 s98, 8
  s_cselect_b32 s35, s35, 0
  s_add_u32 s37, s37, s35
  v_readlane_b32 s35, v11, 22
s_nop 3
  s_add_u32 s38, s38, s35
  v_readlane_b32 s35, v11, 20
s_nop 3
  s_add_u32 s36, s36, s35
  s_cmp_eq_u32 s35, 0
  s_cselect_b32 s97, 0, 1
  s_or_b32 s34, s34, s97
  s_cmp_gt_u32 s98, 9
  s_cselect_b32 s35, s35, 0
  s_add_u32 s37, s37, s35
  v_readlane_b32 s35, v11, 26
s_nop 3
  s_add_u32 s38, s38, s35
  v_readlane_b32 s35, v11, 24
s_nop 3
  s_add_u32 s36, s36, s35
  s_cmp_eq_u32 s35, 0
  s_cselect_b32 s97, 0, 1
  s_or_b32 s34, s34, s97
  s_cmp_gt_u32 s98, 10
  s_cselect_b32 s35, s35, 0
  s_add_u32 s37, s37, s35
  v_readlane_b32 s35, v11, 30
s_nop 3
  s_add_u32 s38, s38, s35
  v_readlane_b32 s35, v11, 28
s_nop 3
  s_add_u32 s36, s36, s35
  s_cmp_eq_u32 s35, 0
  s_cselect_b32 s97, 0, 1
  s_or_b32 s34, s34, s97
  s_cmp_gt_u32 s98, 11
  s_cselect_b32 s35, s35, 0
  s_add_u32 s37, s37, s35
  v_readlane_b32 s35, v11, 50
s_nop 3
  s_add_u32 s38, s38, s35
  v_readlane_b32 s35, v11, 48
s_nop 3
  s_add_u32 s36, s36, s35
  s_cmp_eq_u32 s35, 0
  s_cselect_b32 s97, 0, 1
  s_or_b32 s34, s34, s97
  s_cmp_gt_u32 s98, 12
  s_cselect_b32 s35, s35, 0
  s_add_u32 s37, s37, s35
  v_readlane_b32 s35, v11, 54
s_nop 3
  s_add_u32 s38, s38, s35
  v_readlane_b32 s35, v11, 52
s_nop 3
  s_add_u32 s36, s36, s35
  s_cmp_eq_u32 s35, 0
  s_cselect_b32 s97, 0, 1
  s_or_b32 s34, s34, s97
  s_cmp_gt_u32 s98, 13
  s_cselect_b32 s35, s35, 0
  s_add_u32 s37, s37, s35
  v_readlane_b32 s35, v11, 58
s_nop 3
  s_add_u32 s38, s38, s35
  v_readlane_b32 s35, v11, 56
s_nop 3
  s_add_u32 s36, s36, s35
  s_cmp_eq_u32 s35, 0
  s_cselect_b32 s97, 0, 1
  s_or_b32 s34, s34, s97
  s_cmp_gt_u32 s98, 14
  s_cselect_b32 s35, s35, 0
  s_add_u32 s37, s37, s35
  v_readlane_b32 s35, v11, 62
s_nop 3
  s_add_u32 s38, s38, s35
  v_readlane_b32 s35, v11, 60
s_nop 3
  s_add_u32 s36, s36, s35
  s_cmp_eq_u32 s35, 0
  s_cselect_b32 s97, 0, 1
  s_or_b32 s34, s34, s97
  s_cmp_gt_u32 s98, 15
  s_cselect_b32 s35, s35, 0
  s_add_u32 s37, s37, s35
  v_readlane_b32 s32, v11, 1
  s_cmp_eq_u32 s36, 256
  s_cselect_b32 s35, s38, 0
  s_cmp_eq_u32 s35, 256
  s_cbranch_scc1 valg_193
  s_sleep 2
  s_add_u32 s39, s39, 1
  s_cmp_lt_u32 s39, s33
  s_cbranch_scc1 val_192
  s_mov_b32 s33, 0
valg_193:
s_nop 0
  s_and_b32 s32, s32, 2
  s_lshl_b32 s32, s32, 12
  s_cmp_eq_u32 s34, 0
  s_cbranch_scc1 valok_194
  s_mov_b32 s31, 1
  s_mov_b32 s32, 0
  s_add_u32 s37, s37, s99
  s_and_b32 s37, s37, 255
  s_lshr_b32 s28, s37, 5
  s_and_b32 s29, s37, 31
  s_barrier
  s_branch L_dispatch
valok_194:
  s_cmp_lg_u32 s31, 0
  s_cbranch_scc1 pwd_196
  s_mov_b32 s39, 0
  v_mov_b32 v13, 4
pw_195:
  buffer_load_dword v12, v13, s[12:15], 0 offen sc1
  s_waitcnt vmcnt(0)
  v_readfirstlane_b32 s32, v12
s_nop 3
  s_cmp_lg_u32 s32, 0
  s_cbranch_scc1 pw_195_g
  s_sleep 2
  s_add_u32 s39, s39, 1
  s_cmp_lt_u32 s39, s33
  s_cbranch_scc1 pw_195
  s_mov_b32 s33, 0
pw_195_g:
  s_and_b32 s32, s32, 2
  s_lshl_b32 s32, s32, 12
pwd_196:
  s_xor_b32 s100, s32, 8192
  s_add_u32 s101, s100, 3817472
  s_add_u32 s100, s100, 3801088
  s_cmp_ge_u32 s30, 4
  s_cbranch_scc1 mpq_197
  s_lshl_b32 s34, s42, 13
  s_and_b32 s35, s30, 3
  v_lshrrev_b32 v10, 5, v1
  v_and_b32 v11, 15, v1
  v_lshl_add_u32 v11, v10, 4, v11
  v_lshlrev_b32 v11, 4, v11
  v_bfe_u32 v10, v1, 4, 1
  s_lshr_b32 s36, s30, 2
  s_sub_u32 s36, 0, s36
  s_mov_b32 s36, 0
  s_lshl_b32 s36, s36, 18
  s_lshl_b32 s37, s43, 24
  s_add_u32 s36, s36, s37
  s_cmp_eq_u32 s43, 2
  s_cbranch_scc1 L_mp_vb0
  s_lshl_b32 s35, s35, 10
  v_lshl_add_u32 v11, v10, 12, v11
  v_cvt_pk_bf16_f32 v176, v176, v177
  v_cvt_pk_bf16_f32 v177, v178, v179
  v_cvt_pk_bf16_f32 v178, v180, v181
  v_cvt_pk_bf16_f32 v179, v182, v183
  v_cvt_pk_bf16_f32 v180, v184, v185
  v_cvt_pk_bf16_f32 v181, v186, v187
  v_cvt_pk_bf16_f32 v182, v188, v189
  v_cvt_pk_bf16_f32 v183, v190, v191
  s_branch L_mp_sb0
L_mp_vb0:
  s_lshl_b32 s35, s35, 11
  v_lshl_add_u32 v11, v10, 10, v11
  v_cvt_pk_bf16_f32 v176, v176, v177
  v_cvt_pk_bf16_f32 v177, v178, v179
  v_cvt_pk_bf16_f32 v178, v184, v185
  v_cvt_pk_bf16_f32 v179, v186, v187
  v_cvt_pk_bf16_f32 v180, v180, v181
  v_cvt_pk_bf16_f32 v181, v182, v183
  v_cvt_pk_bf16_f32 v182, v188, v189
  v_cvt_pk_bf16_f32 v183, v190, v191
L_mp_sb0:
  s_add_u32 s34, s34, s35
  v_add_u32 v11, s34, v11
  buffer_store_dwordx4 v[176:179], v11, s[8:11], s36 offen sc1
  buffer_store_dwordx4 v[180:183], v11, s[8:11], s36 offen offset:512 sc1
mpq_197:
  s_waitcnt vmcnt(0)
  s_barrier
  v_add_u32 v10, 0, v0
  v_mul_u32_u24 v11, 52429, v10
  v_lshrrev_b32 v11, 22, v11
  v_add_u32 v11, v11, v10
  v_lshlrev_b32 v11, 4, v11
  ds_write_b128 v11, v[192:195] offset:0
  v_add_u32 v10, 512, v0
  v_mul_u32_u24 v11, 52429, v10
  v_lshrrev_b32 v11, 22, v11
  v_add_u32 v11, v11, v10
  v_lshlrev_b32 v11, 4, v11
  ds_write_b128 v11, v[196:199] offset:0
  v_add_u32 v10, 1024, v0
  v_mul_u32_u24 v11, 52429, v10
  v_lshrrev_b32 v11, 22, v11
  v_add_u32 v11, v11, v10
  v_lshlrev_b32 v11, 4, v11
  ds_write_b128 v11, v[200:203] offset:0
  v_add_u32 v10, 1536, v0
  v_mul_u32_u24 v11, 52429, v10
  v_lshrrev_b32 v11, 22, v11
  v_add_u32 v11, v11, v10
  v_lshlrev_b32 v11, 4, v11
  ds_write_b128 v11, v[204:207] offset:0
  v_add_u32 v10, 2048, v0
  v_mul_u32_u24 v11, 52429, v10
  v_lshrrev_b32 v11, 22, v11
  v_add_u32 v11, v11, v10
  v_lshlrev_b32 v11, 4, v11
  ds_write_b128 v11, v[208:211] offset:0
  s_waitcnt lgkmcnt(0)
  s_waitcnt vmcnt(0)
  s_barrier
  s_cmp_lg_u32 s30, 0
  s_cbranch_scc1 mpf_198
  s_lshl_b32 s34, s41, 2
  s_add_u32 s34, s34, 1024
  s_add_u32 s34, s34, s100
  v_mov_b32 v10, s34
  v_mov_b32 v11, 1
  s_mov_b64 exec, 1
  buffer_store_dword v11, v10, s[8:11], 0 offen sc1
  s_mov_b64 exec, -1
mpf_198:
  s_lshr_b32 s34, s30, 2
  s_mul_i32 s34, s34, 41472
  v_add_u32 v3, s34, v3
  s_cmp_eq_u32 s43, 2
  s_cbranch_scc1 mpv_199
  ds_read_b128 v[4:7], v3
  ds_read_b128 v[8:11], v3 offset:32
  s_waitcnt lgkmcnt(1)
  v_mfma_f32_32x32x16_bf16 v[176:191], v[16:19], v[4:7], 0
  ds_read_b128 v[4:7], v3 offset:64
  s_waitcnt lgkmcnt(1)
  v_mfma_f32_32x32x16_bf16 v[176:191], v[20:23], v[8:11], v[176:191]
  ds_read_b128 v[8:11], v3 offset:96
  s_waitcnt lgkmcnt(1)
  v_mfma_f32_32x32x16_bf16 v[176:191], v[24:27], v[4:7], v[176:191]
  ds_read_b128 v[4:7], v3 offset:128
  s_waitcnt lgkmcnt(1)
  v_mfma_f32_32x32x16_bf16 v[176:191], v[28:31], v[8:11], v[176:191]
  ds_read_b128 v[8:11], v3 offset:160
  s_waitcnt lgkmcnt(1)
  v_mfma_f32_32x32x16_bf16 v[176:191], v[32:35], v[4:7], v[176:191]
  ds_read_b128 v[4:7], v3 offset:192
  s_waitcnt lgkmcnt(1)
  v_mfma_f32_32x32x16_bf16 v[176:191], v[36:39], v[8:11], v[176:191]
  ds_read_b128 v[8:11], v3 offset:224
  s_waitcnt lgkmcnt(1)
  v_mfma_f32_32x32x16_bf16 v[176:191], v[40:43], v[4:7], v[176:191]
  ds_read_b128 v[4:7], v3 offset:256
  s_waitcnt lgkmcnt(1)
  v_mfma_f32_32x32x16_bf16 v[176:191], v[44:47], v[8:11], v[176:191]
  ds_read_b128 v[8:11], v3 offset:288
  s_waitcnt lgkmcnt(1)
  v_mfma_f32_32x32x16_bf16 v[176:191], v[48:51], v[4:7], v[176:191]
  ds_read_b128 v[4:7], v3 offset:320
  s_waitcnt lgkmcnt(1)
  v_mfma_f32_32x32x16_bf16 v[176:191], v[52:55], v[8:11], v[176:191]
  ds_read_b128 v[8:11], v3 offset:352
  s_waitcnt lgkmcnt(1)
  v_mfma_f32_32x32x16_bf16 v[176:191], v[56:59], v[4:7], v[176:191]
  ds_read_b128 v[4:7], v3 offset:384
  s_waitcnt lgkmcnt(1)
  v_mfma_f32_32x32x16_bf16 v[176:191], v[60:63], v[8:11], v[176:191]
  ds_read_b128 v[8:11], v3 offset:416
  s_waitcnt lgkmcnt(1)
  v_mfma_f32_32x32x16_bf16 v[176:191], v[64:67], v[4:7], v[176:191]
  ds_read_b128 v[4:7], v3 offset:448
  s_waitcnt lgkmcnt(1)
  v_mfma_f32_32x32x16_bf16 v[176:191], v[68:71], v[8:11], v[176:191]
  ds_read_b128 v[8:11], v3 offset:480
  s_waitcnt lgkmcnt(1)
  v_mfma_f32_32x32x16_bf16 v[176:191], v[72:75], v[4:7], v[176:191]
  ds_read_b128 v[4:7], v3 offset:512
  s_waitcnt lgkmcnt(1)
  v_mfma_f32_32x32x16_bf16 v[176:191], v[76:79], v[8:11], v[176:191]
  ds_read_b128 v[8:11], v3 offset:544
  s_waitcnt lgkmcnt(1)
  v_mfma_f32_32x32x16_bf16 v[176:191], v[80:83], v[4:7], v[176:191]
  ds_read_b128 v[4:7], v3 offset:576
  s_waitcnt lgkmcnt(1)
  v_mfma_f32_32x32x16_bf16 v[176:191], v[84:87], v[8:11], v[176:191]
  ds_read_b128 v[8:11], v3 offset:608
  s_waitcnt lgkmcnt(1)
  v_mfma_f32_32x32x16_bf16 v[176:191], v[88:91], v[4:7], v[176:191]
  ds_read_b128 v[4:7], v3 offset:640
  s_waitcnt lgkmcnt(1)
  v_mfma_f32_32x32x16_bf16 v[176:191], v[92:95], v[8:11], v[176:191]
  ds_read_b128 v[8:11], v3 offset:672
  s_waitcnt lgkmcnt(1)
  v_mfma_f32_32x32x16_bf16 v[176:191], v[96:99], v[4:7], v[176:191]
  ds_read_b128 v[4:7], v3 offset:704
  s_waitcnt lgkmcnt(1)
  v_mfma_f32_32x32x16_bf16 v[176:191], v[100:103], v[8:11], v[176:191]
  ds_read_b128 v[8:11], v3 offset:736
  s_waitcnt lgkmcnt(1)
  v_mfma_f32_32x32x16_bf16 v[176:191], v[104:107], v[4:7], v[176:191]
  ds_read_b128 v[4:7], v3 offset:768
  s_waitcnt lgkmcnt(1)
  v_mfma_f32_32x32x16_bf16 v[176:191], v[108:111], v[8:11], v[176:191]
  ds_read_b128 v[8:11], v3 offset:800
  s_waitcnt lgkmcnt(1)
  v_mfma_f32_32x32x16_bf16 v[176:191], v[112:115], v[4:7], v[176:191]
  ds_read_b128 v[4:7], v3 offset:832
  s_waitcnt lgkmcnt(1)
  v_mfma_f32_32x32x16_bf16 v[176:191], v[116:119], v[8:11], v[176:191]
  ds_read_b128 v[8:11], v3 offset:864
  s_waitcnt lgkmcnt(1)
  v_mfma_f32_32x32x16_bf16 v[176:191], v[120:123], v[4:7], v[176:191]
  ds_read_b128 v[4:7], v3 offset:896
  s_waitcnt lgkmcnt(1)
  v_mfma_f32_32x32x16_bf16 v[176:191], v[124:127], v[8:11], v[176:191]
  ds_read_b128 v[8:11], v3 offset:928
  s_waitcnt lgkmcnt(1)
  v_mfma_f32_32x32x16_bf16 v[176:191], v[128:131], v[4:7], v[176:191]
  ds_read_b128 v[4:7], v3 offset:960
  s_waitcnt lgkmcnt(1)
  v_mfma_f32_32x32x16_bf16 v[176:191], v[132:135], v[8:11], v[176:191]
  ds_read_b128 v[8:11], v3 offset:992
  s_waitcnt lgkmcnt(1)
  v_mfma_f32_32x32x16_bf16 v[176:191], v[136:139], v[4:7], v[176:191]
  ds_read_b128 v[4:7], v3 offset:1024
  s_waitcnt lgkmcnt(1)
  v_mfma_f32_32x32x16_bf16 v[176:191], v[140:143], v[8:11], v[176:191]
  ds_read_b128 v[8:11], v3 offset:1056
  s_waitcnt lgkmcnt(1)
  v_mfma_f32_32x32x16_bf16 v[176:191], v[144:147], v[4:7], v[176:191]
  ds_read_b128 v[4:7], v3 offset:1088
  s_waitcnt lgkmcnt(1)
  v_mfma_f32_32x32x16_bf16 v[176:191], v[148:151], v[8:11], v[176:191]
  ds_read_b128 v[8:11], v3 offset:1120
  s_waitcnt lgkmcnt(1)
  v_mfma_f32_32x32x16_bf16 v[176:191], v[152:155], v[4:7], v[176:191]
  ds_read_b128 v[4:7], v3 offset:1152
  s_waitcnt lgkmcnt(1)
  v_mfma_f32_32x32x16_bf16 v[176:191], v[156:159], v[8:11], v[176:191]
  ds_read_b128 v[8:11], v3 offset:1184
  s_waitcnt lgkmcnt(1)
  v_mfma_f32_32x32x16_bf16 v[176:191], v[160:163], v[4:7], v[176:191]
  ds_read_b128 v[4:7], v3 offset:1216
  s_waitcnt lgkmcnt(1)
  v_mfma_f32_32x32x16_bf16 v[176:191], v[164:167], v[8:11], v[176:191]
  ds_read_b128 v[8:11], v3 offset:1248
  s_waitcnt lgkmcnt(1)
  v_mfma_f32_32x32x16_bf16 v[176:191], v[168:171], v[4:7], v[176:191]
  s_waitcnt lgkmcnt(0)
  v_mfma_f32_32x32x16_bf16 v[176:191], v[172:175], v[8:11], v[176:191]
  s_branch mpd_200
mpv_199:
  ds_read_b128 v[4:7], v3
  ds_read_b128 v[8:11], v3 offset:32
  s_waitcnt lgkmcnt(1)
  v_mfma_f32_32x32x16_bf16 v[176:191], v[4:7], v[16:19], 0
  ds_read_b128 v[4:7], v3 offset:64
  s_waitcnt lgkmcnt(1)
  v_mfma_f32_32x32x16_bf16 v[176:191], v[8:11], v[20:23], v[176:191]
  ds_read_b128 v[8:11], v3 offset:96
  s_waitcnt lgkmcnt(1)
  v_mfma_f32_32x32x16_bf16 v[176:191], v[4:7], v[24:27], v[176:191]
  ds_read_b128 v[4:7], v3 offset:128
  s_waitcnt lgkmcnt(1)
  v_mfma_f32_32x32x16_bf16 v[176:191], v[8:11], v[28:31], v[176:191]
  ds_read_b128 v[8:11], v3 offset:160
  s_waitcnt lgkmcnt(1)
  v_mfma_f32_32x32x16_bf16 v[176:191], v[4:7], v[32:35], v[176:191]
  ds_read_b128 v[4:7], v3 offset:192
  s_waitcnt lgkmcnt(1)
  v_mfma_f32_32x32x16_bf16 v[176:191], v[8:11], v[36:39], v[176:191]
  ds_read_b128 v[8:11], v3 offset:224
  s_waitcnt lgkmcnt(1)
  v_mfma_f32_32x32x16_bf16 v[176:191], v[4:7], v[40:43], v[176:191]
  ds_read_b128 v[4:7], v3 offset:256
  s_waitcnt lgkmcnt(1)
  v_mfma_f32_32x32x16_bf16 v[176:191], v[8:11], v[44:47], v[176:191]
  ds_read_b128 v[8:11], v3 offset:288
  s_waitcnt lgkmcnt(1)
  v_mfma_f32_32x32x16_bf16 v[176:191], v[4:7], v[48:51], v[176:191]
  ds_read_b128 v[4:7], v3 offset:320
  s_waitcnt lgkmcnt(1)
  v_mfma_f32_32x32x16_bf16 v[176:191], v[8:11], v[52:55], v[176:191]
  ds_read_b128 v[8:11], v3 offset:352
  s_waitcnt lgkmcnt(1)
  v_mfma_f32_32x32x16_bf16 v[176:191], v[4:7], v[56:59], v[176:191]
  ds_read_b128 v[4:7], v3 offset:384
  s_waitcnt lgkmcnt(1)
  v_mfma_f32_32x32x16_bf16 v[176:191], v[8:11], v[60:63], v[176:191]
  ds_read_b128 v[8:11], v3 offset:416
  s_waitcnt lgkmcnt(1)
  v_mfma_f32_32x32x16_bf16 v[176:191], v[4:7], v[64:67], v[176:191]
  ds_read_b128 v[4:7], v3 offset:448
  s_waitcnt lgkmcnt(1)
  v_mfma_f32_32x32x16_bf16 v[176:191], v[8:11], v[68:71], v[176:191]
  ds_read_b128 v[8:11], v3 offset:480
  s_waitcnt lgkmcnt(1)
  v_mfma_f32_32x32x16_bf16 v[176:191], v[4:7], v[72:75], v[176:191]
  ds_read_b128 v[4:7], v3 offset:512
  s_waitcnt lgkmcnt(1)
  v_mfma_f32_32x32x16_bf16 v[176:191], v[8:11], v[76:79], v[176:191]
  ds_read_b128 v[8:11], v3 offset:544
  s_waitcnt lgkmcnt(1)
  v_mfma_f32_32x32x16_bf16 v[176:191], v[4:7], v[80:83], v[176:191]
  ds_read_b128 v[4:7], v3 offset:576
  s_waitcnt lgkmcnt(1)
  v_mfma_f32_32x32x16_bf16 v[176:191], v[8:11], v[84:87], v[176:191]
  ds_read_b128 v[8:11], v3 offset:608
  s_waitcnt lgkmcnt(1)
  v_mfma_f32_32x32x16_bf16 v[176:191], v[4:7], v[88:91], v[176:191]
  ds_read_b128 v[4:7], v3 offset:640
  s_waitcnt lgkmcnt(1)
  v_mfma_f32_32x32x16_bf16 v[176:191], v[8:11], v[92:95], v[176:191]
  ds_read_b128 v[8:11], v3 offset:672
  s_waitcnt lgkmcnt(1)
  v_mfma_f32_32x32x16_bf16 v[176:191], v[4:7], v[96:99], v[176:191]
  ds_read_b128 v[4:7], v3 offset:704
  s_waitcnt lgkmcnt(1)
  v_mfma_f32_32x32x16_bf16 v[176:191], v[8:11], v[100:103], v[176:191]
  ds_read_b128 v[8:11], v3 offset:736
  s_waitcnt lgkmcnt(1)
  v_mfma_f32_32x32x16_bf16 v[176:191], v[4:7], v[104:107], v[176:191]
  ds_read_b128 v[4:7], v3 offset:768
  s_waitcnt lgkmcnt(1)
  v_mfma_f32_32x32x16_bf16 v[176:191], v[8:11], v[108:111], v[176:191]
  ds_read_b128 v[8:11], v3 offset:800
  s_waitcnt lgkmcnt(1)
  v_mfma_f32_32x32x16_bf16 v[176:191], v[4:7], v[112:115], v[176:191]
  ds_read_b128 v[4:7], v3 offset:832
  s_waitcnt lgkmcnt(1)
  v_mfma_f32_32x32x16_bf16 v[176:191], v[8:11], v[116:119], v[176:191]
  ds_read_b128 v[8:11], v3 offset:864
  s_waitcnt lgkmcnt(1)
  v_mfma_f32_32x32x16_bf16 v[176:191], v[4:7], v[120:123], v[176:191]
  ds_read_b128 v[4:7], v3 offset:896
  s_waitcnt lgkmcnt(1)
  v_mfma_f32_32x32x16_bf16 v[176:191], v[8:11], v[124:127], v[176:191]
  ds_read_b128 v[8:11], v3 offset:928
  s_waitcnt lgkmcnt(1)
  v_mfma_f32_32x32x16_bf16 v[176:191], v[4:7], v[128:131], v[176:191]
  ds_read_b128 v[4:7], v3 offset:960
  s_waitcnt lgkmcnt(1)
  v_mfma_f32_32x32x16_bf16 v[176:191], v[8:11], v[132:135], v[176:191]
  ds_read_b128 v[8:11], v3 offset:992
  s_waitcnt lgkmcnt(1)
  v_mfma_f32_32x32x16_bf16 v[176:191], v[4:7], v[136:139], v[176:191]
  ds_read_b128 v[4:7], v3 offset:1024
  s_waitcnt lgkmcnt(1)
  v_mfma_f32_32x32x16_bf16 v[176:191], v[8:11], v[140:143], v[176:191]
  ds_read_b128 v[8:11], v3 offset:1056
  s_waitcnt lgkmcnt(1)
  v_mfma_f32_32x32x16_bf16 v[176:191], v[4:7], v[144:147], v[176:191]
  ds_read_b128 v[4:7], v3 offset:1088
  s_waitcnt lgkmcnt(1)
  v_mfma_f32_32x32x16_bf16 v[176:191], v[8:11], v[148:151], v[176:191]
  ds_read_b128 v[8:11], v3 offset:1120
  s_waitcnt lgkmcnt(1)
  v_mfma_f32_32x32x16_bf16 v[176:191], v[4:7], v[152:155], v[176:191]
  ds_read_b128 v[4:7], v3 offset:1152
  s_waitcnt lgkmcnt(1)
  v_mfma_f32_32x32x16_bf16 v[176:191], v[8:11], v[156:159], v[176:191]
  ds_read_b128 v[8:11], v3 offset:1184
  s_waitcnt lgkmcnt(1)
  v_mfma_f32_32x32x16_bf16 v[176:191], v[4:7], v[160:163], v[176:191]
  ds_read_b128 v[4:7], v3 offset:1216
  s_waitcnt lgkmcnt(1)
  v_mfma_f32_32x32x16_bf16 v[176:191], v[8:11], v[164:167], v[176:191]
  ds_read_b128 v[8:11], v3 offset:1248
  s_waitcnt lgkmcnt(1)
  v_mfma_f32_32x32x16_bf16 v[176:191], v[4:7], v[168:171], v[176:191]
  s_waitcnt lgkmcnt(0)
  v_mfma_f32_32x32x16_bf16 v[176:191], v[8:11], v[172:175], v[176:191]
mpd_200:
  s_lshl_b32 s34, s42, 13
  s_and_b32 s35, s30, 3
  v_lshrrev_b32 v10, 5, v1
  v_and_b32 v11, 15, v1
  v_lshl_add_u32 v11, v10, 4, v11
  v_lshlrev_b32 v11, 4, v11
  v_bfe_u32 v10, v1, 4, 1
  s_lshr_b32 s36, s30, 2
  s_sub_u32 s36, 2, s36
  s_lshl_b32 s36, s36, 18
  s_lshl_b32 s37, s43, 24
  s_add_u32 s36, s36, s37
  s_cmp_eq_u32 s43, 2
  s_cbranch_scc1 L_mp_vb1
  s_lshl_b32 s35, s35, 10
  v_lshl_add_u32 v11, v10, 12, v11
  v_cvt_pk_bf16_f32 v176, v176, v177
  v_cvt_pk_bf16_f32 v177, v178, v179
  v_cvt_pk_bf16_f32 v178, v180, v181
  v_cvt_pk_bf16_f32 v179, v182, v183
  v_cvt_pk_bf16_f32 v180, v184, v185
  v_cvt_pk_bf16_f32 v181, v186, v187
  v_cvt_pk_bf16_f32 v182, v188, v189
  v_cvt_pk_bf16_f32 v183, v190, v191
  s_branch L_mp_sb1
L_mp_vb1:
  s_lshl_b32 s35, s35, 11
  v_lshl_add_u32 v11, v10, 10, v11
  v_cvt_pk_bf16_f32 v176, v176, v177
  v_cvt_pk_bf16_f32 v177, v178, v179
  v_cvt_pk_bf16_f32 v178, v184, v185
  v_cvt_pk_bf16_f32 v179, v186, v187
  v_cvt_pk_bf16_f32 v180, v180, v181
  v_cvt_pk_bf16_f32 v181, v182, v183
  v_cvt_pk_bf16_f32 v182, v188, v189
  v_cvt_pk_bf16_f32 v183, v190, v191
L_mp_sb1:
  s_add_u32 s34, s34, s35
  v_add_u32 v11, s34, v11
  buffer_store_dwordx4 v[176:179], v11, s[8:11], s36 offen sc1
  buffer_store_dwordx4 v[180:183], v11, s[8:11], s36 offen offset:512 sc1
  s_waitcnt vmcnt(0)
  s_barrier
  s_cmp_lg_u32 s30, 0
  s_cbranch_scc1 mpf_201
  s_lshl_b32 s34, s41, 2
  s_add_u32 s34, s34, 1024
  s_add_u32 s34, s34, s100
  v_mov_b32 v10, s34
  v_mov_b32 v11, 3
  s_mov_b64 exec, 1
  buffer_store_dword v11, v10, s[8:11], 0 offen sc1
  s_mov_b64 exec, -1
mpf_201:
  s_barrier
L_b_nomini:
  s_sleep 127
  s_load_dwordx2 s[4:5], s[0:1], 64
  s_load_dwordx2 s[6:7], s[0:1], 56
  s_waitcnt lgkmcnt(0)
  s_mov_b32 s16, s4
  s_and_b32 s17, s5, 0xffff
  s_mov_b32 s18, 0x258000
  s_mov_b32 s19, 0x20000
  s_mov_b32 s20, s6
  s_and_b32 s21, s7, 0xffff
  s_mov_b32 s22, 0x280000
  s_mov_b32 s23, 0x20000
  s_cmp_ge_u32 s41, 48
  s_cbranch_scc1 L_b2v
  s_mul_i32 s34, s41, 43
  s_lshr_b32 s34, s34, 9
  s_mul_i32 s35, s34, 12
  s_sub_u32 s35, s41, s35
  s_lshl_b32 s47, s34, 4
  s_lshr_b32 s42, s35, 2
  s_and_b32 s43, s35, 3
  s_mul_i32 s46, s42, 1280
  s_mul_i32 s34, s43, 320
  s_add_u32 s46, s46, s34
  v_lshlrev_b32 v2, 4, v0
  v_add_u32 v10, 0, v0
  v_mul_u32_u24 v11, 52429, v10
  v_lshrrev_b32 v11, 22, v11
  v_add_u32 v11, v11, v10
  v_lshlrev_b32 v3, 4, v11
  v_add_u32 v10, 512, v0
  v_mul_u32_u24 v11, 52429, v10
  v_lshrrev_b32 v11, 22, v11
  v_add_u32 v11, v11, v10
  v_lshlrev_b32 v4, 4, v11
  v_add_u32 v10, 1024, v0
  v_mul_u32_u24 v11, 52429, v10
  v_lshrrev_b32 v11, 22, v11
  v_add_u32 v11, v11, v10
  v_lshlrev_b32 v5, 4, v11
  v_add_u32 v10, 1536, v0
  v_mul_u32_u24 v11, 52429, v10
  v_lshrrev_b32 v11, 22, v11
  v_add_u32 v11, v11, v10
  v_lshlrev_b32 v6, 4, v11
  v_add_u32 v10, 2048, v0
  v_mul_u32_u24 v11, 52429, v10
  v_lshrrev_b32 v11, 22, v11
  v_add_u32 v11, v11, v10
  v_lshlrev_b32 v7, 4, v11
  s_mul_i32 s34, s47, 40960
  buffer_load_dwordx4 v[204:207], v2, s[20:23], s34 offen
  s_add_u32 s34, s34, 8192
  buffer_load_dwordx4 v[208:211], v2, s[20:23], s34 offen
  s_add_u32 s34, s34, 8192
  buffer_load_dwordx4 v[212:215], v2, s[20:23], s34 offen
  s_add_u32 s34, s34, 8192
  buffer_load_dwordx4 v[216:219], v2, s[20:23], s34 offen
  s_add_u32 s34, s34, 8192
  buffer_load_dwordx4 v[220:223], v2, s[20:23], s34 offen
  s_add_u32 s34, s34, 8192
  v_lshrrev_b32 v10, 4, v1
  v_lshrrev_b32 v11, 1, v10
  v_and_b32 v10, 1, v10
  v_bfe_u32 v14, v1, 2, 2
  v_lshl_add_u32 v11, v11, 3, v14
  v_mul_u32_u24 v11, 320, v11
  v_lshl_add_u32 v11, v10, 5, v11
  v_and_b32 v10, 3, v1
  v_lshl_add_u32 v11, v10, 3, v11
  s_mul_i32 s34, s30, 40
  v_add_u32 v14, s34, v11
  v_add_u32 v9, 0, v0
  v_mul_u32_u24 v13, 52429, v9
  v_lshrrev_b32 v13, 20, v13
  v_mul_u32_u24 v8, 20, v13
  v_sub_u32 v8, v9, v8
  v_mul_u32_u24 v13, 3840, v13
  v_lshl_add_u32 v13, v8, 4, v13
  v_add_u32 v10, s46, v13
  v_add_u32 v9, 512, v0
  v_mul_u32_u24 v13, 52429, v9
  v_lshrrev_b32 v13, 20, v13
  v_mul_u32_u24 v8, 20, v13
  v_sub_u32 v8, v9, v8
  v_mul_u32_u24 v13, 3840, v13
  v_lshl_add_u32 v13, v8, 4, v13
  v_add_u32 v11, s46, v13
  v_add_u32 v9, 1024, v0
  v_mul_u32_u24 v13, 52429, v9
  v_lshrrev_b32 v13, 20, v13
  v_mul_u32_u24 v8, 20, v13
  v_sub_u32 v8, v9, v8
  v_mul_u32_u24 v13, 3840, v13
  v_lshl_add_u32 v13, v8, 4, v13
  v_add_u32 v12, s46, v13
  s_mov_b32 s34, 0
  buffer_load_dwordx4 v[232:235], v10, s[16:19], s34 offen
  buffer_load_dwordx4 v[236:239], v11, s[16:19], s34 offen
  buffer_load_dwordx4 v[240:243], v12, s[16:19], s34 offen
  s_mov_b32 s34, 245760
  buffer_load_dwordx4 v[244:247], v10, s[16:19], s34 offen
  buffer_load_dwordx4 v[248:251], v11, s[16:19], s34 offen
  buffer_load_dwordx4 v[252:255], v12, s[16:19], s34 offen
  s_waitcnt vmcnt(3)
  ds_write_b128 v2, v[232:235] offset:0
  ds_write_b128 v2, v[236:239] offset:8192
  ds_write_b128 v2, v[240:243] offset:16384
  s_waitcnt lgkmcnt(0)
  s_mov_b32 s34, 491520
  buffer_load_dwordx4 v[232:235], v10, s[16:19], s34 offen
  buffer_load_dwordx4 v[236:239], v11, s[16:19], s34 offen
  buffer_load_dwordx4 v[240:243], v12, s[16:19], s34 offen
  s_barrier
  ds_read_b64_tr_b16 v[16:17], v14 offset:0
  ds_read_b64_tr_b16 v[18:19], v14 offset:1280
  ds_read_b64_tr_b16 v[20:21], v14 offset:5120
  ds_read_b64_tr_b16 v[22:23], v14 offset:6400
  ds_read_b64_tr_b16 v[24:25], v14 offset:10240
  ds_read_b64_tr_b16 v[26:27], v14 offset:11520
  ds_read_b64_tr_b16 v[28:29], v14 offset:15360
  ds_read_b64_tr_b16 v[30:31], v14 offset:16640
  s_waitcnt lgkmcnt(0)
  s_waitcnt vmcnt(3)
  ds_write_b128 v2, v[244:247] offset:24576
  ds_write_b128 v2, v[248:251] offset:32768
  ds_write_b128 v2, v[252:255] offset:40960
  s_waitcnt lgkmcnt(0)
  s_mov_b32 s34, 737280
  buffer_load_dwordx4 v[244:247], v10, s[16:19], s34 offen
  buffer_load_dwordx4 v[248:251], v11, s[16:19], s34 offen
  buffer_load_dwordx4 v[252:255], v12, s[16:19], s34 offen
  s_barrier
  ds_read_b64_tr_b16 v[32:33], v14 offset:24576
  ds_read_b64_tr_b16 v[34:35], v14 offset:25856
  ds_read_b64_tr_b16 v[36:37], v14 offset:29696
  ds_read_b64_tr_b16 v[38:39], v14 offset:30976
  ds_read_b64_tr_b16 v[40:41], v14 offset:34816
  ds_read_b64_tr_b16 v[42:43], v14 offset:36096
  ds_read_b64_tr_b16 v[44:45], v14 offset:39936
  ds_read_b64_tr_b16 v[46:47], v14 offset:41216
  s_waitcnt lgkmcnt(0)
  s_waitcnt vmcnt(3)
  ds_write_b128 v2, v[232:235] offset:0
  ds_write_b128 v2, v[236:239] offset:8192
  ds_write_b128 v2, v[240:243] offset:16384
  s_waitcnt lgkmcnt(0)
  s_mov_b32 s34, 983040
  buffer_load_dwordx4 v[232:235], v10, s[16:19], s34 offen
  buffer_load_dwordx4 v[236:239], v11, s[16:19], s34 offen
  buffer_load_dwordx4 v[240:243], v12, s[16:19], s34 offen
  s_barrier
  ds_read_b64_tr_b16 v[48:49], v14 offset:0
  ds_read_b64_tr_b16 v[50:51], v14 offset:1280
  ds_read_b64_tr_b16 v[52:53], v14 offset:5120
  ds_read_b64_tr_b16 v[54:55], v14 offset:6400
  ds_read_b64_tr_b16 v[56:57], v14 offset:10240
  ds_read_b64_tr_b16 v[58:59], v14 offset:11520
  ds_read_b64_tr_b16 v[60:61], v14 offset:15360
  ds_read_b64_tr_b16 v[62:63], v14 offset:16640
  s_waitcnt lgkmcnt(0)
  s_waitcnt vmcnt(3)
  ds_write_b128 v2, v[244:247] offset:24576
  ds_write_b128 v2, v[248:251] offset:32768
  ds_write_b128 v2, v[252:255] offset:40960
  s_waitcnt lgkmcnt(0)
  s_mov_b32 s34, 1228800
  buffer_load_dwordx4 v[244:247], v10, s[16:19], s34 offen
  buffer_load_dwordx4 v[248:251], v11, s[16:19], s34 offen
  buffer_load_dwordx4 v[252:255], v12, s[16:19], s34 offen
  s_barrier
  ds_read_b64_tr_b16 v[64:65], v14 offset:24576
  ds_read_b64_tr_b16 v[66:67], v14 offset:25856
  ds_read_b64_tr_b16 v[68:69], v14 offset:29696
  ds_read_b64_tr_b16 v[70:71], v14 offset:30976
  ds_read_b64_tr_b16 v[72:73], v14 offset:34816
  ds_read_b64_tr_b16 v[74:75], v14 offset:36096
  ds_read_b64_tr_b16 v[76:77], v14 offset:39936
  ds_read_b64_tr_b16 v[78:79], v14 offset:41216
  s_waitcnt lgkmcnt(0)
  s_waitcnt vmcnt(3)
  ds_write_b128 v2, v[232:235] offset:0
  ds_write_b128 v2, v[236:239] offset:8192
  ds_write_b128 v2, v[240:243] offset:16384
  s_waitcnt lgkmcnt(0)
  s_mov_b32 s34, 1474560
  buffer_load_dwordx4 v[232:235], v10, s[16:19], s34 offen
  buffer_load_dwordx4 v[236:239], v11, s[16:19], s34 offen
  buffer_load_dwordx4 v[240:243], v12, s[16:19], s34 offen
  s_barrier
  ds_read_b64_tr_b16 v[80:81], v14 offset:0
  ds_read_b64_tr_b16 v[82:83], v14 offset:1280
  ds_read_b64_tr_b16 v[84:85], v14 offset:5120
  ds_read_b64_tr_b16 v[86:87], v14 offset:6400
  ds_read_b64_tr_b16 v[88:89], v14 offset:10240
  ds_read_b64_tr_b16 v[90:91], v14 offset:11520
  ds_read_b64_tr_b16 v[92:93], v14 offset:15360
  ds_read_b64_tr_b16 v[94:95], v14 offset:16640
  s_waitcnt lgkmcnt(0)
  s_waitcnt vmcnt(3)
  ds_write_b128 v2, v[244:247] offset:24576
  ds_write_b128 v2, v[248:251] offset:32768
  ds_write_b128 v2, v[252:255] offset:40960
  s_waitcnt lgkmcnt(0)
  s_mov_b32 s34, 1720320
  buffer_load_dwordx4 v[244:247], v10, s[16:19], s34 offen
  buffer_load_dwordx4 v[248:251], v11, s[16:19], s34 offen
  buffer_load_dwordx4 v[252:255], v12, s[16:19], s34 offen
  s_barrier
  ds_read_b64_tr_b16 v[96:97], v14 offset:24576
  ds_read_b64_tr_b16 v[98:99], v14 offset:25856
  ds_read_b64_tr_b16 v[100:101], v14 offset:29696
  ds_read_b64_tr_b16 v[102:103], v14 offset:30976
  ds_read_b64_tr_b16 v[104:105], v14 offset:34816
  ds_read_b64_tr_b16 v[106:107], v14 offset:36096
  ds_read_b64_tr_b16 v[108:109], v14 offset:39936
  ds_read_b64_tr_b16 v[110:111], v14 offset:41216
  s_waitcnt lgkmcnt(0)
  s_waitcnt vmcnt(3)
  ds_write_b128 v2, v[232:235] offset:0
  ds_write_b128 v2, v[236:239] offset:8192
  ds_write_b128 v2, v[240:243] offset:16384
  s_waitcnt lgkmcnt(0)
  s_mov_b32 s34, 1966080
  buffer_load_dwordx4 v[232:235], v10, s[16:19], s34 offen
  buffer_load_dwordx4 v[236:239], v11, s[16:19], s34 offen
  buffer_load_dwordx4 v[240:243], v12, s[16:19], s34 offen
  s_barrier
  ds_read_b64_tr_b16 v[112:113], v14 offset:0
  ds_read_b64_tr_b16 v[114:115], v14 offset:1280
  ds_read_b64_tr_b16 v[116:117], v14 offset:5120
  ds_read_b64_tr_b16 v[118:119], v14 offset:6400
  ds_read_b64_tr_b16 v[120:121], v14 offset:10240
  ds_read_b64_tr_b16 v[122:123], v14 offset:11520
  ds_read_b64_tr_b16 v[124:125], v14 offset:15360
  ds_read_b64_tr_b16 v[126:127], v14 offset:16640
  s_waitcnt lgkmcnt(0)
  s_waitcnt vmcnt(3)
  ds_write_b128 v2, v[244:247] offset:24576
  ds_write_b128 v2, v[248:251] offset:32768
  ds_write_b128 v2, v[252:255] offset:40960
  s_waitcnt lgkmcnt(0)
  s_mov_b32 s34, 2211840
  buffer_load_dwordx4 v[244:247], v10, s[16:19], s34 offen
  buffer_load_dwordx4 v[248:251], v11, s[16:19], s34 offen
  buffer_load_dwordx4 v[252:255], v12, s[16:19], s34 offen
  s_barrier
  ds_read_b64_tr_b16 v[128:129], v14 offset:24576
  ds_read_b64_tr_b16 v[130:131], v14 offset:25856
  ds_read_b64_tr_b16 v[132:133], v14 offset:29696
  ds_read_b64_tr_b16 v[134:135], v14 offset:30976
  ds_read_b64_tr_b16 v[136:137], v14 offset:34816
  ds_read_b64_tr_b16 v[138:139], v14 offset:36096
  ds_read_b64_tr_b16 v[140:141], v14 offset:39936
  ds_read_b64_tr_b16 v[142:143], v14 offset:41216
  s_waitcnt lgkmcnt(0)
  s_waitcnt vmcnt(3)
  ds_write_b128 v2, v[232:235] offset:0
  ds_write_b128 v2, v[236:239] offset:8192
  ds_write_b128 v2, v[240:243] offset:16384
  s_waitcnt lgkmcnt(0)
  s_barrier
  ds_read_b64_tr_b16 v[144:145], v14 offset:0
  ds_read_b64_tr_b16 v[146:147], v14 offset:1280
  ds_read_b64_tr_b16 v[148:149], v14 offset:5120
  ds_read_b64_tr_b16 v[150:151], v14 offset:6400
  ds_read_b64_tr_b16 v[152:153], v14 offset:10240
  ds_read_b64_tr_b16 v[154:155], v14 offset:11520
  ds_read_b64_tr_b16 v[156:157], v14 offset:15360
  ds_read_b64_tr_b16 v[158:159], v14 offset:16640
  s_waitcnt lgkmcnt(0)
  s_waitcnt vmcnt(0)
  ds_write_b128 v2, v[244:247] offset:24576
  ds_write_b128 v2, v[248:251] offset:32768
  ds_write_b128 v2, v[252:255] offset:40960
  s_waitcnt lgkmcnt(0)
  s_barrier
  ds_read_b64_tr_b16 v[160:161], v14 offset:24576
  ds_read_b64_tr_b16 v[162:163], v14 offset:25856
  ds_read_b64_tr_b16 v[164:165], v14 offset:29696
  ds_read_b64_tr_b16 v[166:167], v14 offset:30976
  ds_read_b64_tr_b16 v[168:169], v14 offset:34816
  ds_read_b64_tr_b16 v[170:171], v14 offset:36096
  ds_read_b64_tr_b16 v[172:173], v14 offset:39936
  ds_read_b64_tr_b16 v[174:175], v14 offset:41216
  s_waitcnt lgkmcnt(0)
  s_barrier
  v_and_b32 v10, 31, v1
  v_mul_u32_u24 v10, 1296, v10
  v_lshrrev_b32 v11, 5, v1
  v_lshl_add_u32 v9, v11, 4, v10
  ds_write_b128 v3, v[204:207]
  ds_write_b128 v4, v[208:211]
  ds_write_b128 v5, v[212:215]
  ds_write_b128 v6, v[216:219]
  ds_write_b128 v7, v[220:223]
  s_waitcnt lgkmcnt(0)
  s_add_u32 s34, s47, 1
  s_mul_i32 s34, s34, 40960
  buffer_load_dwordx4 v[204:207], v2, s[20:23], s34 offen
  s_add_u32 s34, s34, 8192
  buffer_load_dwordx4 v[208:211], v2, s[20:23], s34 offen
  s_add_u32 s34, s34, 8192
  buffer_load_dwordx4 v[212:215], v2, s[20:23], s34 offen
  s_add_u32 s34, s34, 8192
  buffer_load_dwordx4 v[216:219], v2, s[20:23], s34 offen
  s_add_u32 s34, s34, 8192
  buffer_load_dwordx4 v[220:223], v2, s[20:23], s34 offen
  s_add_u32 s34, s34, 8192
  s_cmp_lg_u32 s31, 0
  s_cbranch_scc1 valok_204
  v_lshlrev_b32 v10, 2, v1
  s_mov_b32 s39, 0
val_202:
  buffer_load_dword v11, v10, s[12:15], 0 offen sc1
  s_waitcnt vmcnt(0)
  v_cmp_eq_u32 vcc, 32, v11
s_nop 3
  s_and_b32 s34, vcc_lo, vcc_hi
  s_and_b32 s34, s34, 0x5555
  s_cmp_eq_u32 s34, 0x5555
  s_cbranch_scc0 valg_203_s
  v_readlane_b32 s32, v11, 1
  s_mov_b32 s34, 0
  s_cmp_eq_u32 s34, 0
  s_cbranch_scc1 valg_203
valg_203_s:
  s_mov_b32 s36, 0
  s_mov_b32 s37, 0
  s_mov_b32 s38, 0
  s_mov_b32 s34, 0
  v_readlane_b32 s35, v11, 2
s_nop 3
  s_add_u32 s38, s38, s35
  v_readlane_b32 s35, v11, 0
s_nop 3
  s_add_u32 s36, s36, s35
  s_cmp_eq_u32 s35, 32
  s_cselect_b32 s97, 0, 1
  s_or_b32 s34, s34, s97
  s_cmp_gt_u32 s98, 0
  s_cselect_b32 s35, s35, 0
  s_add_u32 s37, s37, s35
  v_readlane_b32 s35, v11, 6
s_nop 3
  s_add_u32 s38, s38, s35
  v_readlane_b32 s35, v11, 4
s_nop 3
  s_add_u32 s36, s36, s35
  s_cmp_eq_u32 s35, 32
  s_cselect_b32 s97, 0, 1
  s_or_b32 s34, s34, s97
  s_cmp_gt_u32 s98, 1
  s_cselect_b32 s35, s35, 0
  s_add_u32 s37, s37, s35
  v_readlane_b32 s35, v11, 10
s_nop 3
  s_add_u32 s38, s38, s35
  v_readlane_b32 s35, v11, 8
s_nop 3
  s_add_u32 s36, s36, s35
  s_cmp_eq_u32 s35, 32
  s_cselect_b32 s97, 0, 1
  s_or_b32 s34, s34, s97
  s_cmp_gt_u32 s98, 2
  s_cselect_b32 s35, s35, 0
  s_add_u32 s37, s37, s35
  v_readlane_b32 s35, v11, 14
s_nop 3
  s_add_u32 s38, s38, s35
  v_readlane_b32 s35, v11, 12
s_nop 3
  s_add_u32 s36, s36, s35
  s_cmp_eq_u32 s35, 32
  s_cselect_b32 s97, 0, 1
  s_or_b32 s34, s34, s97
  s_cmp_gt_u32 s98, 3
  s_cselect_b32 s35, s35, 0
  s_add_u32 s37, s37, s35
  v_readlane_b32 s35, v11, 34
s_nop 3
  s_add_u32 s38, s38, s35
  v_readlane_b32 s35, v11, 32
s_nop 3
  s_add_u32 s36, s36, s35
  s_cmp_eq_u32 s35, 32
  s_cselect_b32 s97, 0, 1
  s_or_b32 s34, s34, s97
  s_cmp_gt_u32 s98, 4
  s_cselect_b32 s35, s35, 0
  s_add_u32 s37, s37, s35
  v_readlane_b32 s35, v11, 38
s_nop 3
  s_add_u32 s38, s38, s35
  v_readlane_b32 s35, v11, 36
s_nop 3
  s_add_u32 s36, s36, s35
  s_cmp_eq_u32 s35, 32
  s_cselect_b32 s97, 0, 1
  s_or_b32 s34, s34, s97
  s_cmp_gt_u32 s98, 5
  s_cselect_b32 s35, s35, 0
  s_add_u32 s37, s37, s35
  v_readlane_b32 s35, v11, 42
s_nop 3
  s_add_u32 s38, s38, s35
  v_readlane_b32 s35, v11, 40
s_nop 3
  s_add_u32 s36, s36, s35
  s_cmp_eq_u32 s35, 32
  s_cselect_b32 s97, 0, 1
  s_or_b32 s34, s34, s97
  s_cmp_gt_u32 s98, 6
  s_cselect_b32 s35, s35, 0
  s_add_u32 s37, s37, s35
  v_readlane_b32 s35, v11, 46
s_nop 3
  s_add_u32 s38, s38, s35
  v_readlane_b32 s35, v11, 44
s_nop 3
  s_add_u32 s36, s36, s35
  s_cmp_eq_u32 s35, 32
  s_cselect_b32 s97, 0, 1
  s_or_b32 s34, s34, s97
  s_cmp_gt_u32 s98, 7
  s_cselect_b32 s35, s35, 0
  s_add_u32 s37, s37, s35
  v_readlane_b32 s35, v11, 18
s_nop 3
  s_add_u32 s38, s38, s35
  v_readlane_b32 s35, v11, 16
s_nop 3
  s_add_u32 s36, s36, s35
  s_cmp_eq_u32 s35, 0
  s_cselect_b32 s97, 0, 1
  s_or_b32 s34, s34, s97
  s_cmp_gt_u32 s98, 8
  s_cselect_b32 s35, s35, 0
  s_add_u32 s37, s37, s35
  v_readlane_b32 s35, v11, 22
s_nop 3
  s_add_u32 s38, s38, s35
  v_readlane_b32 s35, v11, 20
s_nop 3
  s_add_u32 s36, s36, s35
  s_cmp_eq_u32 s35, 0
  s_cselect_b32 s97, 0, 1
  s_or_b32 s34, s34, s97
  s_cmp_gt_u32 s98, 9
  s_cselect_b32 s35, s35, 0
  s_add_u32 s37, s37, s35
  v_readlane_b32 s35, v11, 26
s_nop 3
  s_add_u32 s38, s38, s35
  v_readlane_b32 s35, v11, 24
s_nop 3
  s_add_u32 s36, s36, s35
  s_cmp_eq_u32 s35, 0
  s_cselect_b32 s97, 0, 1
  s_or_b32 s34, s34, s97
  s_cmp_gt_u32 s98, 10
  s_cselect_b32 s35, s35, 0
  s_add_u32 s37, s37, s35
  v_readlane_b32 s35, v11, 30
s_nop 3
  s_add_u32 s38, s38, s35
  v_readlane_b32 s35, v11, 28
s_nop 3
  s_add_u32 s36, s36, s35
  s_cmp_eq_u32 s35, 0
  s_cselect_b32 s97, 0, 1
  s_or_b32 s34, s34, s97
  s_cmp_gt_u32 s98, 11
  s_cselect_b32 s35, s35, 0
  s_add_u32 s37, s37, s35
  v_readlane_b32 s35, v11, 50
s_nop 3
  s_add_u32 s38, s38, s35
  v_readlane_b32 s35, v11, 48
s_nop 3
  s_add_u32 s36, s36, s35
  s_cmp_eq_u32 s35, 0
  s_cselect_b32 s97, 0, 1
  s_or_b32 s34, s34, s97
  s_cmp_gt_u32 s98, 12
  s_cselect_b32 s35, s35, 0
  s_add_u32 s37, s37, s35
  v_readlane_b32 s35, v11, 54
s_nop 3
  s_add_u32 s38, s38, s35
  v_readlane_b32 s35, v11, 52
s_nop 3
  s_add_u32 s36, s36, s35
  s_cmp_eq_u32 s35, 0
  s_cselect_b32 s97, 0, 1
  s_or_b32 s34, s34, s97
  s_cmp_gt_u32 s98, 13
  s_cselect_b32 s35, s35, 0
  s_add_u32 s37, s37, s35
  v_readlane_b32 s35, v11, 58
s_nop 3
  s_add_u32 s38, s38, s35
  v_readlane_b32 s35, v11, 56
s_nop 3
  s_add_u32 s36, s36, s35
  s_cmp_eq_u32 s35, 0
  s_cselect_b32 s97, 0, 1
  s_or_b32 s34, s34, s97
  s_cmp_gt_u32 s98, 14
  s_cselect_b32 s35, s35, 0
  s_add_u32 s37, s37, s35
  v_readlane_b32 s35, v11, 62
s_nop 3
  s_add_u32 s38, s38, s35
  v_readlane_b32 s35, v11, 60
s_nop 3
  s_add_u32 s36, s36, s35
  s_cmp_eq_u32 s35, 0
  s_cselect_b32 s97, 0, 1
  s_or_b32 s34, s34, s97
  s_cmp_gt_u32 s98, 15
  s_cselect_b32 s35, s35, 0
  s_add_u32 s37, s37, s35
  v_readlane_b32 s32, v11, 1
  s_cmp_eq_u32 s36, 256
  s_cselect_b32 s35, s38, 0
  s_cmp_eq_u32 s35, 256
  s_cbranch_scc1 valg_203
  s_sleep 2
  s_add_u32 s39, s39, 1
  s_cmp_lt_u32 s39, s33
  s_cbranch_scc1 val_202
  s_mov_b32 s33, 0
valg_203:
s_nop 0
  s_and_b32 s32, s32, 2
  s_lshl_b32 s32, s32, 12
  s_cmp_eq_u32 s34, 0
  s_cbranch_scc1 valok_204
  s_mov_b32 s31, 1
  s_mov_b32 s32, 0
  s_add_u32 s37, s37, s99
  s_and_b32 s37, s37, 255
  s_lshr_b32 s28, s37, 5
  s_and_b32 s29, s37, 31
  s_barrier
  s_branch L_dispatch
valok_204:
  s_cmp_lg_u32 s31, 0
  s_cbranch_scc1 pwd_206
  s_mov_b32 s39, 0
  v_mov_b32 v13, 4
pw_205:
  buffer_load_dword v12, v13, s[12:15], 0 offen sc1
  s_waitcnt vmcnt(0)
  v_readfirstlane_b32 s32, v12
s_nop 3
  s_cmp_lg_u32 s32, 0
  s_cbranch_scc1 pw_205_g
  s_sleep 2
  s_add_u32 s39, s39, 1
  s_cmp_lt_u32 s39, s33
  s_cbranch_scc1 pw_205
  s_mov_b32 s33, 0
pw_205_g:
  s_and_b32 s32, s32, 2
  s_lshl_b32 s32, s32, 12
pwd_206:
  s_xor_b32 s100, s32, 8192
  s_add_u32 s101, s100, 3817472
  s_add_u32 s100, s100, 3801088
  s_lshl_b32 s34, s43, 3
  s_add_u32 s34, s34, s30
  s_lshl_b32 s34, s34, 17
  s_mov_b32 s35, 108
  s_cmp_eq_u32 s42, 0
  s_cselect_b32 s35, s35, 96
  s_cmp_eq_u32 s42, 2
  s_cselect_b32 s35, 100, s35
  s_lshl_b32 s35, s35, 20
  s_add_u32 s44, s34, s35
  v_lshlrev_b32 v8, 4, v1
  s_mov_b32 s48, 0x3ea52b5c
  s_cmp_eq_u32 s42, 0
  s_cselect_b32 s48, s48, 1.0
  s_cselect_b32 s49, 0, 0x3f80
  s_mov_b32 s50, 0
  s_mov_b32 s51, -1
  v_and_b32 v12, 31, v1
  v_cmp_gt_u32 vcc, 20, v12
s_nop 3
  s_mov_b64 s[52:53], vcc
  v_cmp_eq_u32 vcc, 20, v12
  v_mov_b32 v13, 0x3f803f80
s_nop 0
  v_cndmask_b32 v13, 0, v13, vcc
  s_mov_b32 s40, 0
  s_waitcnt vmcnt(0)
  s_barrier
L_b1_loop:
  s_and_b32 s34, s40, 1
  s_mul_i32 s35, s34, 41472
  v_add_u32 v10, s35, v9
  s_xor_b32 s34, s34, 1
  s_mul_i32 s35, s34, 41472
  s_cmp_ge_u32 s40, 15
  s_cbranch_scc1 L_b1_nost
  v_add_u32 v11, s35, v3
  ds_write_b128 v11, v[204:207]
  v_add_u32 v11, s35, v4
  ds_write_b128 v11, v[208:211]
  v_add_u32 v11, s35, v5
  ds_write_b128 v11, v[212:215]
  v_add_u32 v11, s35, v6
  ds_write_b128 v11, v[216:219]
  v_add_u32 v11, s35, v7
  ds_write_b128 v11, v[220:223]
  s_waitcnt lgkmcnt(0)
  s_cmp_ge_u32 s40, 14
  s_cbranch_scc1 L_b1_nost
  s_add_u32 s34, s40, 2
  s_add_u32 s34, s34, s47
  s_mul_i32 s34, s34, 40960
  buffer_load_dwordx4 v[204:207], v2, s[20:23], s34 offen
  s_add_u32 s34, s34, 8192
  buffer_load_dwordx4 v[208:211], v2, s[20:23], s34 offen
  s_add_u32 s34, s34, 8192
  buffer_load_dwordx4 v[212:215], v2, s[20:23], s34 offen
  s_add_u32 s34, s34, 8192
  buffer_load_dwordx4 v[216:219], v2, s[20:23], s34 offen
  s_add_u32 s34, s34, 8192
  buffer_load_dwordx4 v[220:223], v2, s[20:23], s34 offen
L_b1_nost:
  s_cmp_eq_u32 s42, 2
  s_cbranch_scc1 L_b1_v1
  ds_read_b128 v[192:195], v10 offset:0
  ds_read_b128 v[196:199], v10 offset:32
  ds_read_b128 v[200:203], v10 offset:64
  s_waitcnt lgkmcnt(2)
  v_mfma_f32_32x32x16_bf16 v[176:191], v[16:19], v[192:195], 0
  ds_read_b128 v[192:195], v10 offset:96
  s_waitcnt lgkmcnt(2)
  v_mfma_f32_32x32x16_bf16 v[176:191], v[20:23], v[196:199], v[176:191]
  ds_read_b128 v[196:199], v10 offset:128
  s_waitcnt lgkmcnt(2)
  v_mfma_f32_32x32x16_bf16 v[176:191], v[24:27], v[200:203], v[176:191]
  ds_read_b128 v[200:203], v10 offset:160
  s_waitcnt lgkmcnt(2)
  v_mfma_f32_32x32x16_bf16 v[176:191], v[28:31], v[192:195], v[176:191]
  ds_read_b128 v[192:195], v10 offset:192
  s_waitcnt lgkmcnt(2)
  v_mfma_f32_32x32x16_bf16 v[176:191], v[32:35], v[196:199], v[176:191]
  ds_read_b128 v[196:199], v10 offset:224
  s_waitcnt lgkmcnt(2)
  v_mfma_f32_32x32x16_bf16 v[176:191], v[36:39], v[200:203], v[176:191]
  ds_read_b128 v[200:203], v10 offset:256
  s_waitcnt lgkmcnt(2)
  v_mfma_f32_32x32x16_bf16 v[176:191], v[40:43], v[192:195], v[176:191]
  ds_read_b128 v[192:195], v10 offset:288
  s_waitcnt lgkmcnt(2)
  v_mfma_f32_32x32x16_bf16 v[176:191], v[44:47], v[196:199], v[176:191]
  ds_read_b128 v[196:199], v10 offset:320
  s_waitcnt lgkmcnt(2)
  v_mfma_f32_32x32x16_bf16 v[176:191], v[48:51], v[200:203], v[176:191]
  ds_read_b128 v[200:203], v10 offset:352
  s_waitcnt lgkmcnt(2)
  v_mfma_f32_32x32x16_bf16 v[176:191], v[52:55], v[192:195], v[176:191]
  ds_read_b128 v[192:195], v10 offset:384
  s_waitcnt lgkmcnt(2)
  v_mfma_f32_32x32x16_bf16 v[176:191], v[56:59], v[196:199], v[176:191]
  ds_read_b128 v[196:199], v10 offset:416
  s_waitcnt lgkmcnt(2)
  v_mfma_f32_32x32x16_bf16 v[176:191], v[60:63], v[200:203], v[176:191]
  ds_read_b128 v[200:203], v10 offset:448
  s_waitcnt lgkmcnt(2)
  v_mfma_f32_32x32x16_bf16 v[176:191], v[64:67], v[192:195], v[176:191]
  ds_read_b128 v[192:195], v10 offset:480
  s_waitcnt lgkmcnt(2)
  v_mfma_f32_32x32x16_bf16 v[176:191], v[68:71], v[196:199], v[176:191]
  ds_read_b128 v[196:199], v10 offset:512
  s_waitcnt lgkmcnt(2)
  v_mfma_f32_32x32x16_bf16 v[176:191], v[72:75], v[200:203], v[176:191]
  ds_read_b128 v[200:203], v10 offset:544
  s_waitcnt lgkmcnt(2)
  v_mfma_f32_32x32x16_bf16 v[176:191], v[76:79], v[192:195], v[176:191]
  ds_read_b128 v[192:195], v10 offset:576
  s_waitcnt lgkmcnt(2)
  v_mfma_f32_32x32x16_bf16 v[176:191], v[80:83], v[196:199], v[176:191]
  ds_read_b128 v[196:199], v10 offset:608
  s_waitcnt lgkmcnt(2)
  v_mfma_f32_32x32x16_bf16 v[176:191], v[84:87], v[200:203], v[176:191]
  ds_read_b128 v[200:203], v10 offset:640
  s_waitcnt lgkmcnt(2)
  v_mfma_f32_32x32x16_bf16 v[176:191], v[88:91], v[192:195], v[176:191]
  ds_read_b128 v[192:195], v10 offset:672
  s_waitcnt lgkmcnt(2)
  v_mfma_f32_32x32x16_bf16 v[176:191], v[92:95], v[196:199], v[176:191]
  ds_read_b128 v[196:199], v10 offset:704
  s_waitcnt lgkmcnt(2)
  v_mfma_f32_32x32x16_bf16 v[176:191], v[96:99], v[200:203], v[176:191]
  ds_read_b128 v[200:203], v10 offset:736
  s_waitcnt lgkmcnt(2)
  v_mfma_f32_32x32x16_bf16 v[176:191], v[100:103], v[192:195], v[176:191]
  ds_read_b128 v[192:195], v10 offset:768
  s_waitcnt lgkmcnt(2)
  v_mfma_f32_32x32x16_bf16 v[176:191], v[104:107], v[196:199], v[176:191]
  ds_read_b128 v[196:199], v10 offset:800
  s_waitcnt lgkmcnt(2)
  v_mfma_f32_32x32x16_bf16 v[176:191], v[108:111], v[200:203], v[176:191]
  ds_read_b128 v[200:203], v10 offset:832
  s_waitcnt lgkmcnt(2)
  v_mfma_f32_32x32x16_bf16 v[176:191], v[112:115], v[192:195], v[176:191]
  ds_read_b128 v[192:195], v10 offset:864
  s_waitcnt lgkmcnt(2)
  v_mfma_f32_32x32x16_bf16 v[176:191], v[116:119], v[196:199], v[176:191]
  ds_read_b128 v[196:199], v10 offset:896
  s_waitcnt lgkmcnt(2)
  v_mfma_f32_32x32x16_bf16 v[176:191], v[120:123], v[200:203], v[176:191]
  ds_read_b128 v[200:203], v10 offset:928
  s_waitcnt lgkmcnt(2)
  v_mfma_f32_32x32x16_bf16 v[176:191], v[124:127], v[192:195], v[176:191]
  ds_read_b128 v[192:195], v10 offset:960
  s_waitcnt lgkmcnt(2)
  v_mfma_f32_32x32x16_bf16 v[176:191], v[128:131], v[196:199], v[176:191]
  ds_read_b128 v[196:199], v10 offset:992
  s_waitcnt lgkmcnt(2)
  v_mfma_f32_32x32x16_bf16 v[176:191], v[132:135], v[200:203], v[176:191]
  ds_read_b128 v[200:203], v10 offset:1024
  s_waitcnt lgkmcnt(2)
  v_mfma_f32_32x32x16_bf16 v[176:191], v[136:139], v[192:195], v[176:191]
  ds_read_b128 v[192:195], v10 offset:1056
  s_waitcnt lgkmcnt(2)
  v_mfma_f32_32x32x16_bf16 v[176:191], v[140:143], v[196:199], v[176:191]
  ds_read_b128 v[196:199], v10 offset:1088
  s_waitcnt lgkmcnt(2)
  v_mfma_f32_32x32x16_bf16 v[176:191], v[144:147], v[200:203], v[176:191]
  ds_read_b128 v[200:203], v10 offset:1120
  s_waitcnt lgkmcnt(2)
  v_mfma_f32_32x32x16_bf16 v[176:191], v[148:151], v[192:195], v[176:191]
  ds_read_b128 v[192:195], v10 offset:1152
  s_waitcnt lgkmcnt(2)
  v_mfma_f32_32x32x16_bf16 v[176:191], v[152:155], v[196:199], v[176:191]
  ds_read_b128 v[196:199], v10 offset:1184
  s_waitcnt lgkmcnt(2)
  v_mfma_f32_32x32x16_bf16 v[176:191], v[156:159], v[200:203], v[176:191]
  ds_read_b128 v[200:203], v10 offset:1216
  s_waitcnt lgkmcnt(2)
  v_mfma_f32_32x32x16_bf16 v[176:191], v[160:163], v[192:195], v[176:191]
  ds_read_b128 v[192:195], v10 offset:1248
  s_waitcnt lgkmcnt(2)
  v_mfma_f32_32x32x16_bf16 v[176:191], v[164:167], v[196:199], v[176:191]
  s_waitcnt lgkmcnt(1)
  v_mfma_f32_32x32x16_bf16 v[176:191], v[168:171], v[200:203], v[176:191]
  s_waitcnt lgkmcnt(0)
  v_mfma_f32_32x32x16_bf16 v[176:191], v[172:175], v[192:195], v[176:191]
s_nop 11
  v_mul_f32 v176, s48, v176
  v_mul_f32 v177, s48, v177
  v_mul_f32 v178, s48, v178
  v_mul_f32 v179, s48, v179
  v_mul_f32 v180, s48, v180
  v_mul_f32 v181, s48, v181
  v_mul_f32 v182, s48, v182
  v_mul_f32 v183, s48, v183
  v_mul_f32 v184, s48, v184
  v_mul_f32 v185, s48, v185
  v_mul_f32 v186, s48, v186
  v_mul_f32 v187, s48, v187
  v_cvt_pk_bf16_f32 v224, v176, v177
  v_cvt_pk_bf16_f32 v225, v178, v179
  v_cvt_pk_bf16_f32 v226, v180, v181
  v_cvt_pk_bf16_f32 v227, v182, v183
  v_cvt_pk_bf16_f32 v228, v184, v185
  v_cvt_pk_bf16_f32 v229, v186, v187
  v_mov_b32 v12, s49
  v_cndmask_b32 v228, v228, v12, s[50:51]
  v_cndmask_b32 v229, v229, 0, s[50:51]
  v_mov_b32 v230, 0
  v_mov_b32 v231, 0
  s_add_u32 s34, s40, s47
  s_lshl_b32 s34, s34, 11
  s_add_u32 s34, s34, s44
  buffer_store_dwordx4 v[224:227], v8, s[8:11], s34 offen sc1
  buffer_store_dwordx4 v[228:231], v8, s[8:11], s34 offen offset:1024 sc1
  s_branch L_b1_skip
L_b1_v1:
  ds_read_b128 v[192:195], v10 offset:0
  ds_read_b128 v[196:199], v10 offset:32
  ds_read_b128 v[200:203], v10 offset:64
  s_waitcnt lgkmcnt(2)
  v_mfma_f32_32x32x16_bf16 v[176:191], v[192:195], v[16:19], 0
  ds_read_b128 v[192:195], v10 offset:96
  s_waitcnt lgkmcnt(2)
  v_mfma_f32_32x32x16_bf16 v[176:191], v[196:199], v[20:23], v[176:191]
  ds_read_b128 v[196:199], v10 offset:128
  s_waitcnt lgkmcnt(2)
  v_mfma_f32_32x32x16_bf16 v[176:191], v[200:203], v[24:27], v[176:191]
  ds_read_b128 v[200:203], v10 offset:160
  s_waitcnt lgkmcnt(2)
  v_mfma_f32_32x32x16_bf16 v[176:191], v[192:195], v[28:31], v[176:191]
  ds_read_b128 v[192:195], v10 offset:192
  s_waitcnt lgkmcnt(2)
  v_mfma_f32_32x32x16_bf16 v[176:191], v[196:199], v[32:35], v[176:191]
  ds_read_b128 v[196:199], v10 offset:224
  s_waitcnt lgkmcnt(2)
  v_mfma_f32_32x32x16_bf16 v[176:191], v[200:203], v[36:39], v[176:191]
  ds_read_b128 v[200:203], v10 offset:256
  s_waitcnt lgkmcnt(2)
  v_mfma_f32_32x32x16_bf16 v[176:191], v[192:195], v[40:43], v[176:191]
  ds_read_b128 v[192:195], v10 offset:288
  s_waitcnt lgkmcnt(2)
  v_mfma_f32_32x32x16_bf16 v[176:191], v[196:199], v[44:47], v[176:191]
  ds_read_b128 v[196:199], v10 offset:320
  s_waitcnt lgkmcnt(2)
  v_mfma_f32_32x32x16_bf16 v[176:191], v[200:203], v[48:51], v[176:191]
  ds_read_b128 v[200:203], v10 offset:352
  s_waitcnt lgkmcnt(2)
  v_mfma_f32_32x32x16_bf16 v[176:191], v[192:195], v[52:55], v[176:191]
  ds_read_b128 v[192:195], v10 offset:384
  s_waitcnt lgkmcnt(2)
  v_mfma_f32_32x32x16_bf16 v[176:191], v[196:199], v[56:59], v[176:191]
  ds_read_b128 v[196:199], v10 offset:416
  s_waitcnt lgkmcnt(2)
  v_mfma_f32_32x32x16_bf16 v[176:191], v[200:203], v[60:63], v[176:191]
  ds_read_b128 v[200:203], v10 offset:448
  s_waitcnt lgkmcnt(2)
  v_mfma_f32_32x32x16_bf16 v[176:191], v[192:195], v[64:67], v[176:191]
  ds_read_b128 v[192:195], v10 offset:480
  s_waitcnt lgkmcnt(2)
  v_mfma_f32_32x32x16_bf16 v[176:191], v[196:199], v[68:71], v[176:191]
  ds_read_b128 v[196:199], v10 offset:512
  s_waitcnt lgkmcnt(2)
  v_mfma_f32_32x32x16_bf16 v[176:191], v[200:203], v[72:75], v[176:191]
  ds_read_b128 v[200:203], v10 offset:544
  s_waitcnt lgkmcnt(2)
  v_mfma_f32_32x32x16_bf16 v[176:191], v[192:195], v[76:79], v[176:191]
  ds_read_b128 v[192:195], v10 offset:576
  s_waitcnt lgkmcnt(2)
  v_mfma_f32_32x32x16_bf16 v[176:191], v[196:199], v[80:83], v[176:191]
  ds_read_b128 v[196:199], v10 offset:608
  s_waitcnt lgkmcnt(2)
  v_mfma_f32_32x32x16_bf16 v[176:191], v[200:203], v[84:87], v[176:191]
  ds_read_b128 v[200:203], v10 offset:640
  s_waitcnt lgkmcnt(2)
  v_mfma_f32_32x32x16_bf16 v[176:191], v[192:195], v[88:91], v[176:191]
  ds_read_b128 v[192:195], v10 offset:672
  s_waitcnt lgkmcnt(2)
  v_mfma_f32_32x32x16_bf16 v[176:191], v[196:199], v[92:95], v[176:191]
  ds_read_b128 v[196:199], v10 offset:704
  s_waitcnt lgkmcnt(2)
  v_mfma_f32_32x32x16_bf16 v[176:191], v[200:203], v[96:99], v[176:191]
  ds_read_b128 v[200:203], v10 offset:736
  s_waitcnt lgkmcnt(2)
  v_mfma_f32_32x32x16_bf16 v[176:191], v[192:195], v[100:103], v[176:191]
  ds_read_b128 v[192:195], v10 offset:768
  s_waitcnt lgkmcnt(2)
  v_mfma_f32_32x32x16_bf16 v[176:191], v[196:199], v[104:107], v[176:191]
  ds_read_b128 v[196:199], v10 offset:800
  s_waitcnt lgkmcnt(2)
  v_mfma_f32_32x32x16_bf16 v[176:191], v[200:203], v[108:111], v[176:191]
  ds_read_b128 v[200:203], v10 offset:832
  s_waitcnt lgkmcnt(2)
  v_mfma_f32_32x32x16_bf16 v[176:191], v[192:195], v[112:115], v[176:191]
  ds_read_b128 v[192:195], v10 offset:864
  s_waitcnt lgkmcnt(2)
  v_mfma_f32_32x32x16_bf16 v[176:191], v[196:199], v[116:119], v[176:191]
  ds_read_b128 v[196:199], v10 offset:896
  s_waitcnt lgkmcnt(2)
  v_mfma_f32_32x32x16_bf16 v[176:191], v[200:203], v[120:123], v[176:191]
  ds_read_b128 v[200:203], v10 offset:928
  s_waitcnt lgkmcnt(2)
  v_mfma_f32_32x32x16_bf16 v[176:191], v[192:195], v[124:127], v[176:191]
  ds_read_b128 v[192:195], v10 offset:960
  s_waitcnt lgkmcnt(2)
  v_mfma_f32_32x32x16_bf16 v[176:191], v[196:199], v[128:131], v[176:191]
  ds_read_b128 v[196:199], v10 offset:992
  s_waitcnt lgkmcnt(2)
  v_mfma_f32_32x32x16_bf16 v[176:191], v[200:203], v[132:135], v[176:191]
  ds_read_b128 v[200:203], v10 offset:1024
  s_waitcnt lgkmcnt(2)
  v_mfma_f32_32x32x16_bf16 v[176:191], v[192:195], v[136:139], v[176:191]
  ds_read_b128 v[192:195], v10 offset:1056
  s_waitcnt lgkmcnt(2)
  v_mfma_f32_32x32x16_bf16 v[176:191], v[196:199], v[140:143], v[176:191]
  ds_read_b128 v[196:199], v10 offset:1088
  s_waitcnt lgkmcnt(2)
  v_mfma_f32_32x32x16_bf16 v[176:191], v[200:203], v[144:147], v[176:191]
  ds_read_b128 v[200:203], v10 offset:1120
  s_waitcnt lgkmcnt(2)
  v_mfma_f32_32x32x16_bf16 v[176:191], v[192:195], v[148:151], v[176:191]
  ds_read_b128 v[192:195], v10 offset:1152
  s_waitcnt lgkmcnt(2)
  v_mfma_f32_32x32x16_bf16 v[176:191], v[196:199], v[152:155], v[176:191]
  ds_read_b128 v[196:199], v10 offset:1184
  s_waitcnt lgkmcnt(2)
  v_mfma_f32_32x32x16_bf16 v[176:191], v[200:203], v[156:159], v[176:191]
  ds_read_b128 v[200:203], v10 offset:1216
  s_waitcnt lgkmcnt(2)
  v_mfma_f32_32x32x16_bf16 v[176:191], v[192:195], v[160:163], v[176:191]
  ds_read_b128 v[192:195], v10 offset:1248
  s_waitcnt lgkmcnt(2)
  v_mfma_f32_32x32x16_bf16 v[176:191], v[196:199], v[164:167], v[176:191]
  s_waitcnt lgkmcnt(1)
  v_mfma_f32_32x32x16_bf16 v[176:191], v[200:203], v[168:171], v[176:191]
  s_waitcnt lgkmcnt(0)
  v_mfma_f32_32x32x16_bf16 v[176:191], v[192:195], v[172:175], v[176:191]
s_nop 11
  v_cvt_pk_bf16_f32 v224, v176, v177
  v_cvt_pk_bf16_f32 v225, v178, v179
  v_cvt_pk_bf16_f32 v226, v180, v181
  v_cvt_pk_bf16_f32 v227, v182, v183
  v_cvt_pk_bf16_f32 v228, v184, v185
  v_cvt_pk_bf16_f32 v229, v186, v187
  v_cvt_pk_bf16_f32 v230, v188, v189
  v_cvt_pk_bf16_f32 v231, v190, v191
  v_cndmask_b32 v224, v13, v224, s[52:53]
  v_cndmask_b32 v225, v13, v225, s[52:53]
  v_cndmask_b32 v226, v13, v226, s[52:53]
  v_cndmask_b32 v227, v13, v227, s[52:53]
  v_cndmask_b32 v228, v13, v228, s[52:53]
  v_cndmask_b32 v229, v13, v229, s[52:53]
  v_cndmask_b32 v230, v13, v230, s[52:53]
  v_cndmask_b32 v231, v13, v231, s[52:53]
  s_add_u32 s34, s40, s47
  s_lshl_b32 s34, s34, 11
  s_add_u32 s34, s34, s44
  buffer_store_dwordx4 v[224:227], v8, s[8:11], s34 offen sc1
  buffer_store_dwordx4 v[228:231], v8, s[8:11], s34 offen offset:1024 sc1
L_b1_skip:
  s_waitcnt vmcnt(2)
  s_branch L_b1_bar
L_b1_idle:
  s_waitcnt vmcnt(0)
L_b1_bar:
  s_barrier
  s_add_u32 s40, s40, 1
  s_cmp_lt_u32 s40, 16
  s_cbranch_scc1 L_b1_loop
  s_waitcnt vmcnt(0)
  s_barrier
  s_cmp_lg_u32 s30, 0
  s_cbranch_scc1 L_b2
  s_lshl_b32 s34, s41, 2
  s_add_u32 s34, s34, 512
  s_add_u32 s34, s34, s100
  v_mov_b32 v10, s34
  v_mov_b32 v11, 1
  s_mov_b64 exec, 1
  buffer_store_dword v11, v10, s[8:11], 0 offen sc1
  s_mov_b64 exec, -1
  s_branch L_b2
L_b2v:
  s_cmp_lg_u32 s31, 0
  s_cbranch_scc1 valok_209
  v_lshlrev_b32 v10, 2, v1
  s_mov_b32 s39, 0
val_207:
  buffer_load_dword v11, v10, s[12:15], 0 offen sc1
  s_waitcnt vmcnt(0)
  v_cmp_eq_u32 vcc, 32, v11
s_nop 3
  s_and_b32 s34, vcc_lo, vcc_hi
  s_and_b32 s34, s34, 0x5555
  s_cmp_eq_u32 s34, 0x5555
  s_cbranch_scc0 valg_208_s
  v_readlane_b32 s32, v11, 1
  s_mov_b32 s34, 0
  s_cmp_eq_u32 s34, 0
  s_cbranch_scc1 valg_208
valg_208_s:
  s_mov_b32 s36, 0
  s_mov_b32 s37, 0
  s_mov_b32 s38, 0
  s_mov_b32 s34, 0
  v_readlane_b32 s35, v11, 2
s_nop 3
  s_add_u32 s38, s38, s35
  v_readlane_b32 s35, v11, 0
s_nop 3
  s_add_u32 s36, s36, s35
  s_cmp_eq_u32 s35, 32
  s_cselect_b32 s97, 0, 1
  s_or_b32 s34, s34, s97
  s_cmp_gt_u32 s98, 0
  s_cselect_b32 s35, s35, 0
  s_add_u32 s37, s37, s35
  v_readlane_b32 s35, v11, 6
s_nop 3
  s_add_u32 s38, s38, s35
  v_readlane_b32 s35, v11, 4
s_nop 3
  s_add_u32 s36, s36, s35
  s_cmp_eq_u32 s35, 32
  s_cselect_b32 s97, 0, 1
  s_or_b32 s34, s34, s97
  s_cmp_gt_u32 s98, 1
  s_cselect_b32 s35, s35, 0
  s_add_u32 s37, s37, s35
  v_readlane_b32 s35, v11, 10
s_nop 3
  s_add_u32 s38, s38, s35
  v_readlane_b32 s35, v11, 8
s_nop 3
  s_add_u32 s36, s36, s35
  s_cmp_eq_u32 s35, 32
  s_cselect_b32 s97, 0, 1
  s_or_b32 s34, s34, s97
  s_cmp_gt_u32 s98, 2
  s_cselect_b32 s35, s35, 0
  s_add_u32 s37, s37, s35
  v_readlane_b32 s35, v11, 14
s_nop 3
  s_add_u32 s38, s38, s35
  v_readlane_b32 s35, v11, 12
s_nop 3
  s_add_u32 s36, s36, s35
  s_cmp_eq_u32 s35, 32
  s_cselect_b32 s97, 0, 1
  s_or_b32 s34, s34, s97
  s_cmp_gt_u32 s98, 3
  s_cselect_b32 s35, s35, 0
  s_add_u32 s37, s37, s35
  v_readlane_b32 s35, v11, 34
s_nop 3
  s_add_u32 s38, s38, s35
  v_readlane_b32 s35, v11, 32
s_nop 3
  s_add_u32 s36, s36, s35
  s_cmp_eq_u32 s35, 32
  s_cselect_b32 s97, 0, 1
  s_or_b32 s34, s34, s97
  s_cmp_gt_u32 s98, 4
  s_cselect_b32 s35, s35, 0
  s_add_u32 s37, s37, s35
  v_readlane_b32 s35, v11, 38
s_nop 3
  s_add_u32 s38, s38, s35
  v_readlane_b32 s35, v11, 36
s_nop 3
  s_add_u32 s36, s36, s35
  s_cmp_eq_u32 s35, 32
  s_cselect_b32 s97, 0, 1
  s_or_b32 s34, s34, s97
  s_cmp_gt_u32 s98, 5
  s_cselect_b32 s35, s35, 0
  s_add_u32 s37, s37, s35
  v_readlane_b32 s35, v11, 42
s_nop 3
  s_add_u32 s38, s38, s35
  v_readlane_b32 s35, v11, 40
s_nop 3
  s_add_u32 s36, s36, s35
  s_cmp_eq_u32 s35, 32
  s_cselect_b32 s97, 0, 1
  s_or_b32 s34, s34, s97
  s_cmp_gt_u32 s98, 6
  s_cselect_b32 s35, s35, 0
  s_add_u32 s37, s37, s35
  v_readlane_b32 s35, v11, 46
s_nop 3
  s_add_u32 s38, s38, s35
  v_readlane_b32 s35, v11, 44
s_nop 3
  s_add_u32 s36, s36, s35
  s_cmp_eq_u32 s35, 32
  s_cselect_b32 s97, 0, 1
  s_or_b32 s34, s34, s97
  s_cmp_gt_u32 s98, 7
  s_cselect_b32 s35, s35, 0
  s_add_u32 s37, s37, s35
  v_readlane_b32 s35, v11, 18
s_nop 3
  s_add_u32 s38, s38, s35
  v_readlane_b32 s35, v11, 16
s_nop 3
  s_add_u32 s36, s36, s35
  s_cmp_eq_u32 s35, 0
  s_cselect_b32 s97, 0, 1
  s_or_b32 s34, s34, s97
  s_cmp_gt_u32 s98, 8
  s_cselect_b32 s35, s35, 0
  s_add_u32 s37, s37, s35
  v_readlane_b32 s35, v11, 22
s_nop 3
  s_add_u32 s38, s38, s35
  v_readlane_b32 s35, v11, 20
s_nop 3
  s_add_u32 s36, s36, s35
  s_cmp_eq_u32 s35, 0
  s_cselect_b32 s97, 0, 1
  s_or_b32 s34, s34, s97
  s_cmp_gt_u32 s98, 9
  s_cselect_b32 s35, s35, 0
  s_add_u32 s37, s37, s35
  v_readlane_b32 s35, v11, 26
s_nop 3
  s_add_u32 s38, s38, s35
  v_readlane_b32 s35, v11, 24
s_nop 3
  s_add_u32 s36, s36, s35
  s_cmp_eq_u32 s35, 0
  s_cselect_b32 s97, 0, 1
  s_or_b32 s34, s34, s97
  s_cmp_gt_u32 s98, 10
  s_cselect_b32 s35, s35, 0
  s_add_u32 s37, s37, s35
  v_readlane_b32 s35, v11, 30
s_nop 3
  s_add_u32 s38, s38, s35
  v_readlane_b32 s35, v11, 28
s_nop 3
  s_add_u32 s36, s36, s35
  s_cmp_eq_u32 s35, 0
  s_cselect_b32 s97, 0, 1
  s_or_b32 s34, s34, s97
  s_cmp_gt_u32 s98, 11
  s_cselect_b32 s35, s35, 0
  s_add_u32 s37, s37, s35
  v_readlane_b32 s35, v11, 50
s_nop 3
  s_add_u32 s38, s38, s35
  v_readlane_b32 s35, v11, 48
s_nop 3
  s_add_u32 s36, s36, s35
  s_cmp_eq_u32 s35, 0
  s_cselect_b32 s97, 0, 1
  s_or_b32 s34, s34, s97
  s_cmp_gt_u32 s98, 12
  s_cselect_b32 s35, s35, 0
  s_add_u32 s37, s37, s35
  v_readlane_b32 s35, v11, 54
s_nop 3
  s_add_u32 s38, s38, s35
  v_readlane_b32 s35, v11, 52
s_nop 3
  s_add_u32 s36, s36, s35
  s_cmp_eq_u32 s35, 0
  s_cselect_b32 s97, 0, 1
  s_or_b32 s34, s34, s97
  s_cmp_gt_u32 s98, 13
  s_cselect_b32 s35, s35, 0
  s_add_u32 s37, s37, s35
  v_readlane_b32 s35, v11, 58
s_nop 3
  s_add_u32 s38, s38, s35
  v_readlane_b32 s35, v11, 56
s_nop 3
  s_add_u32 s36, s36, s35
  s_cmp_eq_u32 s35, 0
  s_cselect_b32 s97, 0, 1
  s_or_b32 s34, s34, s97
  s_cmp_gt_u32 s98, 14
  s_cselect_b32 s35, s35, 0
  s_add_u32 s37, s37, s35
  v_readlane_b32 s35, v11, 62
s_nop 3
  s_add_u32 s38, s38, s35
  v_readlane_b32 s35, v11, 60
s_nop 3
  s_add_u32 s36, s36, s35
  s_cmp_eq_u32 s35, 0
  s_cselect_b32 s97, 0, 1
  s_or_b32 s34, s34, s97
  s_cmp_gt_u32 s98, 15
  s_cselect_b32 s35, s35, 0
  s_add_u32 s37, s37, s35
  v_readlane_b32 s32, v11, 1
  s_cmp_eq_u32 s36, 256
  s_cselect_b32 s35, s38, 0
  s_cmp_eq_u32 s35, 256
  s_cbranch_scc1 valg_208
  s_sleep 2
  s_add_u32 s39, s39, 1
  s_cmp_lt_u32 s39, s33
  s_cbranch_scc1 val_207
  s_mov_b32 s33, 0
valg_208:
s_nop 0
  s_and_b32 s32, s32, 2
  s_lshl_b32 s32, s32, 12
  s_cmp_eq_u32 s34, 0
  s_cbranch_scc1 valok_209
  s_mov_b32 s31, 1
  s_mov_b32 s32, 0
  s_add_u32 s37, s37, s99
  s_and_b32 s37, s37, 255
  s_lshr_b32 s28, s37, 5
  s_and_b32 s29, s37, 31
  s_barrier
  s_branch L_dispatch
valok_209:
  s_cmp_lg_u32 s31, 0
  s_cbranch_scc1 pwd_211
  s_mov_b32 s39, 0
  v_mov_b32 v13, 4
pw_210:
  buffer_load_dword v12, v13, s[12:15], 0 offen sc1
  s_waitcnt vmcnt(0)
  v_readfirstlane_b32 s32, v12
s_nop 3
  s_cmp_lg_u32 s32, 0
  s_cbranch_scc1 pw_210_g
  s_sleep 2
  s_add_u32 s39, s39, 1
  s_cmp_lt_u32 s39, s33
  s_cbranch_scc1 pw_210
  s_mov_b32 s33, 0
pw_210_g:
  s_and_b32 s32, s32, 2
  s_lshl_b32 s32, s32, 12
pwd_211:
  s_xor_b32 s100, s32, 8192
  s_add_u32 s101, s100, 3817472
  s_add_u32 s100, s100, 3801088
L_b2:
  v_lshlrev_b32 v10, 2, v1
  v_add_u32 v10, 512, v10
  v_add_u32 v10, s100, v10
  s_mov_b32 s36, 1
  s_cmp_lg_u32 s30, 0
  s_cbranch_scc1 L_b1w_go
  s_mov_b32 s39, 0
  s_mov_b64 s[70:71], exec
  s_mov_b32 exec_lo, 0xffffffff
  s_mov_b32 exec_hi, 0xffff
b1w_212:
  buffer_load_dword v13, v10, s[8:11], 0 offen sc1
  s_waitcnt vmcnt(0)
  v_cmp_gt_u32 vcc, s36, v13
  s_cbranch_vccz b1wd_213
  s_sleep 16
  s_add_u32 s39, s39, 1
  s_cmp_lt_u32 s39, s33
  s_cbranch_scc1 b1w_212
  s_mov_b32 s33, 0
b1wd_213:
  s_mov_b64 exec, s[70:71]
L_b1w_go:
  s_barrier
  s_lshr_b32 s43, s41, 1
  s_and_b32 s44, s41, 1
  s_lshl_b32 s34, s43, 17
  v_lshlrev_b32 v2, 4, v1
  v_add_u32 v3, s34, v2
  s_lshl_b32 s35, s44, 5
  s_lshl_b32 s36, s30, 2
  s_add_u32 s35, s35, s36
  s_lshl_b32 s36, s35, 11
  s_add_u32 s36, s36, 113246208
  buffer_load_dwordx4 v[16:19], v3, s[8:11], s36 offen offset:0 sc1
  buffer_load_dwordx4 v[20:23], v3, s[8:11], s36 offen offset:1024 sc1
  s_add_u32 s36, s36, 2048
  buffer_load_dwordx4 v[24:27], v3, s[8:11], s36 offen offset:0 sc1
  buffer_load_dwordx4 v[28:31], v3, s[8:11], s36 offen offset:1024 sc1
  s_add_u32 s36, s36, 2048
  buffer_load_dwordx4 v[32:35], v3, s[8:11], s36 offen offset:0 sc1
  buffer_load_dwordx4 v[36:39], v3, s[8:11], s36 offen offset:1024 sc1
  s_add_u32 s36, s36, 2048
  buffer_load_dwordx4 v[40:43], v3, s[8:11], s36 offen offset:0 sc1
  buffer_load_dwordx4 v[44:47], v3, s[8:11], s36 offen offset:1024 sc1
  s_mov_b32 s45, s35
  s_lshl_b32 s46, s30, 11
  v_add_u32 v4, s46, v3
  s_mov_b32 s40, 0
  s_and_b32 s34, s40, 1
  s_lshl_b32 s34, s34, 15
  s_add_u32 s34, s34, s46
  s_mov_b32 m0, s34
  s_lshl_b32 s35, s40, 14
  s_add_u32 s36, s35, 100663296
  buffer_load_dwordx4 v4, s[8:11], s36 offen sc1 lds
  buffer_load_dwordx4 v4, s[8:11], s36 offen offset:1024 sc1 lds
  s_add_u32 m0, s34, 16384
  s_add_u32 s36, s35, 104857600
  buffer_load_dwordx4 v4, s[8:11], s36 offen sc1 lds
  buffer_load_dwordx4 v4, s[8:11], s36 offen offset:1024 sc1 lds
  v_mov_b32 v48, 0
  v_mov_b32 v49, 0
  v_mov_b32 v50, 0
  v_mov_b32 v51, 0
  v_mov_b32 v52, 0
  v_mov_b32 v53, 0
  v_mov_b32 v54, 0
  v_mov_b32 v55, 0
  v_mov_b32 v56, 0
  v_mov_b32 v57, 0
  v_mov_b32 v58, 0
  v_mov_b32 v59, 0
  v_mov_b32 v60, 0
  v_mov_b32 v61, 0
  v_mov_b32 v62, 0
  v_mov_b32 v63, 0
  v_mov_b32 v64, 0
  v_mov_b32 v65, 0
  v_mov_b32 v66, 0
  v_mov_b32 v67, 0
  v_mov_b32 v68, 0
  v_mov_b32 v69, 0
  v_mov_b32 v70, 0
  v_mov_b32 v71, 0
  v_mov_b32 v72, 0
  v_mov_b32 v73, 0
  v_mov_b32 v74, 0
  v_mov_b32 v75, 0
  v_mov_b32 v76, 0
  v_mov_b32 v77, 0
  v_mov_b32 v78, 0
  v_mov_b32 v79, 0
  v_mov_b32 v80, 0
  v_mov_b32 v81, 0
  v_mov_b32 v82, 0
  v_mov_b32 v83, 0
  v_mov_b32 v84, 0
  v_mov_b32 v85, 0
  v_mov_b32 v86, 0
  v_mov_b32 v87, 0
  v_mov_b32 v88, 0
  v_mov_b32 v89, 0
  v_mov_b32 v90, 0
  v_mov_b32 v91, 0
  v_mov_b32 v92, 0
  v_mov_b32 v93, 0
  v_mov_b32 v94, 0
  v_mov_b32 v95, 0
  v_mov_b32 v96, 0
  v_mov_b32 v97, 0
  v_mov_b32 v98, 0
  v_mov_b32 v99, 0
  v_mov_b32 v100, 0
  v_mov_b32 v101, 0
  v_mov_b32 v102, 0
  v_mov_b32 v103, 0
  v_mov_b32 v104, 0
  v_mov_b32 v105, 0
  v_mov_b32 v106, 0
  v_mov_b32 v107, 0
  v_mov_b32 v108, 0
  v_mov_b32 v109, 0
  v_mov_b32 v110, 0
  v_mov_b32 v111, 0
  v_mov_b32 v184, 0
  v_mov_b32 v185, 0
  v_mov_b32 v186, 0
  v_mov_b32 v187, 0
  s_mov_b32 s50, 0
  s_mov_b32 s51, -1
  s_mov_b32 s52, 0xff800000
  s_mov_b32 s53, 0xff800000
L_b2_chunk:
  s_waitcnt vmcnt(0)
  s_barrier
  s_cmp_ge_u32 s40, 7
  s_cbranch_scc1 L_b2_nodma
  s_add_u32 s37, s40, 1
  s_and_b32 s34, s37, 1
  s_lshl_b32 s34, s34, 15
  s_add_u32 s34, s34, s46
  s_mov_b32 m0, s34
  s_lshl_b32 s35, s37, 14
  s_add_u32 s36, s35, 100663296
  buffer_load_dwordx4 v4, s[8:11], s36 offen sc1 lds
  buffer_load_dwordx4 v4, s[8:11], s36 offen offset:1024 sc1 lds
  s_add_u32 m0, s34, 16384
  s_add_u32 s36, s35, 104857600
  buffer_load_dwordx4 v4, s[8:11], s36 offen sc1 lds
  buffer_load_dwordx4 v4, s[8:11], s36 offen offset:1024 sc1 lds
L_b2_nodma:
  s_and_b32 s34, s40, 1
  s_lshl_b32 s34, s34, 15
  v_add_u32 v5, s34, v2
  s_mov_b32 s47, 0
  ds_read_b128 v[112:115], v5 offset:0
  ds_read_b128 v[116:119], v5 offset:1024
  ds_read_b128 v[120:123], v5 offset:16384
  ds_read_b128 v[124:127], v5 offset:17408
  s_waitcnt lgkmcnt(0)
  v_mfma_f32_32x32x16_bf16 v[144:159], v[112:115], v[16:19], 0
  v_mfma_f32_32x32x16_bf16 v[144:159], v[116:119], v[20:23], v[144:159]
L_b2_pair:
  ds_read_b128 v[128:131], v5 offset:2048
  ds_read_b128 v[132:135], v5 offset:3072
  ds_read_b128 v[136:139], v5 offset:18432
  ds_read_b128 v[140:143], v5 offset:19456
  v_mfma_f32_32x32x16_bf16 v[160:175], v[112:115], v[24:27], 0
  v_mfma_f32_32x32x16_bf16 v[160:175], v[116:119], v[28:31], v[160:175]
s_nop 5
  v_max3_f32 v188, v144, v145, v146
  v_max3_f32 v188, v188, v147, v148
  v_max3_f32 v188, v188, v149, v150
  v_max3_f32 v188, v188, v151, v152
  v_max3_f32 v188, v188, v153, v154
  v_max3_f32 v188, v188, v155, v156
  v_max3_f32 v188, v188, v157, v158
  v_max_f32 v188, v188, v159
  v_cmp_lt_f32 vcc, s52, v188
  s_cbranch_vccnz b2r_214
b2b_215:
  v_exp_f32 v144, v144
  v_exp_f32 v145, v145
  v_exp_f32 v146, v146
  v_exp_f32 v147, v147
  v_exp_f32 v148, v148
  v_exp_f32 v149, v149
  v_exp_f32 v150, v150
  v_exp_f32 v151, v151
  v_exp_f32 v152, v152
  v_exp_f32 v153, v153
  v_exp_f32 v154, v154
  v_exp_f32 v155, v155
  v_exp_f32 v156, v156
  v_exp_f32 v157, v157
  v_exp_f32 v158, v158
  v_exp_f32 v159, v159
  v_cvt_pk_bf16_f32 v176, v144, v145
  v_cvt_pk_bf16_f32 v177, v146, v147
  v_cvt_pk_bf16_f32 v178, v148, v149
  v_cvt_pk_bf16_f32 v179, v150, v151
  v_cvt_pk_bf16_f32 v180, v152, v153
  v_cvt_pk_bf16_f32 v181, v154, v155
  v_cvt_pk_bf16_f32 v182, v156, v157
  v_cvt_pk_bf16_f32 v183, v158, v159
  v_mfma_f32_32x32x16_bf16 v[48:63], v[120:123], v[176:179], v[48:63]
s_nop 0
  v_mfma_f32_32x32x16_bf16 v[48:63], v[124:127], v[180:183], v[48:63]
  v_mfma_f32_32x32x16_bf16 v[144:159], v[112:115], v[32:35], 0
  v_mfma_f32_32x32x16_bf16 v[144:159], v[116:119], v[36:39], v[144:159]
  v_max3_f32 v188, v160, v161, v162
  v_max3_f32 v188, v188, v163, v164
  v_max3_f32 v188, v188, v165, v166
  v_max3_f32 v188, v188, v167, v168
  v_max3_f32 v188, v188, v169, v170
  v_max3_f32 v188, v188, v171, v172
  v_max3_f32 v188, v188, v173, v174
  v_max_f32 v188, v188, v175
  v_cmp_lt_f32 vcc, s52, v188
  s_cbranch_vccnz b2r_216
b2b_217:
  v_exp_f32 v160, v160
  v_exp_f32 v161, v161
  v_exp_f32 v162, v162
  v_exp_f32 v163, v163
  v_exp_f32 v164, v164
  v_exp_f32 v165, v165
  v_exp_f32 v166, v166
  v_exp_f32 v167, v167
  v_exp_f32 v168, v168
  v_exp_f32 v169, v169
  v_exp_f32 v170, v170
  v_exp_f32 v171, v171
  v_exp_f32 v172, v172
  v_exp_f32 v173, v173
  v_exp_f32 v174, v174
  v_exp_f32 v175, v175
  v_cvt_pk_bf16_f32 v176, v160, v161
  v_cvt_pk_bf16_f32 v177, v162, v163
  v_cvt_pk_bf16_f32 v178, v164, v165
  v_cvt_pk_bf16_f32 v179, v166, v167
  v_cvt_pk_bf16_f32 v180, v168, v169
  v_cvt_pk_bf16_f32 v181, v170, v171
  v_cvt_pk_bf16_f32 v182, v172, v173
  v_cvt_pk_bf16_f32 v183, v174, v175
  v_mfma_f32_32x32x16_bf16 v[64:79], v[120:123], v[176:179], v[64:79]
s_nop 0
  v_mfma_f32_32x32x16_bf16 v[64:79], v[124:127], v[180:183], v[64:79]
  v_mfma_f32_32x32x16_bf16 v[160:175], v[112:115], v[40:43], 0
  v_mfma_f32_32x32x16_bf16 v[160:175], v[116:119], v[44:47], v[160:175]
  v_max3_f32 v188, v144, v145, v146
  v_max3_f32 v188, v188, v147, v148
  v_max3_f32 v188, v188, v149, v150
  v_max3_f32 v188, v188, v151, v152
  v_max3_f32 v188, v188, v153, v154
  v_max3_f32 v188, v188, v155, v156
  v_max3_f32 v188, v188, v157, v158
  v_max_f32 v188, v188, v159
  v_cmp_lt_f32 vcc, s52, v188
  s_cbranch_vccnz b2r_218
b2b_219:
  v_exp_f32 v144, v144
  v_exp_f32 v145, v145
  v_exp_f32 v146, v146
  v_exp_f32 v147, v147
  v_exp_f32 v148, v148
  v_exp_f32 v149, v149
  v_exp_f32 v150, v150
  v_exp_f32 v151, v151
  v_exp_f32 v152, v152
  v_exp_f32 v153, v153
  v_exp_f32 v154, v154
  v_exp_f32 v155, v155
  v_exp_f32 v156, v156
  v_exp_f32 v157, v157
  v_exp_f32 v158, v158
  v_exp_f32 v159, v159
  v_cvt_pk_bf16_f32 v176, v144, v145
  v_cvt_pk_bf16_f32 v177, v146, v147
  v_cvt_pk_bf16_f32 v178, v148, v149
  v_cvt_pk_bf16_f32 v179, v150, v151
  v_cvt_pk_bf16_f32 v180, v152, v153
  v_cvt_pk_bf16_f32 v181, v154, v155
  v_cvt_pk_bf16_f32 v182, v156, v157
  v_cvt_pk_bf16_f32 v183, v158, v159
  v_mfma_f32_32x32x16_bf16 v[80:95], v[120:123], v[176:179], v[80:95]
s_nop 0
  v_mfma_f32_32x32x16_bf16 v[80:95], v[124:127], v[180:183], v[80:95]
  s_waitcnt lgkmcnt(0)
  v_mfma_f32_32x32x16_bf16 v[144:159], v[128:131], v[16:19], 0
  v_mfma_f32_32x32x16_bf16 v[144:159], v[132:135], v[20:23], v[144:159]
  v_max3_f32 v188, v160, v161, v162
  v_max3_f32 v188, v188, v163, v164
  v_max3_f32 v188, v188, v165, v166
  v_max3_f32 v188, v188, v167, v168
  v_max3_f32 v188, v188, v169, v170
  v_max3_f32 v188, v188, v171, v172
  v_max3_f32 v188, v188, v173, v174
  v_max_f32 v188, v188, v175
  v_cmp_lt_f32 vcc, s52, v188
  s_cbranch_vccnz b2r_220
b2b_221:
  v_exp_f32 v160, v160
  v_exp_f32 v161, v161
  v_exp_f32 v162, v162
  v_exp_f32 v163, v163
  v_exp_f32 v164, v164
  v_exp_f32 v165, v165
  v_exp_f32 v166, v166
  v_exp_f32 v167, v167
  v_exp_f32 v168, v168
  v_exp_f32 v169, v169
  v_exp_f32 v170, v170
  v_exp_f32 v171, v171
  v_exp_f32 v172, v172
  v_exp_f32 v173, v173
  v_exp_f32 v174, v174
  v_exp_f32 v175, v175
  v_cvt_pk_bf16_f32 v176, v160, v161
  v_cvt_pk_bf16_f32 v177, v162, v163
  v_cvt_pk_bf16_f32 v178, v164, v165
  v_cvt_pk_bf16_f32 v179, v166, v167
  v_cvt_pk_bf16_f32 v180, v168, v169
  v_cvt_pk_bf16_f32 v181, v170, v171
  v_cvt_pk_bf16_f32 v182, v172, v173
  v_cvt_pk_bf16_f32 v183, v174, v175
  v_mfma_f32_32x32x16_bf16 v[96:111], v[120:123], v[176:179], v[96:111]
s_nop 0
  v_mfma_f32_32x32x16_bf16 v[96:111], v[124:127], v[180:183], v[96:111]
  s_mov_b32 s52, 0x41200000
  s_mov_b32 s53, 0
  v_add_u32 v5, 4096, v5
  s_cmp_eq_u32 s47, 3
  s_cbranch_scc1 b2nr_222
  ds_read_b128 v[112:115], v5 offset:0
  ds_read_b128 v[116:119], v5 offset:1024
  ds_read_b128 v[120:123], v5 offset:16384
  ds_read_b128 v[124:127], v5 offset:17408
b2nr_222:
  v_mfma_f32_32x32x16_bf16 v[160:175], v[128:131], v[24:27], 0
  v_mfma_f32_32x32x16_bf16 v[160:175], v[132:135], v[28:31], v[160:175]
  v_max3_f32 v188, v144, v145, v146
  v_max3_f32 v188, v188, v147, v148
  v_max3_f32 v188, v188, v149, v150
  v_max3_f32 v188, v188, v151, v152
  v_max3_f32 v188, v188, v153, v154
  v_max3_f32 v188, v188, v155, v156
  v_max3_f32 v188, v188, v157, v158
  v_max_f32 v188, v188, v159
  v_cmp_lt_f32 vcc, s52, v188
  s_cbranch_vccnz b2r_223
b2b_224:
  v_exp_f32 v144, v144
  v_exp_f32 v145, v145
  v_exp_f32 v146, v146
  v_exp_f32 v147, v147
  v_exp_f32 v148, v148
  v_exp_f32 v149, v149
  v_exp_f32 v150, v150
  v_exp_f32 v151, v151
  v_exp_f32 v152, v152
  v_exp_f32 v153, v153
  v_exp_f32 v154, v154
  v_exp_f32 v155, v155
  v_exp_f32 v156, v156
  v_exp_f32 v157, v157
  v_exp_f32 v158, v158
  v_exp_f32 v159, v159
  v_cvt_pk_bf16_f32 v176, v144, v145
  v_cvt_pk_bf16_f32 v177, v146, v147
  v_cvt_pk_bf16_f32 v178, v148, v149
  v_cvt_pk_bf16_f32 v179, v150, v151
  v_cvt_pk_bf16_f32 v180, v152, v153
  v_cvt_pk_bf16_f32 v181, v154, v155
  v_cvt_pk_bf16_f32 v182, v156, v157
  v_cvt_pk_bf16_f32 v183, v158, v159
  v_mfma_f32_32x32x16_bf16 v[48:63], v[136:139], v[176:179], v[48:63]
s_nop 0
  v_mfma_f32_32x32x16_bf16 v[48:63], v[140:143], v[180:183], v[48:63]
  v_mfma_f32_32x32x16_bf16 v[144:159], v[128:131], v[32:35], 0
  v_mfma_f32_32x32x16_bf16 v[144:159], v[132:135], v[36:39], v[144:159]
  v_max3_f32 v188, v160, v161, v162
  v_max3_f32 v188, v188, v163, v164
  v_max3_f32 v188, v188, v165, v166
  v_max3_f32 v188, v188, v167, v168
  v_max3_f32 v188, v188, v169, v170
  v_max3_f32 v188, v188, v171, v172
  v_max3_f32 v188, v188, v173, v174
  v_max_f32 v188, v188, v175
  v_cmp_lt_f32 vcc, s52, v188
  s_cbranch_vccnz b2r_225
b2b_226:
  v_exp_f32 v160, v160
  v_exp_f32 v161, v161
  v_exp_f32 v162, v162
  v_exp_f32 v163, v163
  v_exp_f32 v164, v164
  v_exp_f32 v165, v165
  v_exp_f32 v166, v166
  v_exp_f32 v167, v167
  v_exp_f32 v168, v168
  v_exp_f32 v169, v169
  v_exp_f32 v170, v170
  v_exp_f32 v171, v171
  v_exp_f32 v172, v172
  v_exp_f32 v173, v173
  v_exp_f32 v174, v174
  v_exp_f32 v175, v175
  v_cvt_pk_bf16_f32 v176, v160, v161
  v_cvt_pk_bf16_f32 v177, v162, v163
  v_cvt_pk_bf16_f32 v178, v164, v165
  v_cvt_pk_bf16_f32 v179, v166, v167
  v_cvt_pk_bf16_f32 v180, v168, v169
  v_cvt_pk_bf16_f32 v181, v170, v171
  v_cvt_pk_bf16_f32 v182, v172, v173
  v_cvt_pk_bf16_f32 v183, v174, v175
  v_mfma_f32_32x32x16_bf16 v[64:79], v[136:139], v[176:179], v[64:79]
s_nop 0
  v_mfma_f32_32x32x16_bf16 v[64:79], v[140:143], v[180:183], v[64:79]
  v_mfma_f32_32x32x16_bf16 v[160:175], v[128:131], v[40:43], 0
  v_mfma_f32_32x32x16_bf16 v[160:175], v[132:135], v[44:47], v[160:175]
  v_max3_f32 v188, v144, v145, v146
  v_max3_f32 v188, v188, v147, v148
  v_max3_f32 v188, v188, v149, v150
  v_max3_f32 v188, v188, v151, v152
  v_max3_f32 v188, v188, v153, v154
  v_max3_f32 v188, v188, v155, v156
  v_max3_f32 v188, v188, v157, v158
  v_max_f32 v188, v188, v159
  v_cmp_lt_f32 vcc, s52, v188
  s_cbranch_vccnz b2r_227
b2b_228:
  v_exp_f32 v144, v144
  v_exp_f32 v145, v145
  v_exp_f32 v146, v146
  v_exp_f32 v147, v147
  v_exp_f32 v148, v148
  v_exp_f32 v149, v149
  v_exp_f32 v150, v150
  v_exp_f32 v151, v151
  v_exp_f32 v152, v152
  v_exp_f32 v153, v153
  v_exp_f32 v154, v154
  v_exp_f32 v155, v155
  v_exp_f32 v156, v156
  v_exp_f32 v157, v157
  v_exp_f32 v158, v158
  v_exp_f32 v159, v159
  v_cvt_pk_bf16_f32 v176, v144, v145
  v_cvt_pk_bf16_f32 v177, v146, v147
  v_cvt_pk_bf16_f32 v178, v148, v149
  v_cvt_pk_bf16_f32 v179, v150, v151
  v_cvt_pk_bf16_f32 v180, v152, v153
  v_cvt_pk_bf16_f32 v181, v154, v155
  v_cvt_pk_bf16_f32 v182, v156, v157
  v_cvt_pk_bf16_f32 v183, v158, v159
  v_mfma_f32_32x32x16_bf16 v[80:95], v[136:139], v[176:179], v[80:95]
s_nop 0
  v_mfma_f32_32x32x16_bf16 v[80:95], v[140:143], v[180:183], v[80:95]
  s_waitcnt lgkmcnt(0)
  s_cmp_eq_u32 s47, 3
  s_cbranch_scc1 b2ns_229
  v_mfma_f32_32x32x16_bf16 v[144:159], v[112:115], v[16:19], 0
  v_mfma_f32_32x32x16_bf16 v[144:159], v[116:119], v[20:23], v[144:159]
b2ns_229:
  v_max3_f32 v188, v160, v161, v162
  v_max3_f32 v188, v188, v163, v164
  v_max3_f32 v188, v188, v165, v166
  v_max3_f32 v188, v188, v167, v168
  v_max3_f32 v188, v188, v169, v170
  v_max3_f32 v188, v188, v171, v172
  v_max3_f32 v188, v188, v173, v174
  v_max_f32 v188, v188, v175
  v_cmp_lt_f32 vcc, s52, v188
  s_cbranch_vccnz b2r_230
b2b_231:
  v_exp_f32 v160, v160
  v_exp_f32 v161, v161
  v_exp_f32 v162, v162
  v_exp_f32 v163, v163
  v_exp_f32 v164, v164
  v_exp_f32 v165, v165
  v_exp_f32 v166, v166
  v_exp_f32 v167, v167
  v_exp_f32 v168, v168
  v_exp_f32 v169, v169
  v_exp_f32 v170, v170
  v_exp_f32 v171, v171
  v_exp_f32 v172, v172
  v_exp_f32 v173, v173
  v_exp_f32 v174, v174
  v_exp_f32 v175, v175
  v_cvt_pk_bf16_f32 v176, v160, v161
  v_cvt_pk_bf16_f32 v177, v162, v163
  v_cvt_pk_bf16_f32 v178, v164, v165
  v_cvt_pk_bf16_f32 v179, v166, v167
  v_cvt_pk_bf16_f32 v180, v168, v169
  v_cvt_pk_bf16_f32 v181, v170, v171
  v_cvt_pk_bf16_f32 v182, v172, v173
  v_cvt_pk_bf16_f32 v183, v174, v175
  v_mfma_f32_32x32x16_bf16 v[96:111], v[136:139], v[176:179], v[96:111]
s_nop 0
  v_mfma_f32_32x32x16_bf16 v[96:111], v[140:143], v[180:183], v[96:111]
  s_add_u32 s47, s47, 1
  s_cmp_lt_u32 s47, 4
  s_cbranch_scc1 L_b2_pair
  s_add_u32 s40, s40, 1
  s_cmp_lt_u32 s40, 8
  s_cbranch_scc1 L_b2_chunk
  s_branch L_b2_done
b2r_214:
  v_mov_b32 v189, v188
s_nop 1
  v_permlane32_swap_b32 v188, v189
  v_max_f32 v188, v188, v189
  v_max_f32 v188, s53, v188
  v_add_f32 v188, v184, v188
  v_cvt_pk_bf16_f32 v189, v188, v188
  v_lshlrev_b32 v188, 16, v189
  v_sub_f32 v190, v188, v184
  v_mov_b32 v184, v188
  v_and_b32 v189, 0xffff, v189
  v_xor_b32 v189, 0x8000, v189
  v_cndmask_b32 v20, v20, v189, s[50:51]
  v_sub_f32 v144, v144, v190
  v_sub_f32 v145, v145, v190
  v_sub_f32 v146, v146, v190
  v_sub_f32 v147, v147, v190
  v_sub_f32 v148, v148, v190
  v_sub_f32 v149, v149, v190
  v_sub_f32 v150, v150, v190
  v_sub_f32 v151, v151, v190
  v_sub_f32 v152, v152, v190
  v_sub_f32 v153, v153, v190
  v_sub_f32 v154, v154, v190
  v_sub_f32 v155, v155, v190
  v_sub_f32 v156, v156, v190
  v_sub_f32 v157, v157, v190
  v_sub_f32 v158, v158, v190
  v_sub_f32 v159, v159, v190
  v_sub_f32 v190, 0, v190
  v_exp_f32 v190, v190
s_nop 0
  v_mul_f32 v48, v48, v190
  v_mul_f32 v49, v49, v190
  v_mul_f32 v50, v50, v190
  v_mul_f32 v51, v51, v190
  v_mul_f32 v52, v52, v190
  v_mul_f32 v53, v53, v190
  v_mul_f32 v54, v54, v190
  v_mul_f32 v55, v55, v190
  v_mul_f32 v56, v56, v190
  v_mul_f32 v57, v57, v190
  v_mul_f32 v58, v58, v190
  v_mul_f32 v59, v59, v190
  v_mul_f32 v60, v60, v190
  v_mul_f32 v61, v61, v190
  v_mul_f32 v62, v62, v190
  v_mul_f32 v63, v63, v190
  s_branch b2b_215
b2r_216:
  v_mov_b32 v189, v188
s_nop 1
  v_permlane32_swap_b32 v188, v189
  v_max_f32 v188, v188, v189
  v_max_f32 v188, s53, v188
  v_add_f32 v188, v185, v188
  v_cvt_pk_bf16_f32 v189, v188, v188
  v_lshlrev_b32 v188, 16, v189
  v_sub_f32 v190, v188, v185
  v_mov_b32 v185, v188
  v_and_b32 v189, 0xffff, v189
  v_xor_b32 v189, 0x8000, v189
  v_cndmask_b32 v28, v28, v189, s[50:51]
  v_sub_f32 v160, v160, v190
  v_sub_f32 v161, v161, v190
  v_sub_f32 v162, v162, v190
  v_sub_f32 v163, v163, v190
  v_sub_f32 v164, v164, v190
  v_sub_f32 v165, v165, v190
  v_sub_f32 v166, v166, v190
  v_sub_f32 v167, v167, v190
  v_sub_f32 v168, v168, v190
  v_sub_f32 v169, v169, v190
  v_sub_f32 v170, v170, v190
  v_sub_f32 v171, v171, v190
  v_sub_f32 v172, v172, v190
  v_sub_f32 v173, v173, v190
  v_sub_f32 v174, v174, v190
  v_sub_f32 v175, v175, v190
  v_sub_f32 v190, 0, v190
  v_exp_f32 v190, v190
s_nop 0
  v_mul_f32 v64, v64, v190
  v_mul_f32 v65, v65, v190
  v_mul_f32 v66, v66, v190
  v_mul_f32 v67, v67, v190
  v_mul_f32 v68, v68, v190
  v_mul_f32 v69, v69, v190
  v_mul_f32 v70, v70, v190
  v_mul_f32 v71, v71, v190
  v_mul_f32 v72, v72, v190
  v_mul_f32 v73, v73, v190
  v_mul_f32 v74, v74, v190
  v_mul_f32 v75, v75, v190
  v_mul_f32 v76, v76, v190
  v_mul_f32 v77, v77, v190
  v_mul_f32 v78, v78, v190
  v_mul_f32 v79, v79, v190
  s_branch b2b_217
b2r_218:
  v_mov_b32 v189, v188
s_nop 1
  v_permlane32_swap_b32 v188, v189
  v_max_f32 v188, v188, v189
  v_max_f32 v188, s53, v188
  v_add_f32 v188, v186, v188
  v_cvt_pk_bf16_f32 v189, v188, v188
  v_lshlrev_b32 v188, 16, v189
  v_sub_f32 v190, v188, v186
  v_mov_b32 v186, v188
  v_and_b32 v189, 0xffff, v189
  v_xor_b32 v189, 0x8000, v189
  v_cndmask_b32 v36, v36, v189, s[50:51]
  v_sub_f32 v144, v144, v190
  v_sub_f32 v145, v145, v190
  v_sub_f32 v146, v146, v190
  v_sub_f32 v147, v147, v190
  v_sub_f32 v148, v148, v190
  v_sub_f32 v149, v149, v190
  v_sub_f32 v150, v150, v190
  v_sub_f32 v151, v151, v190
  v_sub_f32 v152, v152, v190
  v_sub_f32 v153, v153, v190
  v_sub_f32 v154, v154, v190
  v_sub_f32 v155, v155, v190
  v_sub_f32 v156, v156, v190
  v_sub_f32 v157, v157, v190
  v_sub_f32 v158, v158, v190
  v_sub_f32 v159, v159, v190
  v_sub_f32 v190, 0, v190
  v_exp_f32 v190, v190
s_nop 0
  v_mul_f32 v80, v80, v190
  v_mul_f32 v81, v81, v190
  v_mul_f32 v82, v82, v190
  v_mul_f32 v83, v83, v190
  v_mul_f32 v84, v84, v190
  v_mul_f32 v85, v85, v190
  v_mul_f32 v86, v86, v190
  v_mul_f32 v87, v87, v190
  v_mul_f32 v88, v88, v190
  v_mul_f32 v89, v89, v190
  v_mul_f32 v90, v90, v190
  v_mul_f32 v91, v91, v190
  v_mul_f32 v92, v92, v190
  v_mul_f32 v93, v93, v190
  v_mul_f32 v94, v94, v190
  v_mul_f32 v95, v95, v190
  s_branch b2b_219
b2r_220:
  v_mov_b32 v189, v188
s_nop 1
  v_permlane32_swap_b32 v188, v189
  v_max_f32 v188, v188, v189
  v_max_f32 v188, s53, v188
  v_add_f32 v188, v187, v188
  v_cvt_pk_bf16_f32 v189, v188, v188
  v_lshlrev_b32 v188, 16, v189
  v_sub_f32 v190, v188, v187
  v_mov_b32 v187, v188
  v_and_b32 v189, 0xffff, v189
  v_xor_b32 v189, 0x8000, v189
  v_cndmask_b32 v44, v44, v189, s[50:51]
  v_sub_f32 v160, v160, v190
  v_sub_f32 v161, v161, v190
  v_sub_f32 v162, v162, v190
  v_sub_f32 v163, v163, v190
  v_sub_f32 v164, v164, v190
  v_sub_f32 v165, v165, v190
  v_sub_f32 v166, v166, v190
  v_sub_f32 v167, v167, v190
  v_sub_f32 v168, v168, v190
  v_sub_f32 v169, v169, v190
  v_sub_f32 v170, v170, v190
  v_sub_f32 v171, v171, v190
  v_sub_f32 v172, v172, v190
  v_sub_f32 v173, v173, v190
  v_sub_f32 v174, v174, v190
  v_sub_f32 v175, v175, v190
  v_sub_f32 v190, 0, v190
  v_exp_f32 v190, v190
s_nop 0
  v_mul_f32 v96, v96, v190
  v_mul_f32 v97, v97, v190
  v_mul_f32 v98, v98, v190
  v_mul_f32 v99, v99, v190
  v_mul_f32 v100, v100, v190
  v_mul_f32 v101, v101, v190
  v_mul_f32 v102, v102, v190
  v_mul_f32 v103, v103, v190
  v_mul_f32 v104, v104, v190
  v_mul_f32 v105, v105, v190
  v_mul_f32 v106, v106, v190
  v_mul_f32 v107, v107, v190
  v_mul_f32 v108, v108, v190
  v_mul_f32 v109, v109, v190
  v_mul_f32 v110, v110, v190
  v_mul_f32 v111, v111, v190
  s_branch b2b_221
b2r_223:
  v_mov_b32 v189, v188
s_nop 1
  v_permlane32_swap_b32 v188, v189
  v_max_f32 v188, v188, v189
  v_max_f32 v188, s53, v188
  v_add_f32 v188, v184, v188
  v_cvt_pk_bf16_f32 v189, v188, v188
  v_lshlrev_b32 v188, 16, v189
  v_sub_f32 v190, v188, v184
  v_mov_b32 v184, v188
  v_and_b32 v189, 0xffff, v189
  v_xor_b32 v189, 0x8000, v189
  v_cndmask_b32 v20, v20, v189, s[50:51]
  v_sub_f32 v144, v144, v190
  v_sub_f32 v145, v145, v190
  v_sub_f32 v146, v146, v190
  v_sub_f32 v147, v147, v190
  v_sub_f32 v148, v148, v190
  v_sub_f32 v149, v149, v190
  v_sub_f32 v150, v150, v190
  v_sub_f32 v151, v151, v190
  v_sub_f32 v152, v152, v190
  v_sub_f32 v153, v153, v190
  v_sub_f32 v154, v154, v190
  v_sub_f32 v155, v155, v190
  v_sub_f32 v156, v156, v190
  v_sub_f32 v157, v157, v190
  v_sub_f32 v158, v158, v190
  v_sub_f32 v159, v159, v190
  v_sub_f32 v190, 0, v190
  v_exp_f32 v190, v190
s_nop 0
  v_mul_f32 v48, v48, v190
  v_mul_f32 v49, v49, v190
  v_mul_f32 v50, v50, v190
  v_mul_f32 v51, v51, v190
  v_mul_f32 v52, v52, v190
  v_mul_f32 v53, v53, v190
  v_mul_f32 v54, v54, v190
  v_mul_f32 v55, v55, v190
  v_mul_f32 v56, v56, v190
  v_mul_f32 v57, v57, v190
  v_mul_f32 v58, v58, v190
  v_mul_f32 v59, v59, v190
  v_mul_f32 v60, v60, v190
  v_mul_f32 v61, v61, v190
  v_mul_f32 v62, v62, v190
  v_mul_f32 v63, v63, v190
  s_branch b2b_224
b2r_225:
  v_mov_b32 v189, v188
s_nop 1
  v_permlane32_swap_b32 v188, v189
  v_max_f32 v188, v188, v189
  v_max_f32 v188, s53, v188
  v_add_f32 v188, v185, v188
  v_cvt_pk_bf16_f32 v189, v188, v188
  v_lshlrev_b32 v188, 16, v189
  v_sub_f32 v190, v188, v185
  v_mov_b32 v185, v188
  v_and_b32 v189, 0xffff, v189
  v_xor_b32 v189, 0x8000, v189
  v_cndmask_b32 v28, v28, v189, s[50:51]
  v_sub_f32 v160, v160, v190
  v_sub_f32 v161, v161, v190
  v_sub_f32 v162, v162, v190
  v_sub_f32 v163, v163, v190
  v_sub_f32 v164, v164, v190
  v_sub_f32 v165, v165, v190
  v_sub_f32 v166, v166, v190
  v_sub_f32 v167, v167, v190
  v_sub_f32 v168, v168, v190
  v_sub_f32 v169, v169, v190
  v_sub_f32 v170, v170, v190
  v_sub_f32 v171, v171, v190
  v_sub_f32 v172, v172, v190
  v_sub_f32 v173, v173, v190
  v_sub_f32 v174, v174, v190
  v_sub_f32 v175, v175, v190
  v_sub_f32 v190, 0, v190
  v_exp_f32 v190, v190
s_nop 0
  v_mul_f32 v64, v64, v190
  v_mul_f32 v65, v65, v190
  v_mul_f32 v66, v66, v190
  v_mul_f32 v67, v67, v190
  v_mul_f32 v68, v68, v190
  v_mul_f32 v69, v69, v190
  v_mul_f32 v70, v70, v190
  v_mul_f32 v71, v71, v190
  v_mul_f32 v72, v72, v190
  v_mul_f32 v73, v73, v190
  v_mul_f32 v74, v74, v190
  v_mul_f32 v75, v75, v190
  v_mul_f32 v76, v76, v190
  v_mul_f32 v77, v77, v190
  v_mul_f32 v78, v78, v190
  v_mul_f32 v79, v79, v190
  s_branch b2b_226
b2r_227:
  v_mov_b32 v189, v188
s_nop 1
  v_permlane32_swap_b32 v188, v189
  v_max_f32 v188, v188, v189
  v_max_f32 v188, s53, v188
  v_add_f32 v188, v186, v188
  v_cvt_pk_bf16_f32 v189, v188, v188
  v_lshlrev_b32 v188, 16, v189
  v_sub_f32 v190, v188, v186
  v_mov_b32 v186, v188
  v_and_b32 v189, 0xffff, v189
  v_xor_b32 v189, 0x8000, v189
  v_cndmask_b32 v36, v36, v189, s[50:51]
  v_sub_f32 v144, v144, v190
  v_sub_f32 v145, v145, v190
  v_sub_f32 v146, v146, v190
  v_sub_f32 v147, v147, v190
  v_sub_f32 v148, v148, v190
  v_sub_f32 v149, v149, v190
  v_sub_f32 v150, v150, v190
  v_sub_f32 v151, v151, v190
  v_sub_f32 v152, v152, v190
  v_sub_f32 v153, v153, v190
  v_sub_f32 v154, v154, v190
  v_sub_f32 v155, v155, v190
  v_sub_f32 v156, v156, v190
  v_sub_f32 v157, v157, v190
  v_sub_f32 v158, v158, v190
  v_sub_f32 v159, v159, v190
  v_sub_f32 v190, 0, v190
  v_exp_f32 v190, v190
s_nop 0
  v_mul_f32 v80, v80, v190
  v_mul_f32 v81, v81, v190
  v_mul_f32 v82, v82, v190
  v_mul_f32 v83, v83, v190
  v_mul_f32 v84, v84, v190
  v_mul_f32 v85, v85, v190
  v_mul_f32 v86, v86, v190
  v_mul_f32 v87, v87, v190
  v_mul_f32 v88, v88, v190
  v_mul_f32 v89, v89, v190
  v_mul_f32 v90, v90, v190
  v_mul_f32 v91, v91, v190
  v_mul_f32 v92, v92, v190
  v_mul_f32 v93, v93, v190
  v_mul_f32 v94, v94, v190
  v_mul_f32 v95, v95, v190
  s_branch b2b_228
b2r_230:
  v_mov_b32 v189, v188
s_nop 1
  v_permlane32_swap_b32 v188, v189
  v_max_f32 v188, v188, v189
  v_max_f32 v188, s53, v188
  v_add_f32 v188, v187, v188
  v_cvt_pk_bf16_f32 v189, v188, v188
  v_lshlrev_b32 v188, 16, v189
  v_sub_f32 v190, v188, v187
  v_mov_b32 v187, v188
  v_and_b32 v189, 0xffff, v189
  v_xor_b32 v189, 0x8000, v189
  v_cndmask_b32 v44, v44, v189, s[50:51]
  v_sub_f32 v160, v160, v190
  v_sub_f32 v161, v161, v190
  v_sub_f32 v162, v162, v190
  v_sub_f32 v163, v163, v190
  v_sub_f32 v164, v164, v190
  v_sub_f32 v165, v165, v190
  v_sub_f32 v166, v166, v190
  v_sub_f32 v167, v167, v190
  v_sub_f32 v168, v168, v190
  v_sub_f32 v169, v169, v190
  v_sub_f32 v170, v170, v190
  v_sub_f32 v171, v171, v190
  v_sub_f32 v172, v172, v190
  v_sub_f32 v173, v173, v190
  v_sub_f32 v174, v174, v190
  v_sub_f32 v175, v175, v190
  v_sub_f32 v190, 0, v190
  v_exp_f32 v190, v190
s_nop 0
  v_mul_f32 v96, v96, v190
  v_mul_f32 v97, v97, v190
  v_mul_f32 v98, v98, v190
  v_mul_f32 v99, v99, v190
  v_mul_f32 v100, v100, v190
  v_mul_f32 v101, v101, v190
  v_mul_f32 v102, v102, v190
  v_mul_f32 v103, v103, v190
  v_mul_f32 v104, v104, v190
  v_mul_f32 v105, v105, v190
  v_mul_f32 v106, v106, v190
  v_mul_f32 v107, v107, v190
  v_mul_f32 v108, v108, v190
  v_mul_f32 v109, v109, v190
  v_mul_f32 v110, v110, v190
  v_mul_f32 v111, v111, v190
  s_branch b2b_231
L_b2_done:
  v_and_b32 v10, 31, v1
  v_lshrrev_b32 v11, 5, v1
  v_mul_u32_u24 v10, 1280, v10
  v_lshl_add_u32 v10, v11, 3, v10
  s_mul_i32 s34, s43, 40
  s_mul_i32 s35, s45, 40960
  s_add_u32 s34, s34, s35
  s_add_u32 s34, s34, 109051904
  v_mov_b32 v188, v56
  v_mov_b32 v189, v56
s_nop 1
  v_permlane32_swap_b32 v188, v189
  v_rcp_f32 v189, v189
s_nop 0
  v_mul_f32 v48, v48, v189
  v_mul_f32 v49, v49, v189
  v_mul_f32 v50, v50, v189
  v_mul_f32 v51, v51, v189
  v_cvt_pk_bf16_f32 v176, v48, v49
  v_cvt_pk_bf16_f32 v177, v50, v51
  v_mul_f32 v52, v52, v189
  v_mul_f32 v53, v53, v189
  v_mul_f32 v54, v54, v189
  v_mul_f32 v55, v55, v189
  v_cvt_pk_bf16_f32 v178, v52, v53
  v_cvt_pk_bf16_f32 v179, v54, v55
  v_mul_f32 v56, v56, v189
  v_mul_f32 v57, v57, v189
  v_mul_f32 v58, v58, v189
  v_mul_f32 v59, v59, v189
  v_cvt_pk_bf16_f32 v180, v56, v57
  v_cvt_pk_bf16_f32 v181, v58, v59
  buffer_store_dwordx2 v[176:177], v10, s[8:11], s34 offen sc1
  buffer_store_dwordx2 v[178:179], v10, s[8:11], s34 offen offset:16 sc1
  s_mov_b32 exec_hi, 0
  buffer_store_dwordx2 v[180:181], v10, s[8:11], s34 offen offset:32 sc1
  s_mov_b32 exec_hi, -1
  s_add_u32 s34, s34, 40960
  v_mov_b32 v188, v72
  v_mov_b32 v189, v72
s_nop 1
  v_permlane32_swap_b32 v188, v189
  v_rcp_f32 v189, v189
s_nop 0
  v_mul_f32 v64, v64, v189
  v_mul_f32 v65, v65, v189
  v_mul_f32 v66, v66, v189
  v_mul_f32 v67, v67, v189
  v_cvt_pk_bf16_f32 v176, v64, v65
  v_cvt_pk_bf16_f32 v177, v66, v67
  v_mul_f32 v68, v68, v189
  v_mul_f32 v69, v69, v189
  v_mul_f32 v70, v70, v189
  v_mul_f32 v71, v71, v189
  v_cvt_pk_bf16_f32 v178, v68, v69
  v_cvt_pk_bf16_f32 v179, v70, v71
  v_mul_f32 v72, v72, v189
  v_mul_f32 v73, v73, v189
  v_mul_f32 v74, v74, v189
  v_mul_f32 v75, v75, v189
  v_cvt_pk_bf16_f32 v180, v72, v73
  v_cvt_pk_bf16_f32 v181, v74, v75
  buffer_store_dwordx2 v[176:177], v10, s[8:11], s34 offen sc1
  buffer_store_dwordx2 v[178:179], v10, s[8:11], s34 offen offset:16 sc1
  s_mov_b32 exec_hi, 0
  buffer_store_dwordx2 v[180:181], v10, s[8:11], s34 offen offset:32 sc1
  s_mov_b32 exec_hi, -1
  s_add_u32 s34, s34, 40960
  v_mov_b32 v188, v88
  v_mov_b32 v189, v88
s_nop 1
  v_permlane32_swap_b32 v188, v189
  v_rcp_f32 v189, v189
s_nop 0
  v_mul_f32 v80, v80, v189
  v_mul_f32 v81, v81, v189
  v_mul_f32 v82, v82, v189
  v_mul_f32 v83, v83, v189
  v_cvt_pk_bf16_f32 v176, v80, v81
  v_cvt_pk_bf16_f32 v177, v82, v83
  v_mul_f32 v84, v84, v189
  v_mul_f32 v85, v85, v189
  v_mul_f32 v86, v86, v189
  v_mul_f32 v87, v87, v189
  v_cvt_pk_bf16_f32 v178, v84, v85
  v_cvt_pk_bf16_f32 v179, v86, v87
  v_mul_f32 v88, v88, v189
  v_mul_f32 v89, v89, v189
  v_mul_f32 v90, v90, v189
  v_mul_f32 v91, v91, v189
  v_cvt_pk_bf16_f32 v180, v88, v89
  v_cvt_pk_bf16_f32 v181, v90, v91
  buffer_store_dwordx2 v[176:177], v10, s[8:11], s34 offen sc1
  buffer_store_dwordx2 v[178:179], v10, s[8:11], s34 offen offset:16 sc1
  s_mov_b32 exec_hi, 0
  buffer_store_dwordx2 v[180:181], v10, s[8:11], s34 offen offset:32 sc1
  s_mov_b32 exec_hi, -1
  s_add_u32 s34, s34, 40960
  v_mov_b32 v188, v104
  v_mov_b32 v189, v104
s_nop 1
  v_permlane32_swap_b32 v188, v189
  v_rcp_f32 v189, v189
s_nop 0
  v_mul_f32 v96, v96, v189
  v_mul_f32 v97, v97, v189
  v_mul_f32 v98, v98, v189
  v_mul_f32 v99, v99, v189
  v_cvt_pk_bf16_f32 v176, v96, v97
  v_cvt_pk_bf16_f32 v177, v98, v99
  v_mul_f32 v100, v100, v189
  v_mul_f32 v101, v101, v189
  v_mul_f32 v102, v102, v189
  v_mul_f32 v103, v103, v189
  v_cvt_pk_bf16_f32 v178, v100, v101
  v_cvt_pk_bf16_f32 v179, v102, v103
  v_mul_f32 v104, v104, v189
  v_mul_f32 v105, v105, v189
  v_mul_f32 v106, v106, v189
  v_mul_f32 v107, v107, v189
  v_cvt_pk_bf16_f32 v180, v104, v105
  v_cvt_pk_bf16_f32 v181, v106, v107
  buffer_store_dwordx2 v[176:177], v10, s[8:11], s34 offen sc1
  buffer_store_dwordx2 v[178:179], v10, s[8:11], s34 offen offset:16 sc1
  s_mov_b32 exec_hi, 0
  buffer_store_dwordx2 v[180:181], v10, s[8:11], s34 offen offset:32 sc1
  s_mov_b32 exec_hi, -1
  s_add_u32 s34, s34, 40960
  s_waitcnt vmcnt(0)
  s_barrier
  s_cmp_lg_u32 s30, 0
  s_cbranch_scc1 L_b3
  s_waitcnt vmcnt(0)
  s_lshl_b32 s34, s41, 2
  s_add_u32 s34, s34, 768
  s_add_u32 s34, s34, s100
  v_mov_b32 v10, s34
  v_mov_b32 v11, 1
  s_mov_b64 exec, 1
  buffer_store_dword v11, v10, s[8:11], 0 offen sc1
  s_mov_b64 exec, -1
L_b3:
  s_load_dwordx2 s[4:5], s[0:1], 72
  s_load_dwordx2 s[6:7], s[0:1], 80
  s_waitcnt lgkmcnt(0)
  s_mov_b32 s16, s4
  s_and_b32 s17, s5, 0xffff
  s_mov_b32 s18, 0xc8000
  s_mov_b32 s19, 0x20000
  s_mov_b32 s24, s6
  s_and_b32 s25, s7, 0xffff
  s_mov_b32 s26, 0x500000
  s_mov_b32 s27, 0x20000
  s_mov_b32 s20, s8
  s_mov_b32 s21, s9
  s_add_u32 s20, s20, 109051904
  s_addc_u32 s21, s21, 0
  s_mov_b32 s22, 2621440
  s_mov_b32 s23, 0x20000
  v_lshlrev_b32 v10, 2, v1
  v_add_u32 v10, 768, v10
  v_add_u32 v10, s100, v10
  s_mov_b32 s36, 1
  s_cmp_lg_u32 s30, 0
  s_cbranch_scc1 L_b2w_go
  s_mov_b32 s39, 0
  s_mov_b64 s[70:71], exec
  s_mov_b32 exec_lo, 0xffffffff
  s_mov_b32 exec_hi, 0xffffffff
b2w_232:
  buffer_load_dword v13, v10, s[8:11], 0 offen sc1
  s_waitcnt vmcnt(0)
  v_cmp_gt_u32 vcc, s36, v13
  s_cbranch_vccz b2wd_233
  s_sleep 16
  s_add_u32 s39, s39, 1
  s_cmp_lt_u32 s39, s33
  s_cbranch_scc1 b2w_232
  s_mov_b32 s33, 0
b2wd_233:
  s_mov_b64 exec, s[70:71]
L_b2w_go:
  s_barrier
  s_and_b32 s43, s41, 3
  s_lshr_b32 s34, s41, 2
  s_lshl_b32 s47, s34, 2
  s_mul_i32 s46, s43, 320
  v_lshlrev_b32 v2, 4, v0
  v_add_u32 v10, 0, v0
  v_mul_u32_u24 v11, 52429, v10
  v_lshrrev_b32 v11, 22, v11
  v_add_u32 v11, v11, v10
  v_lshlrev_b32 v3, 4, v11
  v_add_u32 v10, 512, v0
  v_mul_u32_u24 v11, 52429, v10
  v_lshrrev_b32 v11, 22, v11
  v_add_u32 v11, v11, v10
  v_lshlrev_b32 v4, 4, v11
  v_add_u32 v10, 1024, v0
  v_mul_u32_u24 v11, 52429, v10
  v_lshrrev_b32 v11, 22, v11
  v_add_u32 v11, v11, v10
  v_lshlrev_b32 v5, 4, v11
  v_add_u32 v10, 1536, v0
  v_mul_u32_u24 v11, 52429, v10
  v_lshrrev_b32 v11, 22, v11
  v_add_u32 v11, v11, v10
  v_lshlrev_b32 v6, 4, v11
  v_add_u32 v10, 2048, v0
  v_mul_u32_u24 v11, 52429, v10
  v_lshrrev_b32 v11, 22, v11
  v_add_u32 v11, v11, v10
  v_lshlrev_b32 v7, 4, v11
  s_mul_i32 s34, s47, 40960
  buffer_load_dwordx4 v[204:207], v2, s[20:23], s34 offen sc1
  s_add_u32 s34, s34, 8192
  buffer_load_dwordx4 v[208:211], v2, s[20:23], s34 offen sc1
  s_add_u32 s34, s34, 8192
  buffer_load_dwordx4 v[212:215], v2, s[20:23], s34 offen sc1
  s_add_u32 s34, s34, 8192
  buffer_load_dwordx4 v[216:219], v2, s[20:23], s34 offen sc1
  s_add_u32 s34, s34, 8192
  buffer_load_dwordx4 v[220:223], v2, s[20:23], s34 offen sc1
  s_add_u32 s34, s34, 8192
  v_lshrrev_b32 v10, 4, v1
  v_lshrrev_b32 v11, 1, v10
  v_and_b32 v10, 1, v10
  v_bfe_u32 v14, v1, 2, 2
  v_lshl_add_u32 v11, v11, 3, v14
  v_mul_u32_u24 v11, 320, v11
  v_lshl_add_u32 v11, v10, 5, v11
  v_and_b32 v10, 3, v1
  v_lshl_add_u32 v11, v10, 3, v11
  s_mul_i32 s34, s30, 64
  v_add_u32 v14, s34, v11
  v_add_u32 v9, 0, v0
  v_mul_u32_u24 v13, 52429, v9
  v_lshrrev_b32 v13, 20, v13
  v_mul_u32_u24 v8, 20, v13
  v_sub_u32 v8, v9, v8
  v_mul_u32_u24 v13, 1280, v13
  v_lshl_add_u32 v13, v8, 4, v13
  v_add_u32 v10, s46, v13
  v_add_u32 v9, 512, v0
  v_mul_u32_u24 v13, 52429, v9
  v_lshrrev_b32 v13, 20, v13
  v_mul_u32_u24 v8, 20, v13
  v_sub_u32 v8, v9, v8
  v_mul_u32_u24 v13, 1280, v13
  v_lshl_add_u32 v13, v8, 4, v13
  v_add_u32 v11, s46, v13
  v_add_u32 v9, 1024, v0
  v_mul_u32_u24 v13, 52429, v9
  v_lshrrev_b32 v13, 20, v13
  v_mul_u32_u24 v8, 20, v13
  v_sub_u32 v8, v9, v8
  v_mul_u32_u24 v13, 1280, v13
  v_lshl_add_u32 v13, v8, 4, v13
  v_add_u32 v12, s46, v13
  s_mov_b32 s34, 0
  buffer_load_dwordx4 v[232:235], v10, s[16:19], s34 offen
  buffer_load_dwordx4 v[236:239], v11, s[16:19], s34 offen
  buffer_load_dwordx4 v[240:243], v12, s[16:19], s34 offen
  s_mov_b32 s34, 81920
  buffer_load_dwordx4 v[244:247], v10, s[16:19], s34 offen
  buffer_load_dwordx4 v[248:251], v11, s[16:19], s34 offen
  buffer_load_dwordx4 v[252:255], v12, s[16:19], s34 offen
  s_waitcnt vmcnt(3)
  ds_write_b128 v2, v[232:235] offset:0
  ds_write_b128 v2, v[236:239] offset:8192
  ds_write_b128 v2, v[240:243] offset:16384
  s_waitcnt lgkmcnt(0)
  s_mov_b32 s34, 163840
  buffer_load_dwordx4 v[232:235], v10, s[16:19], s34 offen
  buffer_load_dwordx4 v[236:239], v11, s[16:19], s34 offen
  buffer_load_dwordx4 v[240:243], v12, s[16:19], s34 offen
  s_barrier
  ds_read_b64_tr_b16 v[16:17], v14 offset:0
  ds_read_b64_tr_b16 v[18:19], v14 offset:1280
  ds_read_b64_tr_b16 v[20:21], v14 offset:5120
  ds_read_b64_tr_b16 v[22:23], v14 offset:6400
  ds_read_b64_tr_b16 v[24:25], v14 offset:10240
  ds_read_b64_tr_b16 v[26:27], v14 offset:11520
  ds_read_b64_tr_b16 v[28:29], v14 offset:15360
  ds_read_b64_tr_b16 v[30:31], v14 offset:16640
  s_waitcnt lgkmcnt(0)
  s_waitcnt vmcnt(3)
  ds_write_b128 v2, v[244:247] offset:24576
  ds_write_b128 v2, v[248:251] offset:32768
  ds_write_b128 v2, v[252:255] offset:40960
  s_waitcnt lgkmcnt(0)
  s_mov_b32 s34, 245760
  buffer_load_dwordx4 v[244:247], v10, s[16:19], s34 offen
  buffer_load_dwordx4 v[248:251], v11, s[16:19], s34 offen
  buffer_load_dwordx4 v[252:255], v12, s[16:19], s34 offen
  s_barrier
  ds_read_b64_tr_b16 v[32:33], v14 offset:24576
  ds_read_b64_tr_b16 v[34:35], v14 offset:25856
  ds_read_b64_tr_b16 v[36:37], v14 offset:29696
  ds_read_b64_tr_b16 v[38:39], v14 offset:30976
  ds_read_b64_tr_b16 v[40:41], v14 offset:34816
  ds_read_b64_tr_b16 v[42:43], v14 offset:36096
  ds_read_b64_tr_b16 v[44:45], v14 offset:39936
  ds_read_b64_tr_b16 v[46:47], v14 offset:41216
  s_waitcnt lgkmcnt(0)
  s_waitcnt vmcnt(3)
  ds_write_b128 v2, v[232:235] offset:0
  ds_write_b128 v2, v[236:239] offset:8192
  ds_write_b128 v2, v[240:243] offset:16384
  s_waitcnt lgkmcnt(0)
  s_mov_b32 s34, 327680
  buffer_load_dwordx4 v[232:235], v10, s[16:19], s34 offen
  buffer_load_dwordx4 v[236:239], v11, s[16:19], s34 offen
  buffer_load_dwordx4 v[240:243], v12, s[16:19], s34 offen
  s_barrier
  ds_read_b64_tr_b16 v[48:49], v14 offset:0
  ds_read_b64_tr_b16 v[50:51], v14 offset:1280
  ds_read_b64_tr_b16 v[52:53], v14 offset:5120
  ds_read_b64_tr_b16 v[54:55], v14 offset:6400
  ds_read_b64_tr_b16 v[56:57], v14 offset:10240
  ds_read_b64_tr_b16 v[58:59], v14 offset:11520
  ds_read_b64_tr_b16 v[60:61], v14 offset:15360
  ds_read_b64_tr_b16 v[62:63], v14 offset:16640
  s_waitcnt lgkmcnt(0)
  s_waitcnt vmcnt(3)
  ds_write_b128 v2, v[244:247] offset:24576
  ds_write_b128 v2, v[248:251] offset:32768
  ds_write_b128 v2, v[252:255] offset:40960
  s_waitcnt lgkmcnt(0)
  s_mov_b32 s34, 409600
  buffer_load_dwordx4 v[244:247], v10, s[16:19], s34 offen
  buffer_load_dwordx4 v[248:251], v11, s[16:19], s34 offen
  buffer_load_dwordx4 v[252:255], v12, s[16:19], s34 offen
  s_barrier
  ds_read_b64_tr_b16 v[64:65], v14 offset:24576
  ds_read_b64_tr_b16 v[66:67], v14 offset:25856
  ds_read_b64_tr_b16 v[68:69], v14 offset:29696
  ds_read_b64_tr_b16 v[70:71], v14 offset:30976
  ds_read_b64_tr_b16 v[72:73], v14 offset:34816
  ds_read_b64_tr_b16 v[74:75], v14 offset:36096
  ds_read_b64_tr_b16 v[76:77], v14 offset:39936
  ds_read_b64_tr_b16 v[78:79], v14 offset:41216
  s_waitcnt lgkmcnt(0)
  s_waitcnt vmcnt(3)
  ds_write_b128 v2, v[232:235] offset:0
  ds_write_b128 v2, v[236:239] offset:8192
  ds_write_b128 v2, v[240:243] offset:16384
  s_waitcnt lgkmcnt(0)
  s_mov_b32 s34, 491520
  buffer_load_dwordx4 v[232:235], v10, s[16:19], s34 offen
  buffer_load_dwordx4 v[236:239], v11, s[16:19], s34 offen
  buffer_load_dwordx4 v[240:243], v12, s[16:19], s34 offen
  s_barrier
  ds_read_b64_tr_b16 v[80:81], v14 offset:0
  ds_read_b64_tr_b16 v[82:83], v14 offset:1280
  ds_read_b64_tr_b16 v[84:85], v14 offset:5120
  ds_read_b64_tr_b16 v[86:87], v14 offset:6400
  ds_read_b64_tr_b16 v[88:89], v14 offset:10240
  ds_read_b64_tr_b16 v[90:91], v14 offset:11520
  ds_read_b64_tr_b16 v[92:93], v14 offset:15360
  ds_read_b64_tr_b16 v[94:95], v14 offset:16640
  s_waitcnt lgkmcnt(0)
  s_waitcnt vmcnt(3)
  ds_write_b128 v2, v[244:247] offset:24576
  ds_write_b128 v2, v[248:251] offset:32768
  ds_write_b128 v2, v[252:255] offset:40960
  s_waitcnt lgkmcnt(0)
  s_mov_b32 s34, 573440
  buffer_load_dwordx4 v[244:247], v10, s[16:19], s34 offen
  buffer_load_dwordx4 v[248:251], v11, s[16:19], s34 offen
  buffer_load_dwordx4 v[252:255], v12, s[16:19], s34 offen
  s_barrier
  ds_read_b64_tr_b16 v[96:97], v14 offset:24576
  ds_read_b64_tr_b16 v[98:99], v14 offset:25856
  ds_read_b64_tr_b16 v[100:101], v14 offset:29696
  ds_read_b64_tr_b16 v[102:103], v14 offset:30976
  ds_read_b64_tr_b16 v[104:105], v14 offset:34816
  ds_read_b64_tr_b16 v[106:107], v14 offset:36096
  ds_read_b64_tr_b16 v[108:109], v14 offset:39936
  ds_read_b64_tr_b16 v[110:111], v14 offset:41216
  s_waitcnt lgkmcnt(0)
  s_waitcnt vmcnt(3)
  ds_write_b128 v2, v[232:235] offset:0
  ds_write_b128 v2, v[236:239] offset:8192
  ds_write_b128 v2, v[240:243] offset:16384
  s_waitcnt lgkmcnt(0)
  s_mov_b32 s34, 655360
  buffer_load_dwordx4 v[232:235], v10, s[16:19], s34 offen
  buffer_load_dwordx4 v[236:239], v11, s[16:19], s34 offen
  buffer_load_dwordx4 v[240:243], v12, s[16:19], s34 offen
  s_barrier
  ds_read_b64_tr_b16 v[112:113], v14 offset:0
  ds_read_b64_tr_b16 v[114:115], v14 offset:1280
  ds_read_b64_tr_b16 v[116:117], v14 offset:5120
  ds_read_b64_tr_b16 v[118:119], v14 offset:6400
  ds_read_b64_tr_b16 v[120:121], v14 offset:10240
  ds_read_b64_tr_b16 v[122:123], v14 offset:11520
  ds_read_b64_tr_b16 v[124:125], v14 offset:15360
  ds_read_b64_tr_b16 v[126:127], v14 offset:16640
  s_waitcnt lgkmcnt(0)
  s_waitcnt vmcnt(3)
  ds_write_b128 v2, v[244:247] offset:24576
  ds_write_b128 v2, v[248:251] offset:32768
  ds_write_b128 v2, v[252:255] offset:40960
  s_waitcnt lgkmcnt(0)
  s_mov_b32 s34, 737280
  buffer_load_dwordx4 v[244:247], v10, s[16:19], s34 offen
  buffer_load_dwordx4 v[248:251], v11, s[16:19], s34 offen
  buffer_load_dwordx4 v[252:255], v12, s[16:19], s34 offen
  s_barrier
  ds_read_b64_tr_b16 v[128:129], v14 offset:24576
  ds_read_b64_tr_b16 v[130:131], v14 offset:25856
  ds_read_b64_tr_b16 v[132:133], v14 offset:29696
  ds_read_b64_tr_b16 v[134:135], v14 offset:30976
  ds_read_b64_tr_b16 v[136:137], v14 offset:34816
  ds_read_b64_tr_b16 v[138:139], v14 offset:36096
  ds_read_b64_tr_b16 v[140:141], v14 offset:39936
  ds_read_b64_tr_b16 v[142:143], v14 offset:41216
  s_waitcnt lgkmcnt(0)
  s_waitcnt vmcnt(3)
  ds_write_b128 v2, v[232:235] offset:0
  ds_write_b128 v2, v[236:239] offset:8192
  ds_write_b128 v2, v[240:243] offset:16384
  s_waitcnt lgkmcnt(0)
  s_barrier
  ds_read_b64_tr_b16 v[144:145], v14 offset:0
  ds_read_b64_tr_b16 v[146:147], v14 offset:1280
  ds_read_b64_tr_b16 v[148:149], v14 offset:5120
  ds_read_b64_tr_b16 v[150:151], v14 offset:6400
  ds_read_b64_tr_b16 v[152:153], v14 offset:10240
  ds_read_b64_tr_b16 v[154:155], v14 offset:11520
  ds_read_b64_tr_b16 v[156:157], v14 offset:15360
  ds_read_b64_tr_b16 v[158:159], v14 offset:16640
  s_waitcnt lgkmcnt(0)
  s_waitcnt vmcnt(0)
  ds_write_b128 v2, v[244:247] offset:24576
  ds_write_b128 v2, v[248:251] offset:32768
  ds_write_b128 v2, v[252:255] offset:40960
  s_waitcnt lgkmcnt(0)
  s_barrier
  ds_read_b64_tr_b16 v[160:161], v14 offset:24576
  ds_read_b64_tr_b16 v[162:163], v14 offset:25856
  ds_read_b64_tr_b16 v[164:165], v14 offset:29696
  ds_read_b64_tr_b16 v[166:167], v14 offset:30976
  ds_read_b64_tr_b16 v[168:169], v14 offset:34816
  ds_read_b64_tr_b16 v[170:171], v14 offset:36096
  ds_read_b64_tr_b16 v[172:173], v14 offset:39936
  ds_read_b64_tr_b16 v[174:175], v14 offset:41216
  s_waitcnt lgkmcnt(0)
  s_barrier
  v_and_b32 v10, 31, v1
  v_mul_u32_u24 v10, 1296, v10
  v_lshrrev_b32 v11, 5, v1
  v_lshl_add_u32 v9, v11, 4, v10
  ds_write_b128 v3, v[204:207]
  ds_write_b128 v4, v[208:211]
  ds_write_b128 v5, v[212:215]
  ds_write_b128 v6, v[216:219]
  ds_write_b128 v7, v[220:223]
  s_waitcnt lgkmcnt(0)
  s_add_u32 s34, s47, 1
  s_mul_i32 s34, s34, 40960
  buffer_load_dwordx4 v[204:207], v2, s[20:23], s34 offen sc1
  s_add_u32 s34, s34, 8192
  buffer_load_dwordx4 v[208:211], v2, s[20:23], s34 offen sc1
  s_add_u32 s34, s34, 8192
  buffer_load_dwordx4 v[212:215], v2, s[20:23], s34 offen sc1
  s_add_u32 s34, s34, 8192
  buffer_load_dwordx4 v[216:219], v2, s[20:23], s34 offen sc1
  s_add_u32 s34, s34, 8192
  buffer_load_dwordx4 v[220:223], v2, s[20:23], s34 offen sc1
  s_add_u32 s34, s34, 8192
  v_and_b32 v12, 31, v1
  v_lshrrev_b32 v13, 5, v1
  v_mul_u32_u24 v12, 2560, v12
  v_lshl_add_u32 v12, v13, 4, v12
  s_mul_i32 s34, s43, 320
  s_lshl_b32 s35, s30, 6
  s_add_u32 s34, s34, s35
  s_add_u32 s34, s34, 1280
  v_add_u32 v8, s34, v12
  s_mov_b32 s40, 0
  s_waitcnt vmcnt(0)
  s_barrier
L_b3_loop:
  s_and_b32 s34, s40, 1
  s_mul_i32 s35, s34, 41472
  v_add_u32 v10, s35, v9
  s_xor_b32 s34, s34, 1
  s_mul_i32 s35, s34, 41472
  s_cmp_ge_u32 s40, 3
  s_cbranch_scc1 L_b3_nost
  v_add_u32 v11, s35, v3
  ds_write_b128 v11, v[204:207]
  v_add_u32 v11, s35, v4
  ds_write_b128 v11, v[208:211]
  v_add_u32 v11, s35, v5
  ds_write_b128 v11, v[212:215]
  v_add_u32 v11, s35, v6
  ds_write_b128 v11, v[216:219]
  v_add_u32 v11, s35, v7
  ds_write_b128 v11, v[220:223]
  s_waitcnt lgkmcnt(0)
  s_cmp_ge_u32 s40, 2
  s_cbranch_scc1 L_b3_nost
  s_add_u32 s34, s40, 2
  s_add_u32 s34, s34, s47
  s_mul_i32 s34, s34, 40960
  buffer_load_dwordx4 v[204:207], v2, s[20:23], s34 offen sc1
  s_add_u32 s34, s34, 8192
  buffer_load_dwordx4 v[208:211], v2, s[20:23], s34 offen sc1
  s_add_u32 s34, s34, 8192
  buffer_load_dwordx4 v[212:215], v2, s[20:23], s34 offen sc1
  s_add_u32 s34, s34, 8192
  buffer_load_dwordx4 v[216:219], v2, s[20:23], s34 offen sc1
  s_add_u32 s34, s34, 8192
  buffer_load_dwordx4 v[220:223], v2, s[20:23], s34 offen sc1
L_b3_nost:
  s_cmp_ge_u32 s30, 5
  s_cbranch_scc1 L_b3_idle
  ds_read_b128 v[192:195], v10 offset:0
  ds_read_b128 v[196:199], v10 offset:32
  ds_read_b128 v[200:203], v10 offset:64
  s_waitcnt lgkmcnt(2)
  v_mfma_f32_32x32x16_bf16 v[176:191], v[16:19], v[192:195], 0
  ds_read_b128 v[192:195], v10 offset:96
  s_waitcnt lgkmcnt(2)
  v_mfma_f32_32x32x16_bf16 v[176:191], v[20:23], v[196:199], v[176:191]
  ds_read_b128 v[196:199], v10 offset:128
  s_waitcnt lgkmcnt(2)
  v_mfma_f32_32x32x16_bf16 v[176:191], v[24:27], v[200:203], v[176:191]
  ds_read_b128 v[200:203], v10 offset:160
  s_waitcnt lgkmcnt(2)
  v_mfma_f32_32x32x16_bf16 v[176:191], v[28:31], v[192:195], v[176:191]
  ds_read_b128 v[192:195], v10 offset:192
  s_waitcnt lgkmcnt(2)
  v_mfma_f32_32x32x16_bf16 v[176:191], v[32:35], v[196:199], v[176:191]
  ds_read_b128 v[196:199], v10 offset:224
  s_waitcnt lgkmcnt(2)
  v_mfma_f32_32x32x16_bf16 v[176:191], v[36:39], v[200:203], v[176:191]
  ds_read_b128 v[200:203], v10 offset:256
  s_waitcnt lgkmcnt(2)
  v_mfma_f32_32x32x16_bf16 v[176:191], v[40:43], v[192:195], v[176:191]
  ds_read_b128 v[192:195], v10 offset:288
  s_waitcnt lgkmcnt(2)
  v_mfma_f32_32x32x16_bf16 v[176:191], v[44:47], v[196:199], v[176:191]
  ds_read_b128 v[196:199], v10 offset:320
  s_waitcnt lgkmcnt(2)
  v_mfma_f32_32x32x16_bf16 v[176:191], v[48:51], v[200:203], v[176:191]
  ds_read_b128 v[200:203], v10 offset:352
  s_waitcnt lgkmcnt(2)
  v_mfma_f32_32x32x16_bf16 v[176:191], v[52:55], v[192:195], v[176:191]
  ds_read_b128 v[192:195], v10 offset:384
  s_waitcnt lgkmcnt(2)
  v_mfma_f32_32x32x16_bf16 v[176:191], v[56:59], v[196:199], v[176:191]
  ds_read_b128 v[196:199], v10 offset:416
  s_waitcnt lgkmcnt(2)
  v_mfma_f32_32x32x16_bf16 v[176:191], v[60:63], v[200:203], v[176:191]
  ds_read_b128 v[200:203], v10 offset:448
  s_waitcnt lgkmcnt(2)
  v_mfma_f32_32x32x16_bf16 v[176:191], v[64:67], v[192:195], v[176:191]
  ds_read_b128 v[192:195], v10 offset:480
  s_waitcnt lgkmcnt(2)
  v_mfma_f32_32x32x16_bf16 v[176:191], v[68:71], v[196:199], v[176:191]
  ds_read_b128 v[196:199], v10 offset:512
  s_waitcnt lgkmcnt(2)
  v_mfma_f32_32x32x16_bf16 v[176:191], v[72:75], v[200:203], v[176:191]
  ds_read_b128 v[200:203], v10 offset:544
  s_waitcnt lgkmcnt(2)
  v_mfma_f32_32x32x16_bf16 v[176:191], v[76:79], v[192:195], v[176:191]
  ds_read_b128 v[192:195], v10 offset:576
  s_waitcnt lgkmcnt(2)
  v_mfma_f32_32x32x16_bf16 v[176:191], v[80:83], v[196:199], v[176:191]
  ds_read_b128 v[196:199], v10 offset:608
  s_waitcnt lgkmcnt(2)
  v_mfma_f32_32x32x16_bf16 v[176:191], v[84:87], v[200:203], v[176:191]
  ds_read_b128 v[200:203], v10 offset:640
  s_waitcnt lgkmcnt(2)
  v_mfma_f32_32x32x16_bf16 v[176:191], v[88:91], v[192:195], v[176:191]
  ds_read_b128 v[192:195], v10 offset:672
  s_waitcnt lgkmcnt(2)
  v_mfma_f32_32x32x16_bf16 v[176:191], v[92:95], v[196:199], v[176:191]
  ds_read_b128 v[196:199], v10 offset:704
  s_waitcnt lgkmcnt(2)
  v_mfma_f32_32x32x16_bf16 v[176:191], v[96:99], v[200:203], v[176:191]
  ds_read_b128 v[200:203], v10 offset:736
  s_waitcnt lgkmcnt(2)
  v_mfma_f32_32x32x16_bf16 v[176:191], v[100:103], v[192:195], v[176:191]
  ds_read_b128 v[192:195], v10 offset:768
  s_waitcnt lgkmcnt(2)
  v_mfma_f32_32x32x16_bf16 v[176:191], v[104:107], v[196:199], v[176:191]
  ds_read_b128 v[196:199], v10 offset:800
  s_waitcnt lgkmcnt(2)
  v_mfma_f32_32x32x16_bf16 v[176:191], v[108:111], v[200:203], v[176:191]
  ds_read_b128 v[200:203], v10 offset:832
  s_waitcnt lgkmcnt(2)
  v_mfma_f32_32x32x16_bf16 v[176:191], v[112:115], v[192:195], v[176:191]
  ds_read_b128 v[192:195], v10 offset:864
  s_waitcnt lgkmcnt(2)
  v_mfma_f32_32x32x16_bf16 v[176:191], v[116:119], v[196:199], v[176:191]
  ds_read_b128 v[196:199], v10 offset:896
  s_waitcnt lgkmcnt(2)
  v_mfma_f32_32x32x16_bf16 v[176:191], v[120:123], v[200:203], v[176:191]
  ds_read_b128 v[200:203], v10 offset:928
  s_waitcnt lgkmcnt(2)
  v_mfma_f32_32x32x16_bf16 v[176:191], v[124:127], v[192:195], v[176:191]
  ds_read_b128 v[192:195], v10 offset:960
  s_waitcnt lgkmcnt(2)
  v_mfma_f32_32x32x16_bf16 v[176:191], v[128:131], v[196:199], v[176:191]
  ds_read_b128 v[196:199], v10 offset:992
  s_waitcnt lgkmcnt(2)
  v_mfma_f32_32x32x16_bf16 v[176:191], v[132:135], v[200:203], v[176:191]
  ds_read_b128 v[200:203], v10 offset:1024
  s_waitcnt lgkmcnt(2)
  v_mfma_f32_32x32x16_bf16 v[176:191], v[136:139], v[192:195], v[176:191]
  ds_read_b128 v[192:195], v10 offset:1056
  s_waitcnt lgkmcnt(2)
  v_mfma_f32_32x32x16_bf16 v[176:191], v[140:143], v[196:199], v[176:191]
  ds_read_b128 v[196:199], v10 offset:1088
  s_waitcnt lgkmcnt(2)
  v_mfma_f32_32x32x16_bf16 v[176:191], v[144:147], v[200:203], v[176:191]
  ds_read_b128 v[200:203], v10 offset:1120
  s_waitcnt lgkmcnt(2)
  v_mfma_f32_32x32x16_bf16 v[176:191], v[148:151], v[192:195], v[176:191]
  ds_read_b128 v[192:195], v10 offset:1152
  s_waitcnt lgkmcnt(2)
  v_mfma_f32_32x32x16_bf16 v[176:191], v[152:155], v[196:199], v[176:191]
  ds_read_b128 v[196:199], v10 offset:1184
  s_waitcnt lgkmcnt(2)
  v_mfma_f32_32x32x16_bf16 v[176:191], v[156:159], v[200:203], v[176:191]
  ds_read_b128 v[200:203], v10 offset:1216
  s_waitcnt lgkmcnt(2)
  v_mfma_f32_32x32x16_bf16 v[176:191], v[160:163], v[192:195], v[176:191]
  ds_read_b128 v[192:195], v10 offset:1248
  s_waitcnt lgkmcnt(2)
  v_mfma_f32_32x32x16_bf16 v[176:191], v[164:167], v[196:199], v[176:191]
  s_waitcnt lgkmcnt(1)
  v_mfma_f32_32x32x16_bf16 v[176:191], v[168:171], v[200:203], v[176:191]
  s_waitcnt lgkmcnt(0)
  v_mfma_f32_32x32x16_bf16 v[176:191], v[172:175], v[192:195], v[176:191]
s_nop 11
  v_cvt_pk_bf16_f32 v224, v176, v177
  v_cvt_pk_bf16_f32 v225, v178, v179
  v_cvt_pk_bf16_f32 v226, v180, v181
  v_cvt_pk_bf16_f32 v227, v182, v183
  v_cvt_pk_bf16_f32 v228, v184, v185
  v_cvt_pk_bf16_f32 v229, v186, v187
  v_cvt_pk_bf16_f32 v230, v188, v189
  v_cvt_pk_bf16_f32 v231, v190, v191
  s_add_u32 s34, s40, s47
  s_mul_i32 s34, s34, 81920
  v_permlane32_swap_b32 v224, v226
  v_permlane32_swap_b32 v225, v227
  buffer_store_dwordx4 v[224:227], v8, s[24:27], s34 offen offset:0 nt
  v_permlane32_swap_b32 v228, v230
  v_permlane32_swap_b32 v229, v231
  buffer_store_dwordx4 v[228:231], v8, s[24:27], s34 offen offset:32 nt
L_b3_skip:
  s_waitcnt vmcnt(2)
  s_branch L_b3_bar
L_b3_idle:
  s_waitcnt vmcnt(0)
L_b3_bar:
  s_barrier
  s_add_u32 s40, s40, 1
  s_cmp_lt_u32 s40, 4
  s_cbranch_scc1 L_b3_loop
  s_waitcnt vmcnt(0)
  s_branch L_end
L_chain:
  s_cmp_ge_u32 s29, 12
  s_cselect_b32 s45, 1, 0
  s_mul_i32 s34, s45, 12
  s_sub_u32 s43, s29, s34
  s_mul_i32 s34, s43, 11
  s_lshr_b32 s34, s34, 5
  s_mul_i32 s35, s34, 3
  s_sub_u32 s42, s43, s35
  s_lshl_b32 s44, s28, 1
  s_add_u32 s44, s44, s45
  s_lshl_b32 s35, s44, 2
  s_add_u32 s41, s35, s34
  s_lshl_b32 s34, s42, 3
  s_add_u32 s34, s34, 16
  s_load_dwordx2 s[4:5], s[0:1], s34
  s_load_dwordx2 s[6:7], s[0:1], 40
  s_load_dwordx2 s[36:37], s[0:1], 8
  s_waitcnt lgkmcnt(0)
  s_mov_b32 s16, s4
  s_and_b32 s17, s5, 0xffff
  s_mov_b32 s18, 0x500000
  s_mov_b32 s19, 0x20000
  s_mov_b32 s20, s6
  s_and_b32 s21, s7, 0xffff
  s_mov_b32 s22, 0x500000
  s_mov_b32 s23, 0x20000
  s_mov_b32 s24, s36
  s_and_b32 s25, s37, 0xffff
  s_mov_b32 s26, 0x2800
  s_mov_b32 s27, 0x20000
  v_lshlrev_b32 v2, 4, v1
  s_mov_b32 s72, 0x00ff00ff
  s_mov_b32 s73, 0x00ff00ff
  s_mov_b32 s74, 0x55555555
  s_mov_b32 s75, 0x55555555
  s_mov_b32 s76, 0xaaaaaaaa
  s_mov_b32 s77, 0xaaaaaaaa
  s_mov_b32 s78, 0x3e0293ee
  s_mov_b32 s79, 0xbe0293ee
  s_mov_b32 s66, s78
  s_mov_b32 s67, s78
  v_and_b32 v10, 8, v1
  v_cmp_eq_u32 vcc, 0, v10
  v_mov_b32 v10, 0xeeee
  v_mov_b32 v11, 0x4444
  v_cndmask_b32 v15, v10, v11, vcc
  v_mov_b32 v10, 90112
  v_mov_b32 v11, 0
  ds_write_b32 v10, v11
  s_cmp_ge_u32 s30, 4
  s_cbranch_scc1 L_ch_ldw
  v_add_u32 v10, 0, v0
  v_lshrrev_b32 v11, 6, v10
  v_bfe_u32 v12, v10, 4, 2
  v_and_b32 v13, 7, v10
  v_bfe_u32 v14, v10, 3, 1
  v_mul_u32_u24 v13, 1280, v13
  v_lshl_add_u32 v13, v11, 7, v13
  v_lshl_add_u32 v13, v12, 5, v13
  v_lshl_add_u32 v13, v14, 2, v13
  buffer_load_dword v144, v13, s[24:27], 0 offen
  buffer_load_dword v145, v13, s[24:27], 0 offen offset:8
  buffer_load_dword v146, v13, s[24:27], 0 offen offset:16
  buffer_load_dword v147, v13, s[24:27], 0 offen offset:24
  v_add_u32 v10, 256, v0
  v_lshrrev_b32 v11, 6, v10
  v_bfe_u32 v12, v10, 4, 2
  v_and_b32 v13, 7, v10
  v_bfe_u32 v14, v10, 3, 1
  v_mul_u32_u24 v13, 1280, v13
  v_lshl_add_u32 v13, v11, 7, v13
  v_lshl_add_u32 v13, v12, 5, v13
  v_lshl_add_u32 v13, v14, 2, v13
  buffer_load_dword v148, v13, s[24:27], 0 offen
  buffer_load_dword v149, v13, s[24:27], 0 offen offset:8
  buffer_load_dword v150, v13, s[24:27], 0 offen offset:16
  buffer_load_dword v151, v13, s[24:27], 0 offen offset:24
  v_add_u32 v10, 512, v0
  v_lshrrev_b32 v11, 6, v10
  v_bfe_u32 v12, v10, 4, 2
  v_and_b32 v13, 7, v10
  v_bfe_u32 v14, v10, 3, 1
  v_mul_u32_u24 v13, 1280, v13
  v_lshl_add_u32 v13, v11, 7, v13
  v_lshl_add_u32 v13, v12, 5, v13
  v_lshl_add_u32 v13, v14, 2, v13
  buffer_load_dword v152, v13, s[24:27], 0 offen
  buffer_load_dword v153, v13, s[24:27], 0 offen offset:8
  buffer_load_dword v154, v13, s[24:27], 0 offen offset:16
  buffer_load_dword v155, v13, s[24:27], 0 offen offset:24
L_ch_ldw:
  v_lshrrev_b32 v10, 4, v0
  v_and_b32 v11, 15, v0
  v_lshlrev_b32 v12, 13, v10
  v_lshl_add_u32 v12, v11, 4, v12
  s_lshl_b32 s34, s41, 8
  v_add_u32 v12, s34, v12
  s_mov_b32 s34, 0
  buffer_load_dwordx4 v[176:179], v12, s[16:19], s34 offen
  s_mov_b32 s34, 262144
  buffer_load_dwordx4 v[180:183], v12, s[16:19], s34 offen
  s_mov_b32 s34, 524288
  buffer_load_dwordx4 v[184:187], v12, s[16:19], s34 offen
  s_mov_b32 s34, 786432
  buffer_load_dwordx4 v[188:191], v12, s[16:19], s34 offen
  s_mov_b32 s34, 1048576
  buffer_load_dwordx4 v[192:195], v12, s[16:19], s34 offen
  s_mov_b32 s34, 1310720
  buffer_load_dwordx4 v[196:199], v12, s[16:19], s34 offen
  s_mov_b32 s34, 1572864
  buffer_load_dwordx4 v[200:203], v12, s[16:19], s34 offen
  s_mov_b32 s34, 1835008
  buffer_load_dwordx4 v[204:207], v12, s[16:19], s34 offen
  s_mov_b32 s34, 2097152
  buffer_load_dwordx4 v[208:211], v12, s[16:19], s34 offen
  s_mov_b32 s34, 2359296
  buffer_load_dwordx4 v[212:215], v12, s[16:19], s34 offen
  s_mov_b32 s34, 2621440
  buffer_load_dwordx4 v[216:219], v12, s[16:19], s34 offen
  s_mov_b32 s34, 2883584
  buffer_load_dwordx4 v[220:223], v12, s[16:19], s34 offen
  s_mov_b32 s34, 3145728
  buffer_load_dwordx4 v[224:227], v12, s[16:19], s34 offen
  s_mov_b32 s34, 3407872
  buffer_load_dwordx4 v[228:231], v12, s[16:19], s34 offen
  s_mov_b32 s34, 3670016
  buffer_load_dwordx4 v[232:235], v12, s[16:19], s34 offen
  s_mov_b32 s34, 3932160
  buffer_load_dwordx4 v[236:239], v12, s[16:19], s34 offen
  s_mov_b32 s34, 4194304
  buffer_load_dwordx4 v[240:243], v12, s[16:19], s34 offen
  s_mov_b32 s34, 4456448
  buffer_load_dwordx4 v[244:247], v12, s[16:19], s34 offen
  s_mov_b32 s34, 4718592
  buffer_load_dwordx4 v[248:251], v12, s[16:19], s34 offen
  s_mov_b32 s34, 4980736
  buffer_load_dwordx4 v[252:255], v12, s[16:19], s34 offen
  s_mov_b32 s63, 0
  s_cmp_ge_u32 s30, 4
  s_cbranch_scc1 L_ch_nowo_ld
  s_cmp_ge_u32 s43, 10
  s_cbranch_scc1 L_ch_nowo_ld
  v_lshrrev_b32 v4, 3, v1
  v_and_b32 v5, 7, v1
  v_mul_u32_u24 v6, 1280, v4
  v_lshl_add_u32 v6, v5, 4, v6
  s_lshl_b32 s34, s44, 2
  s_add_u32 s34, s34, s30
  s_mul_i32 s34, s34, 163840
  s_lshl_b32 s35, s43, 7
  s_add_u32 s34, s34, s35
  v_add_u32 v6, s34, v6
  s_mov_b32 s63, 1
  s_mov_b32 s34, 0
  buffer_load_dwordx4 v[80:83], v6, s[20:23], s34 offen
  s_mov_b32 s34, 10240
  buffer_load_dwordx4 v[84:87], v6, s[20:23], s34 offen
  s_mov_b32 s34, 20480
  buffer_load_dwordx4 v[88:91], v6, s[20:23], s34 offen
  s_mov_b32 s34, 30720
  buffer_load_dwordx4 v[92:95], v6, s[20:23], s34 offen
  s_mov_b32 s34, 40960
  buffer_load_dwordx4 v[96:99], v6, s[20:23], s34 offen
  s_mov_b32 s34, 51200
  buffer_load_dwordx4 v[100:103], v6, s[20:23], s34 offen
  s_mov_b32 s34, 61440
  buffer_load_dwordx4 v[104:107], v6, s[20:23], s34 offen
  s_mov_b32 s34, 71680
  buffer_load_dwordx4 v[108:111], v6, s[20:23], s34 offen
  s_mov_b32 s34, 81920
  buffer_load_dwordx4 v[112:115], v6, s[20:23], s34 offen
  s_mov_b32 s34, 92160
  buffer_load_dwordx4 v[116:119], v6, s[20:23], s34 offen
  s_mov_b32 s34, 102400
  buffer_load_dwordx4 v[120:123], v6, s[20:23], s34 offen
  s_mov_b32 s34, 112640
  buffer_load_dwordx4 v[124:127], v6, s[20:23], s34 offen
  s_mov_b32 s34, 122880
  buffer_load_dwordx4 v[128:131], v6, s[20:23], s34 offen
  s_mov_b32 s34, 133120
  buffer_load_dwordx4 v[132:135], v6, s[20:23], s34 offen
  s_mov_b32 s34, 143360
  buffer_load_dwordx4 v[136:139], v6, s[20:23], s34 offen
  s_mov_b32 s34, 153600
  buffer_load_dwordx4 v[140:143], v6, s[20:23], s34 offen
L_ch_nowo_ld:
  v_and_b32 v13, 3, v10
  v_lshlrev_b32 v13, 1, v13
  v_bfe_u32 v14, v10, 3, 1
  v_add_u32 v13, v13, v14
  v_lshrrev_b32 v14, 1, v11
  v_add_u32 v13, v13, v14
  v_and_b32 v13, 7, v13
  v_lshlrev_b32 v13, 5, v13
  v_and_b32 v14, 1, v11
  v_lshl_add_u32 v13, v14, 4, v13
  v_lshl_add_u32 v13, v10, 8, v13
  v_lshrrev_b32 v10, 4, v1
  v_bfe_u32 v11, v1, 2, 2
  v_lshl_add_u32 v14, v10, 3, v11
  v_lshlrev_b32 v14, 8, v14
  v_and_b32 v8, 3, v1
  v_lshl_add_u32 v14, v8, 3, v14
  v_and_b32 v10, 1, v10
  v_lshl_add_u32 v10, v11, 1, v10
  s_and_b32 s34, s30, 3
  s_lshl_b32 s34, s34, 1
  v_add_u32 v10, s34, v10
  v_add_u32 v11, 1, v10
  v_and_b32 v10, 7, v10
  v_and_b32 v11, 7, v11
  v_lshl_add_u32 v8, v11, 5, v14
  v_lshl_add_u32 v14, v10, 5, v14
  v_lshrrev_b32 v10, 3, v1
  v_and_b32 v11, 7, v1
  v_lshrrev_b32 v4, 1, v11
  v_lshrrev_b32 v5, 1, v10
  v_add_u32 v4, v4, v5
  v_and_b32 v4, 3, v4
  v_lshlrev_b32 v4, 5, v4
  v_and_b32 v5, 1, v11
  v_lshl_add_u32 v4, v5, 4, v4
  v_lshl_add_u32 v4, v10, 7, v4
  s_lshl_b32 s34, s30, 14
  s_add_u32 s34, s34, 98304
  v_add_u32 v4, s34, v4
  v_lshrrev_b32 v10, 4, v1
  v_bfe_u32 v11, v1, 2, 2
  v_lshl_add_u32 v6, v10, 2, v11
  v_lshlrev_b32 v5, 7, v6
  v_add_u32 v5, s34, v5
  v_and_b32 v10, 3, v1
  v_lshl_add_u32 v5, v10, 3, v5
  v_lshrrev_b32 v6, 1, v6
  s_cmp_eq_u32 s63, 0
  s_cbranch_scc1 wv_234
  s_waitcnt vmcnt(32)
  s_branch wv_235
wv_234:
  s_waitcnt vmcnt(16)
wv_235:
  ds_write_b128 v13, v[176:179] offset:0
  ds_write_b128 v13, v[180:183] offset:8192
  ds_write_b128 v13, v[184:187] offset:16384
  ds_write_b128 v13, v[188:191] offset:24576
  s_waitcnt lgkmcnt(0)
  s_barrier
  s_cmp_lt_u32 s30, 4
  s_cbranch_scc1 w1a_236
  ds_read_b64_tr_b16 v[16:17], v14 offset:0
  ds_read_b64_tr_b16 v[18:19], v14 offset:1024
  ds_read_b64_tr_b16 v[20:21], v14 offset:8192
  ds_read_b64_tr_b16 v[22:23], v14 offset:9216
  ds_read_b64_tr_b16 v[24:25], v14 offset:16384
  ds_read_b64_tr_b16 v[26:27], v14 offset:17408
  ds_read_b64_tr_b16 v[28:29], v14 offset:24576
  ds_read_b64_tr_b16 v[30:31], v14 offset:25600
  s_waitcnt lgkmcnt(0)
  ds_read_b64_tr_b16 v[96:97], v8 offset:0
  ds_read_b64_tr_b16 v[98:99], v8 offset:1024
  ds_read_b64_tr_b16 v[100:101], v8 offset:8192
  ds_read_b64_tr_b16 v[102:103], v8 offset:9216
  ds_read_b64_tr_b16 v[104:105], v8 offset:16384
  ds_read_b64_tr_b16 v[106:107], v8 offset:17408
  ds_read_b64_tr_b16 v[108:109], v8 offset:24576
  ds_read_b64_tr_b16 v[110:111], v8 offset:25600
  s_waitcnt lgkmcnt(0)
  s_branch w1s_237
w1a_236:
  v_add_u32 v10, 0, v0
  v_lshlrev_b32 v10, 4, v10
  v_add_u32 v10, 65536, v10
  ds_write_b128 v10, v[144:147]
  v_add_u32 v10, 256, v0
  v_lshlrev_b32 v10, 4, v10
  v_add_u32 v10, 65536, v10
  ds_write_b128 v10, v[148:151]
  v_add_u32 v10, 512, v0
  v_lshlrev_b32 v10, 4, v10
  v_add_u32 v10, 65536, v10
  ds_write_b128 v10, v[152:155]
  s_waitcnt lgkmcnt(0)
w1s_237:
  s_cmp_eq_u32 s63, 0
  s_cbranch_scc1 wv_238
  s_waitcnt vmcnt(28)
  s_branch wv_239
wv_238:
  s_waitcnt vmcnt(12)
wv_239:
  ds_write_b128 v13, v[192:195] offset:32768
  ds_write_b128 v13, v[196:199] offset:40960
  ds_write_b128 v13, v[200:203] offset:49152
  ds_write_b128 v13, v[204:207] offset:57344
  s_waitcnt lgkmcnt(0)
  s_barrier
  s_cmp_lt_u32 s30, 4
  s_cbranch_scc1 w1a_240
  ds_read_b64_tr_b16 v[32:33], v14 offset:32768
  ds_read_b64_tr_b16 v[34:35], v14 offset:33792
  ds_read_b64_tr_b16 v[36:37], v14 offset:40960
  ds_read_b64_tr_b16 v[38:39], v14 offset:41984
  ds_read_b64_tr_b16 v[40:41], v14 offset:49152
  ds_read_b64_tr_b16 v[42:43], v14 offset:50176
  ds_read_b64_tr_b16 v[44:45], v14 offset:57344
  ds_read_b64_tr_b16 v[46:47], v14 offset:58368
  s_waitcnt lgkmcnt(0)
  ds_read_b64_tr_b16 v[112:113], v8 offset:32768
  ds_read_b64_tr_b16 v[114:115], v8 offset:33792
  ds_read_b64_tr_b16 v[116:117], v8 offset:40960
  ds_read_b64_tr_b16 v[118:119], v8 offset:41984
  ds_read_b64_tr_b16 v[120:121], v8 offset:49152
  ds_read_b64_tr_b16 v[122:123], v8 offset:50176
  ds_read_b64_tr_b16 v[124:125], v8 offset:57344
  ds_read_b64_tr_b16 v[126:127], v8 offset:58368
  s_waitcnt lgkmcnt(0)
  s_branch w1s_241
w1a_240:
w1s_241:
  s_cmp_eq_u32 s63, 0
  s_cbranch_scc1 wv_242
  s_waitcnt vmcnt(24)
  s_branch wv_243
wv_242:
  s_waitcnt vmcnt(8)
wv_243:
  ds_write_b128 v13, v[208:211] offset:0
  ds_write_b128 v13, v[212:215] offset:8192
  ds_write_b128 v13, v[216:219] offset:16384
  ds_write_b128 v13, v[220:223] offset:24576
  s_waitcnt lgkmcnt(0)
  s_barrier
  s_cmp_lt_u32 s30, 4
  s_cbranch_scc1 w1a_244
  ds_read_b64_tr_b16 v[48:49], v14 offset:0
  ds_read_b64_tr_b16 v[50:51], v14 offset:1024
  ds_read_b64_tr_b16 v[52:53], v14 offset:8192
  ds_read_b64_tr_b16 v[54:55], v14 offset:9216
  ds_read_b64_tr_b16 v[56:57], v14 offset:16384
  ds_read_b64_tr_b16 v[58:59], v14 offset:17408
  ds_read_b64_tr_b16 v[60:61], v14 offset:24576
  ds_read_b64_tr_b16 v[62:63], v14 offset:25600
  s_waitcnt lgkmcnt(0)
  ds_read_b64_tr_b16 v[128:129], v8 offset:0
  ds_read_b64_tr_b16 v[130:131], v8 offset:1024
  ds_read_b64_tr_b16 v[132:133], v8 offset:8192
  ds_read_b64_tr_b16 v[134:135], v8 offset:9216
  ds_read_b64_tr_b16 v[136:137], v8 offset:16384
  ds_read_b64_tr_b16 v[138:139], v8 offset:17408
  ds_read_b64_tr_b16 v[140:141], v8 offset:24576
  ds_read_b64_tr_b16 v[142:143], v8 offset:25600
  s_waitcnt lgkmcnt(0)
  s_branch w1s_245
w1a_244:
w1s_245:
  s_cmp_eq_u32 s63, 0
  s_cbranch_scc1 wv_246
  s_waitcnt vmcnt(20)
  s_branch wv_247
wv_246:
  s_waitcnt vmcnt(4)
wv_247:
  ds_write_b128 v13, v[224:227] offset:32768
  ds_write_b128 v13, v[228:231] offset:40960
  ds_write_b128 v13, v[232:235] offset:49152
  ds_write_b128 v13, v[236:239] offset:57344
  s_waitcnt lgkmcnt(0)
  s_barrier
  s_cmp_lt_u32 s30, 4
  s_cbranch_scc1 w1a_248
  ds_read_b64_tr_b16 v[64:65], v14 offset:32768
  ds_read_b64_tr_b16 v[66:67], v14 offset:33792
  ds_read_b64_tr_b16 v[68:69], v14 offset:40960
  ds_read_b64_tr_b16 v[70:71], v14 offset:41984
  ds_read_b64_tr_b16 v[72:73], v14 offset:49152
  ds_read_b64_tr_b16 v[74:75], v14 offset:50176
  ds_read_b64_tr_b16 v[76:77], v14 offset:57344
  ds_read_b64_tr_b16 v[78:79], v14 offset:58368
  s_waitcnt lgkmcnt(0)
  ds_read_b64_tr_b16 v[144:145], v8 offset:32768
  ds_read_b64_tr_b16 v[146:147], v8 offset:33792
  ds_read_b64_tr_b16 v[148:149], v8 offset:40960
  ds_read_b64_tr_b16 v[150:151], v8 offset:41984
  ds_read_b64_tr_b16 v[152:153], v8 offset:49152
  ds_read_b64_tr_b16 v[154:155], v8 offset:50176
  ds_read_b64_tr_b16 v[156:157], v8 offset:57344
  ds_read_b64_tr_b16 v[158:159], v8 offset:58368
  s_waitcnt lgkmcnt(0)
  s_branch w1s_249
w1a_248:
w1s_249:
  s_cmp_eq_u32 s63, 0
  s_cbranch_scc1 wv_250
  s_waitcnt vmcnt(16)
  s_branch wv_251
wv_250:
  s_waitcnt vmcnt(0)
wv_251:
  ds_write_b128 v13, v[240:243] offset:0
  ds_write_b128 v13, v[244:247] offset:8192
  ds_write_b128 v13, v[248:251] offset:16384
  ds_write_b128 v13, v[252:255] offset:24576
  s_waitcnt lgkmcnt(0)
  s_barrier
  s_cmp_lt_u32 s30, 4
  s_cbranch_scc1 w1a_252
  ds_read_b64_tr_b16 v[80:81], v14 offset:0
  ds_read_b64_tr_b16 v[82:83], v14 offset:1024
  ds_read_b64_tr_b16 v[84:85], v14 offset:8192
  ds_read_b64_tr_b16 v[86:87], v14 offset:9216
  ds_read_b64_tr_b16 v[88:89], v14 offset:16384
  ds_read_b64_tr_b16 v[90:91], v14 offset:17408
  ds_read_b64_tr_b16 v[92:93], v14 offset:24576
  ds_read_b64_tr_b16 v[94:95], v14 offset:25600
  s_waitcnt lgkmcnt(0)
  ds_read_b64_tr_b16 v[160:161], v8 offset:0
  ds_read_b64_tr_b16 v[162:163], v8 offset:1024
  ds_read_b64_tr_b16 v[164:165], v8 offset:8192
  ds_read_b64_tr_b16 v[166:167], v8 offset:9216
  ds_read_b64_tr_b16 v[168:169], v8 offset:16384
  ds_read_b64_tr_b16 v[170:171], v8 offset:17408
  ds_read_b64_tr_b16 v[172:173], v8 offset:24576
  ds_read_b64_tr_b16 v[174:175], v8 offset:25600
  s_waitcnt lgkmcnt(0)
  s_branch w1s_253
w1a_252:
w1s_253:
  s_barrier
  s_cmp_lg_u32 s31, 0
  s_cbranch_scc1 valok_256
  v_lshlrev_b32 v10, 2, v1
  s_mov_b32 s39, 0
val_254:
  buffer_load_dword v11, v10, s[12:15], 0 offen sc1
  s_waitcnt vmcnt(0)
  v_cmp_eq_u32 vcc, 32, v11
s_nop 3
  s_and_b32 s34, vcc_lo, vcc_hi
  s_and_b32 s34, s34, 0x5555
  s_cmp_eq_u32 s34, 0x5555
  s_cbranch_scc0 valg_255_s
  v_readlane_b32 s32, v11, 1
  s_mov_b32 s34, 0
  s_cmp_eq_u32 s34, 0
  s_cbranch_scc1 valg_255
valg_255_s:
  s_mov_b32 s36, 0
  s_mov_b32 s37, 0
  s_mov_b32 s38, 0
  s_mov_b32 s34, 0
  v_readlane_b32 s35, v11, 2
s_nop 3
  s_add_u32 s38, s38, s35
  v_readlane_b32 s35, v11, 0
s_nop 3
  s_add_u32 s36, s36, s35
  s_cmp_eq_u32 s35, 32
  s_cselect_b32 s97, 0, 1
  s_or_b32 s34, s34, s97
  s_cmp_gt_u32 s98, 0
  s_cselect_b32 s35, s35, 0
  s_add_u32 s37, s37, s35
  v_readlane_b32 s35, v11, 6
s_nop 3
  s_add_u32 s38, s38, s35
  v_readlane_b32 s35, v11, 4
s_nop 3
  s_add_u32 s36, s36, s35
  s_cmp_eq_u32 s35, 32
  s_cselect_b32 s97, 0, 1
  s_or_b32 s34, s34, s97
  s_cmp_gt_u32 s98, 1
  s_cselect_b32 s35, s35, 0
  s_add_u32 s37, s37, s35
  v_readlane_b32 s35, v11, 10
s_nop 3
  s_add_u32 s38, s38, s35
  v_readlane_b32 s35, v11, 8
s_nop 3
  s_add_u32 s36, s36, s35
  s_cmp_eq_u32 s35, 32
  s_cselect_b32 s97, 0, 1
  s_or_b32 s34, s34, s97
  s_cmp_gt_u32 s98, 2
  s_cselect_b32 s35, s35, 0
  s_add_u32 s37, s37, s35
  v_readlane_b32 s35, v11, 14
s_nop 3
  s_add_u32 s38, s38, s35
  v_readlane_b32 s35, v11, 12
s_nop 3
  s_add_u32 s36, s36, s35
  s_cmp_eq_u32 s35, 32
  s_cselect_b32 s97, 0, 1
  s_or_b32 s34, s34, s97
  s_cmp_gt_u32 s98, 3
  s_cselect_b32 s35, s35, 0
  s_add_u32 s37, s37, s35
  v_readlane_b32 s35, v11, 34
s_nop 3
  s_add_u32 s38, s38, s35
  v_readlane_b32 s35, v11, 32
s_nop 3
  s_add_u32 s36, s36, s35
  s_cmp_eq_u32 s35, 32
  s_cselect_b32 s97, 0, 1
  s_or_b32 s34, s34, s97
  s_cmp_gt_u32 s98, 4
  s_cselect_b32 s35, s35, 0
  s_add_u32 s37, s37, s35
  v_readlane_b32 s35, v11, 38
s_nop 3
  s_add_u32 s38, s38, s35
  v_readlane_b32 s35, v11, 36
s_nop 3
  s_add_u32 s36, s36, s35
  s_cmp_eq_u32 s35, 32
  s_cselect_b32 s97, 0, 1
  s_or_b32 s34, s34, s97
  s_cmp_gt_u32 s98, 5
  s_cselect_b32 s35, s35, 0
  s_add_u32 s37, s37, s35
  v_readlane_b32 s35, v11, 42
s_nop 3
  s_add_u32 s38, s38, s35
  v_readlane_b32 s35, v11, 40
s_nop 3
  s_add_u32 s36, s36, s35
  s_cmp_eq_u32 s35, 32
  s_cselect_b32 s97, 0, 1
  s_or_b32 s34, s34, s97
  s_cmp_gt_u32 s98, 6
  s_cselect_b32 s35, s35, 0
  s_add_u32 s37, s37, s35
  v_readlane_b32 s35, v11, 46
s_nop 3
  s_add_u32 s38, s38, s35
  v_readlane_b32 s35, v11, 44
s_nop 3
  s_add_u32 s36, s36, s35
  s_cmp_eq_u32 s35, 32
  s_cselect_b32 s97, 0, 1
  s_or_b32 s34, s34, s97
  s_cmp_gt_u32 s98, 7
  s_cselect_b32 s35, s35, 0
  s_add_u32 s37, s37, s35
  v_readlane_b32 s35, v11, 18
s_nop 3
  s_add_u32 s38, s38, s35
  v_readlane_b32 s35, v11, 16
s_nop 3
  s_add_u32 s36, s36, s35
  s_cmp_eq_u32 s35, 0
  s_cselect_b32 s97, 0, 1
  s_or_b32 s34, s34, s97
  s_cmp_gt_u32 s98, 8
  s_cselect_b32 s35, s35, 0
  s_add_u32 s37, s37, s35
  v_readlane_b32 s35, v11, 22
s_nop 3
  s_add_u32 s38, s38, s35
  v_readlane_b32 s35, v11, 20
s_nop 3
  s_add_u32 s36, s36, s35
  s_cmp_eq_u32 s35, 0
  s_cselect_b32 s97, 0, 1
  s_or_b32 s34, s34, s97
  s_cmp_gt_u32 s98, 9
  s_cselect_b32 s35, s35, 0
  s_add_u32 s37, s37, s35
  v_readlane_b32 s35, v11, 26
s_nop 3
  s_add_u32 s38, s38, s35
  v_readlane_b32 s35, v11, 24
s_nop 3
  s_add_u32 s36, s36, s35
  s_cmp_eq_u32 s35, 0
  s_cselect_b32 s97, 0, 1
  s_or_b32 s34, s34, s97
  s_cmp_gt_u32 s98, 10
  s_cselect_b32 s35, s35, 0
  s_add_u32 s37, s37, s35
  v_readlane_b32 s35, v11, 30
s_nop 3
  s_add_u32 s38, s38, s35
  v_readlane_b32 s35, v11, 28
s_nop 3
  s_add_u32 s36, s36, s35
  s_cmp_eq_u32 s35, 0
  s_cselect_b32 s97, 0, 1
  s_or_b32 s34, s34, s97
  s_cmp_gt_u32 s98, 11
  s_cselect_b32 s35, s35, 0
  s_add_u32 s37, s37, s35
  v_readlane_b32 s35, v11, 50
s_nop 3
  s_add_u32 s38, s38, s35
  v_readlane_b32 s35, v11, 48
s_nop 3
  s_add_u32 s36, s36, s35
  s_cmp_eq_u32 s35, 0
  s_cselect_b32 s97, 0, 1
  s_or_b32 s34, s34, s97
  s_cmp_gt_u32 s98, 12
  s_cselect_b32 s35, s35, 0
  s_add_u32 s37, s37, s35
  v_readlane_b32 s35, v11, 54
s_nop 3
  s_add_u32 s38, s38, s35
  v_readlane_b32 s35, v11, 52
s_nop 3
  s_add_u32 s36, s36, s35
  s_cmp_eq_u32 s35, 0
  s_cselect_b32 s97, 0, 1
  s_or_b32 s34, s34, s97
  s_cmp_gt_u32 s98, 13
  s_cselect_b32 s35, s35, 0
  s_add_u32 s37, s37, s35
  v_readlane_b32 s35, v11, 58
s_nop 3
  s_add_u32 s38, s38, s35
  v_readlane_b32 s35, v11, 56
s_nop 3
  s_add_u32 s36, s36, s35
  s_cmp_eq_u32 s35, 0
  s_cselect_b32 s97, 0, 1
  s_or_b32 s34, s34, s97
  s_cmp_gt_u32 s98, 14
  s_cselect_b32 s35, s35, 0
  s_add_u32 s37, s37, s35
  v_readlane_b32 s35, v11, 62
s_nop 3
  s_add_u32 s38, s38, s35
  v_readlane_b32 s35, v11, 60
s_nop 3
  s_add_u32 s36, s36, s35
  s_cmp_eq_u32 s35, 0
  s_cselect_b32 s97, 0, 1
  s_or_b32 s34, s34, s97
  s_cmp_gt_u32 s98, 15
  s_cselect_b32 s35, s35, 0
  s_add_u32 s37, s37, s35
  v_readlane_b32 s32, v11, 1
  s_cmp_eq_u32 s36, 256
  s_cselect_b32 s35, s38, 0
  s_cmp_eq_u32 s35, 256
  s_cbranch_scc1 valg_255
  s_sleep 2
  s_add_u32 s39, s39, 1
  s_cmp_lt_u32 s39, s33
  s_cbranch_scc1 val_254
  s_mov_b32 s33, 0
valg_255:
s_nop 0
  s_and_b32 s32, s32, 2
  s_lshl_b32 s32, s32, 12
  s_cmp_eq_u32 s34, 0
  s_cbranch_scc1 valok_256
  s_mov_b32 s31, 1
  s_mov_b32 s32, 0
  s_add_u32 s37, s37, s99
  s_and_b32 s37, s37, 255
  s_lshr_b32 s28, s37, 5
  s_and_b32 s29, s37, 31
  s_barrier
  s_branch L_dispatch
valok_256:
  s_cmp_lg_u32 s31, 0
  s_cbranch_scc1 pwd_258
  s_mov_b32 s39, 0
  v_mov_b32 v13, 4
pw_257:
  buffer_load_dword v12, v13, s[12:15], 0 offen sc1
  s_waitcnt vmcnt(0)
  v_readfirstlane_b32 s32, v12
s_nop 3
  s_cmp_lg_u32 s32, 0
  s_cbranch_scc1 pw_257_g
  s_sleep 2
  s_add_u32 s39, s39, 1
  s_cmp_lt_u32 s39, s33
  s_cbranch_scc1 pw_257
  s_mov_b32 s33, 0
pw_257_g:
  s_and_b32 s32, s32, 2
  s_lshl_b32 s32, s32, 12
pwd_258:
  s_xor_b32 s100, s32, 8192
  s_add_u32 s101, s100, 3817472
  s_add_u32 s100, s100, 3801088
  s_cmp_ge_u32 s30, 4
  s_cbranch_scc1 wo_259
  s_cmp_ge_u32 s43, 10
  s_cbranch_scc1 wo_259
  s_waitcnt vmcnt(0)
  ds_write_b128 v4, v[80:83] offset:0
  ds_write_b128 v4, v[84:87] offset:1024
  ds_write_b128 v4, v[88:91] offset:2048
  ds_write_b128 v4, v[92:95] offset:3072
  ds_write_b128 v4, v[96:99] offset:4096
  ds_write_b128 v4, v[100:103] offset:5120
  ds_write_b128 v4, v[104:107] offset:6144
  ds_write_b128 v4, v[108:111] offset:7168
  ds_write_b128 v4, v[112:115] offset:8192
  ds_write_b128 v4, v[116:119] offset:9216
  ds_write_b128 v4, v[120:123] offset:10240
  ds_write_b128 v4, v[124:127] offset:11264
  ds_write_b128 v4, v[128:131] offset:12288
  ds_write_b128 v4, v[132:135] offset:13312
  ds_write_b128 v4, v[136:139] offset:14336
  ds_write_b128 v4, v[140:143] offset:15360
  s_waitcnt lgkmcnt(0)
  v_add_u32 v10, 0, v6
  v_and_b32 v10, 3, v10
  v_lshl_add_u32 v10, v10, 5, v5
  ds_read_b64_tr_b16 v[16:17], v10 offset:0
  ds_read_b64_tr_b16 v[18:19], v10 offset:2048
  ds_read_b64_tr_b16 v[20:21], v10 offset:4096
  ds_read_b64_tr_b16 v[22:23], v10 offset:6144
  ds_read_b64_tr_b16 v[24:25], v10 offset:8192
  ds_read_b64_tr_b16 v[26:27], v10 offset:10240
  ds_read_b64_tr_b16 v[28:29], v10 offset:12288
  ds_read_b64_tr_b16 v[30:31], v10 offset:14336
  s_waitcnt lgkmcnt(0)
  v_add_u32 v10, 1, v6
  v_and_b32 v10, 3, v10
  v_lshl_add_u32 v10, v10, 5, v5
  ds_read_b64_tr_b16 v[32:33], v10 offset:0
  ds_read_b64_tr_b16 v[34:35], v10 offset:2048
  ds_read_b64_tr_b16 v[36:37], v10 offset:4096
  ds_read_b64_tr_b16 v[38:39], v10 offset:6144
  ds_read_b64_tr_b16 v[40:41], v10 offset:8192
  ds_read_b64_tr_b16 v[42:43], v10 offset:10240
  ds_read_b64_tr_b16 v[44:45], v10 offset:12288
  ds_read_b64_tr_b16 v[46:47], v10 offset:14336
  s_waitcnt lgkmcnt(0)
  v_add_u32 v10, 2, v6
  v_and_b32 v10, 3, v10
  v_lshl_add_u32 v10, v10, 5, v5
  ds_read_b64_tr_b16 v[48:49], v10 offset:0
  ds_read_b64_tr_b16 v[50:51], v10 offset:2048
  ds_read_b64_tr_b16 v[52:53], v10 offset:4096
  ds_read_b64_tr_b16 v[54:55], v10 offset:6144
  ds_read_b64_tr_b16 v[56:57], v10 offset:8192
  ds_read_b64_tr_b16 v[58:59], v10 offset:10240
  ds_read_b64_tr_b16 v[60:61], v10 offset:12288
  ds_read_b64_tr_b16 v[62:63], v10 offset:14336
  s_waitcnt lgkmcnt(0)
  v_add_u32 v10, 3, v6
  v_and_b32 v10, 3, v10
  v_lshl_add_u32 v10, v10, 5, v5
  ds_read_b64_tr_b16 v[64:65], v10 offset:0
  ds_read_b64_tr_b16 v[66:67], v10 offset:2048
  ds_read_b64_tr_b16 v[68:69], v10 offset:4096
  ds_read_b64_tr_b16 v[70:71], v10 offset:6144
  ds_read_b64_tr_b16 v[72:73], v10 offset:8192
  ds_read_b64_tr_b16 v[74:75], v10 offset:10240
  ds_read_b64_tr_b16 v[76:77], v10 offset:12288
  ds_read_b64_tr_b16 v[78:79], v10 offset:14336
  s_waitcnt lgkmcnt(0)
wo_259:
  s_mov_b32 s68, 0
  s_mov_b32 s69, 0
  s_mov_b32 s65, 0
  s_mov_b32 s63, 0
  s_mov_b32 s40, 0
  s_mov_b32 s58, 0
  s_cmp_ge_u32 s30, 4
  s_cbranch_scc1 L_ch_pS
  s_lshl_b32 s34, s44, 2
  s_add_u32 s34, s34, s30
  s_mul_i32 s35, s34, 6144
  v_add_u32 v3, s35, v2
  s_lshl_b32 s35, s34, 13
  v_add_u32 v4, s35, v2
  s_lshl_b32 s35, s30, 11
  s_add_u32 s35, s35, 75776
  v_add_u32 v5, s35, v2
  s_lshl_b32 s35, s30, 14
  s_add_u32 s35, s35, 0
  s_lshr_b32 s34, s34, 1
  v_and_b32 v10, 1, v1
  v_lshlrev_b32 v10, 4, v10
  v_add_u32 v10, s34, v10
  v_add_u32 v10, 16, v10
  v_lshlrev_b32 v9, 7, v10
  v_add_u32 v9, 32768, v9
  v_add_u32 v9, s100, v9
  v_cmp_gt_u32 vcc, 32, v1
  v_mov_b32 v10, 0
  v_mov_b32 v11, 0xf149f2ca
  v_cndmask_b32 v240, v10, v11, vcc
  v_mov_b32 v241, v240
  v_mov_b32 v242, v240
  v_mov_b32 v243, v240
  v_add_u32 v14, s35, v2
  s_branch L_ch_pD
L_ch_pS:
  s_sub_u32 s38, s30, 4
  s_lshl_b32 s34, s38, 10
  v_add_u32 v3, s34, v2
  v_and_b32 v10, 15, v1
  v_bfe_u32 v11, v1, 4, 1
  v_lshrrev_b32 v12, 5, v1
  s_mul_i32 s36, s41, 6144
  s_cmp_eq_u32 s42, 2
  s_cbranch_scc1 L_ch_qst_v
  v_lshl_add_u32 v13, v11, 2, v12
  v_and_b32 v14, 1, v10
  v_lshl_add_u32 v13, v14, 1, v13
  s_lshl_b32 s34, s42, 3
  v_add_u32 v13, s34, v13
  v_bfe_u32 v14, v10, 2, 1
  v_lshl_add_u32 v13, v14, 4, v13
  v_lshlrev_b32 v13, 4, v13
  v_lshrrev_b32 v14, 3, v10
  v_lshl_add_u32 v13, v14, 3, v13
  v_and_b32 v14, 2, v10
  v_lshl_add_u32 v13, v14, 1, v13
  s_lshl_b32 s34, s38, 10
  s_add_u32 s34, s34, s36
  v_add_u32 v4, s34, v13
  v_add_u32 v5, 512, v4
  s_branch L_ch_qst_done
L_ch_qst_v:
  v_lshl_add_u32 v13, v11, 4, v10
  v_lshlrev_b32 v13, 4, v13
  v_lshl_add_u32 v13, v12, 2, v13
  s_and_b32 s34, s38, 1
  s_lshl_b32 s34, s34, 3
  s_lshr_b32 s35, s38, 1
  s_lshl_b32 s35, s35, 10
  s_add_u32 s34, s34, s35
  s_add_u32 s34, s34, 4096
  s_add_u32 s34, s34, s36
  v_add_u32 v5, s34, v13
  v_add_u32 v4, 512, v5
L_ch_qst_done:
  s_mov_b32 s34, 524288
  buffer_load_dword v224, v4, s[8:11], s34 offen sc1
  buffer_load_dword v225, v5, s[8:11], s34 offen sc1
  s_mov_b32 s34, 720896
  buffer_load_dword v224, v4, s[8:11], s34 offen sc1
  buffer_load_dword v225, v5, s[8:11], s34 offen sc1
  s_mov_b32 s34, 917504
  buffer_load_dword v224, v4, s[8:11], s34 offen sc1
  buffer_load_dword v225, v5, s[8:11], s34 offen sc1
  s_mov_b32 s34, 1114112
  buffer_load_dword v224, v4, s[8:11], s34 offen sc1
  buffer_load_dword v225, v5, s[8:11], s34 offen sc1
  v_mov_b32 v216, 0
  v_mov_b32 v217, 0
  v_mov_b32 v218, 0
  v_mov_b32 v219, 0
  v_mov_b32 v220, 0
  v_mov_b32 v221, 0
  v_mov_b32 v222, 0
  v_mov_b32 v223, 0
  v_bfe_u32 v10, v1, 2, 3
  v_lshrrev_b32 v13, 5, v1
  v_and_b32 v12, 3, v1
  v_lshl_add_u32 v11, v13, 2, v12
  v_lshlrev_b32 v12, 4, v12
  v_lshl_add_u32 v12, v13, 3, v12
  v_add_u32 v12, v12, v10
  v_lshlrev_b32 v12, 4, v12
  s_and_b32 s35, s38, 1
  s_lshl_b32 s36, s35, 10
  s_add_u32 s36, s36, 75776
  v_add_u32 v6, s36, v12
  s_lshl_b32 s36, s43, 1
  s_add_u32 s36, s36, s35
  s_lshr_b32 s37, s36, 3
  s_lshl_b32 s37, s37, 14
  s_add_u32 s36, s36, s44
  s_and_b32 s36, s36, 7
  s_lshl_b32 s36, s36, 10
  s_add_u32 s36, s36, s37
  s_mul_i32 s37, s44, 49152
  s_add_u32 s36, s36, s37
  v_add_u32 v7, s36, v2
  s_lshl_b32 s34, s44, 2
  s_add_u32 s34, s34, s38
  s_lshl_b32 s35, s34, 13
  v_add_u32 v8, s35, v2
  s_lshl_b32 s60, s38, 14
  s_add_u32 s60, s60, 0
  s_lshr_b32 s34, s34, 1
  v_and_b32 v9, 1, v1
  v_lshlrev_b32 v9, 4, v9
  v_add_u32 v9, s34, v9
  v_add_u32 v9, 16, v9
  v_lshlrev_b32 v9, 7, v9
  v_add_u32 v9, 32768, v9
  v_add_u32 v9, s100, v9
  s_cmp_ge_u32 s43, 10
  s_cbranch_scc1 L_ch_nok0
  s_mov_b32 s36, 1
  s_lshl_b32 s34, s44, 2
  s_add_u32 s34, s34, s38
  s_cmp_eq_u32 s30, 7
  s_cselect_b32 s35, 1, 0
  s_sub_u32 s34, s34, s35
  s_lshl_b32 s34, s34, 3
  s_add_u32 s34, s34, 1024
  s_add_u32 s34, s34, s100
  v_lshlrev_b32 v12, 2, v1
  v_add_u32 v12, s34, v12
  s_mov_b32 s39, 0
  s_mov_b64 s[70:71], exec
  s_mov_b32 exec_lo, 0xf
  s_mov_b32 exec_hi, 0x0
kv0_260:
  buffer_load_dword v13, v12, s[8:11], 0 offen sc1
  s_waitcnt vmcnt(0)
  v_cmp_gt_u32 vcc, s36, v13
  s_cbranch_vccz kv0d_261
  s_sleep 1
  s_add_u32 s39, s39, 1
  s_cmp_lt_u32 s39, s33
  s_cbranch_scc1 kv0_260
  s_mov_b32 s33, 0
kv0d_261:
  s_mov_b64 exec, s[70:71]
  s_mov_b32 s36, 16777216
  s_mov_b32 s37, 33554432
  s_cmp_eq_u32 s30, 6
  s_cbranch_scc1 kd_263
  s_add_u32 m0, s60, 0
  s_add_u32 s34, s36, 0
  buffer_load_dwordx4 v8, s[8:11], s34 offen offset:0 sc1 lds
  buffer_load_dwordx4 v8, s[8:11], s34 offen offset:1024 sc1 lds
  buffer_load_dwordx4 v8, s[8:11], s34 offen offset:2048 sc1 lds
  buffer_load_dwordx4 v8, s[8:11], s34 offen offset:3072 sc1 lds
  s_add_u32 m0, s60, 4096
  s_add_u32 s34, s36, 4096
  buffer_load_dwordx4 v8, s[8:11], s34 offen offset:0 sc1 lds
  buffer_load_dwordx4 v8, s[8:11], s34 offen offset:1024 sc1 lds
  buffer_load_dwordx4 v8, s[8:11], s34 offen offset:2048 sc1 lds
  buffer_load_dwordx4 v8, s[8:11], s34 offen offset:3072 sc1 lds
  s_add_u32 m0, s60, 8192
  s_add_u32 s34, s37, 0
  buffer_load_dwordx4 v8, s[8:11], s34 offen offset:0 sc1 lds
  buffer_load_dwordx4 v8, s[8:11], s34 offen offset:1024 sc1 lds
  buffer_load_dwordx4 v8, s[8:11], s34 offen offset:2048 sc1 lds
  buffer_load_dwordx4 v8, s[8:11], s34 offen offset:3072 sc1 lds
  s_add_u32 m0, s60, 12288
  s_add_u32 s34, s37, 4096
  buffer_load_dwordx4 v8, s[8:11], s34 offen offset:0 sc1 lds
  buffer_load_dwordx4 v8, s[8:11], s34 offen offset:1024 sc1 lds
  buffer_load_dwordx4 v8, s[8:11], s34 offen offset:2048 sc1 lds
  buffer_load_dwordx4 v8, s[8:11], s34 offen offset:3072 sc1 lds
  s_cmp_eq_u32 s30, 7
  s_cbranch_scc0 kd_263
  s_sub_u32 m0, s60, 16384
  s_sub_u32 s34, s36, 8192
  buffer_load_dwordx4 v8, s[8:11], s34 offen offset:0 sc1 lds
  buffer_load_dwordx4 v8, s[8:11], s34 offen offset:1024 sc1 lds
  buffer_load_dwordx4 v8, s[8:11], s34 offen offset:2048 sc1 lds
  buffer_load_dwordx4 v8, s[8:11], s34 offen offset:3072 sc1 lds
  s_sub_u32 m0, s60, 12288
  s_sub_u32 s34, s36, 4096
  buffer_load_dwordx4 v8, s[8:11], s34 offen offset:0 sc1 lds
  buffer_load_dwordx4 v8, s[8:11], s34 offen offset:1024 sc1 lds
  buffer_load_dwordx4 v8, s[8:11], s34 offen offset:2048 sc1 lds
  buffer_load_dwordx4 v8, s[8:11], s34 offen offset:3072 sc1 lds
  s_sub_u32 m0, s60, 8192
  s_sub_u32 s34, s37, 8192
  buffer_load_dwordx4 v8, s[8:11], s34 offen offset:0 sc1 lds
  buffer_load_dwordx4 v8, s[8:11], s34 offen offset:1024 sc1 lds
  buffer_load_dwordx4 v8, s[8:11], s34 offen offset:2048 sc1 lds
  buffer_load_dwordx4 v8, s[8:11], s34 offen offset:3072 sc1 lds
  s_sub_u32 m0, s60, 4096
  s_sub_u32 s34, s37, 4096
  buffer_load_dwordx4 v8, s[8:11], s34 offen offset:0 sc1 lds
  buffer_load_dwordx4 v8, s[8:11], s34 offen offset:1024 sc1 lds
  buffer_load_dwordx4 v8, s[8:11], s34 offen offset:2048 sc1 lds
  buffer_load_dwordx4 v8, s[8:11], s34 offen offset:3072 sc1 lds
kd_263:
  v_mov_b32 v238, v12
  s_waitcnt vmcnt(0)
L_ch_nok0:
  s_cmp_lg_u32 s30, 6
  s_cbranch_scc1 L_ch_pD
  s_mul_i32 s36, s45, 10
  s_add_u32 s36, s36, s43
  s_lshr_b32 s37, s36, 3
  s_lshl_b32 s37, s37, 14
  s_add_u32 s35, s36, 0
  s_and_b32 s35, s35, 7
  s_lshl_b32 s35, s35, 10
  s_add_u32 s35, s35, s37
  s_add_u32 s35, s35, 0
  v_add_u32 v240, s35, v2
  s_add_u32 s35, s36, 1
  s_and_b32 s35, s35, 7
  s_lshl_b32 s35, s35, 10
  s_add_u32 s35, s35, s37
  s_add_u32 s35, s35, 49152
  v_add_u32 v241, s35, v2
  s_add_u32 s35, s36, 2
  s_and_b32 s35, s35, 7
  s_lshl_b32 s35, s35, 10
  s_add_u32 s35, s35, s37
  s_add_u32 s35, s35, 98304
  v_add_u32 v242, s35, v2
  s_add_u32 s35, s36, 3
  s_and_b32 s35, s35, 7
  s_lshl_b32 s35, s35, 10
  s_add_u32 s35, s35, s37
  s_add_u32 s35, s35, 147456
  v_add_u32 v243, s35, v2
  s_add_u32 s35, s36, 4
  s_and_b32 s35, s35, 7
  s_lshl_b32 s35, s35, 10
  s_add_u32 s35, s35, s37
  s_add_u32 s35, s35, 196608
  v_add_u32 v244, s35, v2
  s_add_u32 s35, s36, 5
  s_and_b32 s35, s35, 7
  s_lshl_b32 s35, s35, 10
  s_add_u32 s35, s35, s37
  s_add_u32 s35, s35, 245760
  v_add_u32 v245, s35, v2
  s_add_u32 s35, s36, 6
  s_and_b32 s35, s35, 7
  s_lshl_b32 s35, s35, 10
  s_add_u32 s35, s35, s37
  s_add_u32 s35, s35, 294912
  v_add_u32 v246, s35, v2
  s_add_u32 s35, s36, 7
  s_and_b32 s35, s35, 7
  s_lshl_b32 s35, s35, 10
  s_add_u32 s35, s35, s37
  s_add_u32 s35, s35, 344064
  v_add_u32 v247, s35, v2
  s_lshl_b32 s36, s36, 5
  v_lshl_add_u32 v12, v11, 2, s36
  v_lshrrev_b32 v13, 6, v12
  v_lshlrev_b32 v13, 10, v13
  v_bfe_u32 v14, v12, 4, 2
  v_lshl_add_u32 v14, v14, 4, v10
  v_lshl_add_u32 v13, v14, 4, v13
  v_bfe_u32 v14, v12, 2, 2
  v_lshl_add_u32 v6, v14, 2, v13
L_ch_pD:
  v_add_u32 v10, 65536, v2
  v_add_u32 v11, 65536, v3
  s_waitcnt vmcnt(0) lgkmcnt(0)
  s_cmp_lg_u32 s31, 0
  s_cbranch_scc1 L_entryS
L_entryF:
L_stepF:
  s_barrier
  s_cmp_lt_u32 s30, 4
  s_cbranch_scc1 L_awF
  s_setprio 3
  ds_read_b128 v[176:179], v10 offset:0
  ds_read_b128 v[180:183], v10 offset:1024
  ds_read_b128 v[184:187], v10 offset:2048
  ds_read_b128 v[188:191], v10 offset:3072
  ds_read_b128 v[192:195], v10 offset:4096
  ds_read_b128 v[196:199], v10 offset:5120
  ds_read_b128 v[200:203], v10 offset:6144
  ds_read_b128 v[204:207], v10 offset:7168
  ds_read_b128 v[208:211], v10 offset:8192
  ds_read_b128 v[212:215], v10 offset:9216
  s_and_b32 s34, s40, 3
  s_mul_i32 s50, s34, 196608
  s_add_u32 s50, s50, 524288
  s_waitcnt lgkmcnt(9)
  v_smfmac_f32_16x16x64_bf16 v[216:219], v[176:179], v[16:23], v15
  v_smfmac_f32_16x16x64_bf16 v[220:223], v[176:179], v[96:103], v15
  s_waitcnt lgkmcnt(8)
  v_smfmac_f32_16x16x64_bf16 v[216:219], v[180:183], v[24:31], v15
  v_smfmac_f32_16x16x64_bf16 v[220:223], v[180:183], v[104:111], v15
  s_waitcnt lgkmcnt(7)
  v_smfmac_f32_16x16x64_bf16 v[216:219], v[184:187], v[32:39], v15
  v_smfmac_f32_16x16x64_bf16 v[220:223], v[184:187], v[112:119], v15
  s_waitcnt lgkmcnt(6)
  v_smfmac_f32_16x16x64_bf16 v[216:219], v[188:191], v[40:47], v15
  v_smfmac_f32_16x16x64_bf16 v[220:223], v[188:191], v[120:127], v15
  s_waitcnt lgkmcnt(5)
  v_smfmac_f32_16x16x64_bf16 v[216:219], v[192:195], v[48:55], v15
  v_smfmac_f32_16x16x64_bf16 v[220:223], v[192:195], v[128:135], v15
  s_waitcnt lgkmcnt(4)
  v_smfmac_f32_16x16x64_bf16 v[216:219], v[196:199], v[56:63], v15
  v_smfmac_f32_16x16x64_bf16 v[220:223], v[196:199], v[136:143], v15
  s_waitcnt lgkmcnt(3)
  v_smfmac_f32_16x16x64_bf16 v[216:219], v[200:203], v[64:71], v15
  v_smfmac_f32_16x16x64_bf16 v[220:223], v[200:203], v[144:151], v15
  s_waitcnt lgkmcnt(2)
  v_smfmac_f32_16x16x64_bf16 v[216:219], v[204:207], v[72:79], v15
  v_smfmac_f32_16x16x64_bf16 v[220:223], v[204:207], v[152:159], v15
  s_waitcnt lgkmcnt(1)
  v_smfmac_f32_16x16x64_bf16 v[216:219], v[208:211], v[80:87], v15
  v_smfmac_f32_16x16x64_bf16 v[220:223], v[208:211], v[160:167], v15
  s_waitcnt lgkmcnt(0)
  v_smfmac_f32_16x16x64_bf16 v[216:219], v[212:215], v[88:95], v15
  v_smfmac_f32_16x16x64_bf16 v[220:223], v[212:215], v[168:175], v15
  s_cmp_eq_u32 s42, 2
  s_mov_b64 vcc, s[74:75]
s_nop 4
  v_permlane32_swap_b32 v216, v217
  v_permlane32_swap_b32 v218, v219
  v_add_f32 v216, v216, v217
  v_add_f32 v218, v218, v219
  v_permlane32_swap_b32 v220, v221
  v_permlane32_swap_b32 v222, v223
  v_add_f32 v220, v220, v221
  v_add_f32 v222, v222, v223
  s_cbranch_scc1 L_s1vF
  v_cndmask_b32_dpp v224, v218, v216, vcc quad_perm:[1,0,3,2] row_mask:0xf bank_mask:0xf
  v_cndmask_b32_dpp v226, v222, v220, vcc quad_perm:[1,0,3,2] row_mask:0xf bank_mask:0xf
  s_mov_b64 vcc, s[76:77]
  v_cndmask_b32_dpp v225, v216, v218, vcc quad_perm:[1,0,3,2] row_mask:0xf bank_mask:0xf
  v_cndmask_b32_dpp v227, v220, v222, vcc quad_perm:[1,0,3,2] row_mask:0xf bank_mask:0xf
  v_cvt_pk_bf16_f32 v12, v224, v225
  v_cvt_pk_bf16_f32 v13, v226, v227
  s_branch L_s1sF
L_s1vF:
  v_cvt_pk_bf16_f32 v12, v216, v218
  v_cvt_pk_bf16_f32 v13, v220, v222
L_s1sF:
  buffer_store_dword v12, v4, s[8:11], s50 offen
  buffer_store_dword v13, v5, s[8:11], s50 offen
  s_cmp_eq_u32 s40, 63
  s_cbranch_scc1 L_fin
  s_cmp_ge_u32 s43, 10
  s_cbranch_scc1 L_s1onlyF
  s_barrier
  s_setprio 0
  s_and_b32 s34, s40, 3
  s_add_u32 s51, s50, 4096
  s_mul_i32 s53, s34, 393216
  s_add_u32 s53, s53, 2097152
  s_add_u32 s53, s53, s32
  s_add_u32 s35, s40, 2
  s_and_b32 s35, s35, 3
  s_mul_i32 s52, s35, 196608
  s_add_u32 s52, s52, 524288
  s_mul_i32 s54, s35, 393216
  s_add_u32 s54, s54, 2097152
  s_add_u32 s54, s54, s32
  s_mul_i32 s36, s28, 10240
  s_add_u32 s36, s36, 131072
  s_add_u32 s35, s40, 1
  s_and_b32 s35, s35, 3
  s_mul_i32 s46, s35, 40960
  s_add_u32 s46, s46, s36
  s_add_u32 s47, s46, 4096
  s_add_u32 s48, s46, 8192
  s_add_u32 s35, s40, 3
  s_and_b32 s35, s35, 3
  s_mul_i32 s49, s35, 40960
  s_add_u32 s49, s49, s36
  s_mul_i32 s55, s40, 196608
  s_add_u32 s55, s55, 83886080
  s_add_u32 s59, s55, 4096
  s_add_u32 s35, s40, 1
  s_lshl_b32 s35, s35, 18
  s_add_u32 s56, s35, 16777216
  s_add_u32 s57, s35, 33554432
  v_mov_b32 v14, -1
  buffer_store_dword v14, v4, s[8:11], s52 offen
  buffer_store_dword v14, v5, s[8:11], s52 offen
  v_mov_b32 v216, 0
  v_mov_b32 v217, 0
  v_mov_b32 v218, 0
  v_mov_b32 v219, 0
  v_mov_b32 v220, 0
  v_mov_b32 v221, 0
  v_mov_b32 v222, 0
  v_mov_b32 v223, 0
  s_add_u32 s61, s40, 2
  s_mov_b32 s62, 1
  s_cmp_ge_u32 s58, s61
  s_cbranch_scc1 kvl_264
  s_cmp_gt_u32 s61, 3
  s_cbranch_scc1 k12_266
  buffer_load_dword v13, v238, s[8:11], 0 offen sc1
  s_waitcnt vmcnt(0)
  v_readlane_b32 s34, v13, 0
  v_readlane_b32 s35, v13, 1
s_nop 3
  s_min_u32 s34, s34, s35
  v_readlane_b32 s35, v13, 2
s_nop 3
  s_min_u32 s34, s34, s35
  v_readlane_b32 s35, v13, 3
s_nop 3
  s_min_u32 s34, s34, s35
  s_mov_b32 s58, s34
  s_cmp_ge_u32 s58, s61
  s_cselect_b32 s62, 1, 0
  s_branch kvq_265
k12_266:
  buffer_load_dword v13, v9, s[8:11], 0 offen sc1
  s_waitcnt vmcnt(0)
  v_readlane_b32 s34, v13, 0
  v_readlane_b32 s35, v13, 1
s_nop 3
  s_min_u32 s58, s34, s35
  s_cmp_ge_u32 s58, s61
  s_cselect_b32 s62, 1, 0
  s_branch kvq_265
kvl_264:
  s_sleep 8
kvq_265:
  s_cmp_eq_u32 s62, 0
  s_cbranch_scc1 kvs_267
  s_cmp_eq_u32 s30, 6
  s_cbranch_scc1 kd_269
  s_add_u32 m0, s60, 0
  s_add_u32 s34, s56, 0
  buffer_load_dwordx4 v8, s[8:11], s34 offen offset:0 sc1 lds
  buffer_load_dwordx4 v8, s[8:11], s34 offen offset:1024 sc1 lds
  buffer_load_dwordx4 v8, s[8:11], s34 offen offset:2048 sc1 lds
  buffer_load_dwordx4 v8, s[8:11], s34 offen offset:3072 sc1 lds
  s_add_u32 m0, s60, 4096
  s_add_u32 s34, s56, 4096
  buffer_load_dwordx4 v8, s[8:11], s34 offen offset:0 sc1 lds
  buffer_load_dwordx4 v8, s[8:11], s34 offen offset:1024 sc1 lds
  buffer_load_dwordx4 v8, s[8:11], s34 offen offset:2048 sc1 lds
  buffer_load_dwordx4 v8, s[8:11], s34 offen offset:3072 sc1 lds
  s_add_u32 m0, s60, 8192
  s_add_u32 s34, s57, 0
  buffer_load_dwordx4 v8, s[8:11], s34 offen offset:0 sc1 lds
  buffer_load_dwordx4 v8, s[8:11], s34 offen offset:1024 sc1 lds
  buffer_load_dwordx4 v8, s[8:11], s34 offen offset:2048 sc1 lds
  buffer_load_dwordx4 v8, s[8:11], s34 offen offset:3072 sc1 lds
  s_add_u32 m0, s60, 12288
  s_add_u32 s34, s57, 4096
  buffer_load_dwordx4 v8, s[8:11], s34 offen offset:0 sc1 lds
  buffer_load_dwordx4 v8, s[8:11], s34 offen offset:1024 sc1 lds
  buffer_load_dwordx4 v8, s[8:11], s34 offen offset:2048 sc1 lds
  buffer_load_dwordx4 v8, s[8:11], s34 offen offset:3072 sc1 lds
  s_cmp_eq_u32 s30, 7
  s_cbranch_scc0 kd_269
  s_sub_u32 m0, s60, 16384
  s_sub_u32 s34, s56, 8192
  buffer_load_dwordx4 v8, s[8:11], s34 offen offset:0 sc1 lds
  buffer_load_dwordx4 v8, s[8:11], s34 offen offset:1024 sc1 lds
  buffer_load_dwordx4 v8, s[8:11], s34 offen offset:2048 sc1 lds
  buffer_load_dwordx4 v8, s[8:11], s34 offen offset:3072 sc1 lds
  s_sub_u32 m0, s60, 12288
  s_sub_u32 s34, s56, 4096
  buffer_load_dwordx4 v8, s[8:11], s34 offen offset:0 sc1 lds
  buffer_load_dwordx4 v8, s[8:11], s34 offen offset:1024 sc1 lds
  buffer_load_dwordx4 v8, s[8:11], s34 offen offset:2048 sc1 lds
  buffer_load_dwordx4 v8, s[8:11], s34 offen offset:3072 sc1 lds
  s_sub_u32 m0, s60, 8192
  s_sub_u32 s34, s57, 8192
  buffer_load_dwordx4 v8, s[8:11], s34 offen offset:0 sc1 lds
  buffer_load_dwordx4 v8, s[8:11], s34 offen offset:1024 sc1 lds
  buffer_load_dwordx4 v8, s[8:11], s34 offen offset:2048 sc1 lds
  buffer_load_dwordx4 v8, s[8:11], s34 offen offset:3072 sc1 lds
  s_sub_u32 m0, s60, 4096
  s_sub_u32 s34, s57, 4096
  buffer_load_dwordx4 v8, s[8:11], s34 offen offset:0 sc1 lds
  buffer_load_dwordx4 v8, s[8:11], s34 offen offset:1024 sc1 lds
  buffer_load_dwordx4 v8, s[8:11], s34 offen offset:2048 sc1 lds
  buffer_load_dwordx4 v8, s[8:11], s34 offen offset:3072 sc1 lds
kd_269:
kvs_267:
  s_setprio 3
  s_barrier
  s_cmp_ge_u32 s30, 6
  s_cbranch_scc1 L_bw6F
  ds_read_b128 v[176:179], v6 offset:0
  ds_read_b128 v[180:183], v6 offset:2048
  ds_read_b128 v[184:187], v6 offset:4096
  ds_read_b128 v[188:191], v6 offset:6144
  s_waitcnt lgkmcnt(2)
  v_pk_add_f32 v[176:177], v[176:177], v[180:181]
  v_pk_add_f32 v[178:179], v[178:179], v[182:183]
  s_waitcnt lgkmcnt(0)
  v_pk_add_f32 v[184:185], v[184:185], v[188:189]
  v_pk_add_f32 v[186:187], v[186:187], v[190:191]
  v_pk_add_f32 v[176:177], v[176:177], v[184:185]
  v_pk_add_f32 v[178:179], v[178:179], v[186:187]
  buffer_store_dwordx4 v[176:179], v7, s[8:11], s53 offen sc1
  v_mov_b32 v180, -1
  v_mov_b32 v181, -1
  v_mov_b32 v182, -1
  v_mov_b32 v183, -1
  buffer_store_dwordx4 v[180:183], v7, s[8:11], s54 offen sc1
  s_branch L_b3F
L_bw6F:
  s_cmp_lg_u32 s30, 6
  s_cbranch_scc1 L_b3F
  s_sleep 11
  buffer_load_dwordx4 v[176:179], v240, s[8:11], s53 offen sc1
  buffer_load_dwordx4 v[180:183], v241, s[8:11], s53 offen sc1
  buffer_load_dwordx4 v[184:187], v242, s[8:11], s53 offen sc1
  buffer_load_dwordx4 v[188:191], v243, s[8:11], s53 offen sc1
  buffer_load_dwordx4 v[192:195], v244, s[8:11], s53 offen sc1
  buffer_load_dwordx4 v[196:199], v245, s[8:11], s53 offen sc1
  buffer_load_dwordx4 v[200:203], v246, s[8:11], s53 offen sc1
  buffer_load_dwordx4 v[204:207], v247, s[8:11], s53 offen sc1
  s_mov_b32 s39, 0
ppc_271:
  s_waitcnt vmcnt(7)
  v_mov_b32 v224, v176
  s_waitcnt vmcnt(6)
  v_max_u32 v224, v224, v180
  v_pk_add_f32 v[176:177], v[176:177], v[180:181]
  v_pk_add_f32 v[178:179], v[178:179], v[182:183]
  s_waitcnt vmcnt(5)
  v_max_u32 v224, v224, v184
  v_pk_add_f32 v[176:177], v[176:177], v[184:185]
  v_pk_add_f32 v[178:179], v[178:179], v[186:187]
  s_waitcnt vmcnt(4)
  v_max_u32 v224, v224, v188
  v_pk_add_f32 v[176:177], v[176:177], v[188:189]
  v_pk_add_f32 v[178:179], v[178:179], v[190:191]
  s_waitcnt vmcnt(3)
  v_max_u32 v224, v224, v192
  v_pk_add_f32 v[176:177], v[176:177], v[192:193]
  v_pk_add_f32 v[178:179], v[178:179], v[194:195]
  s_waitcnt vmcnt(2)
  v_max_u32 v224, v224, v196
  v_pk_add_f32 v[176:177], v[176:177], v[196:197]
  v_pk_add_f32 v[178:179], v[178:179], v[198:199]
  s_waitcnt vmcnt(1)
  v_max_u32 v224, v224, v200
  v_pk_add_f32 v[176:177], v[176:177], v[200:201]
  v_pk_add_f32 v[178:179], v[178:179], v[202:203]
  s_waitcnt vmcnt(0)
  v_max_u32 v224, v224, v204
  v_pk_add_f32 v[176:177], v[176:177], v[204:205]
  v_pk_add_f32 v[178:179], v[178:179], v[206:207]
  v_cmp_eq_u32 vcc, -1, v224
  s_cbranch_vccnz pps_270
ppb_272:
  v_cvt_pk_bf16_f32 v176, v176, v177
  v_cvt_pk_bf16_f32 v177, v178, v179
  buffer_store_dword v176, v6, s[8:11], s46 offen
  buffer_store_dword v177, v6, s[8:11], s46 offen offset:128
L_b3F:
  s_barrier
  s_sleep 2
  s_cmp_ge_u32 s30, 6
  s_cbranch_scc1 mA_273
  buffer_load_dwordx4 v[224:227], v3, s[8:11], s46 offen sc1
  buffer_load_dwordx4 v[228:231], v3, s[8:11], s47 offen sc1
  buffer_load_dwordx4 v[232:235], v3, s[8:11], s48 offen sc1
  s_mov_b32 s39, 0
pmc_276:
  s_waitcnt vmcnt(2)
  v_max3_u32 v236, v224, v225, v226
  v_max_u32 v236, v236, v227
  v_cmp_eq_u32 vcc, -1, v236
  s_cbranch_vccnz pms_275
pmb_277:
  ds_write_b128 v11, v[224:227] offset:0
pmc_279:
  s_waitcnt vmcnt(1)
  v_max3_u32 v236, v228, v229, v230
  v_max_u32 v236, v236, v231
  v_cmp_eq_u32 vcc, -1, v236
  s_cbranch_vccnz pms_278
pmb_280:
  ds_write_b128 v11, v[228:231] offset:4096
pmc_282:
  s_waitcnt vmcnt(0)
  v_max3_u32 v236, v232, v233, v234
  v_max_u32 v236, v236, v235
  v_cmp_eq_u32 vcc, -1, v236
  s_cbranch_vccnz pms_281
pmb_283:
  ds_write_b128 v11, v[232:235] offset:8192
  s_branch mD_274
mA_273:
  buffer_load_dwordx4 v[224:227], v3, s[8:11], s46 offen sc1
  buffer_load_dwordx4 v[228:231], v3, s[8:11], s47 offen sc1
  s_mov_b32 s39, 0
pmc_285:
  s_waitcnt vmcnt(1)
  v_max3_u32 v236, v224, v225, v226
  v_max_u32 v236, v236, v227
  v_cmp_eq_u32 vcc, -1, v236
  s_cbranch_vccnz pms_284
pmb_286:
  ds_write_b128 v11, v[224:227] offset:0
pmc_288:
  s_waitcnt vmcnt(0)
  v_max3_u32 v236, v228, v229, v230
  v_max_u32 v236, v236, v231
  v_cmp_eq_u32 vcc, -1, v236
  s_cbranch_vccnz pms_287
pmb_289:
  ds_write_b128 v11, v[228:231] offset:4096
mD_274:
  s_cmp_lg_u32 s62, 0
  s_cbranch_scc1 kvz_290
  s_cmp_gt_u32 s61, 3
  s_cbranch_scc1 k12a_291
  s_mov_b32 s39, 0
  s_mov_b64 s[70:71], exec
  s_mov_b32 exec_lo, 0xf
  s_mov_b32 exec_hi, 0x0
k12w_293:
  buffer_load_dword v13, v238, s[8:11], 0 offen sc1
  s_waitcnt vmcnt(0)
  v_cmp_gt_u32 vcc, s61, v13
  s_cbranch_vccz k12wd_294
  s_sleep 1
  s_add_u32 s39, s39, 1
  s_cmp_lt_u32 s39, s33
  s_cbranch_scc1 k12w_293
  s_mov_b32 s33, 0
k12wd_294:
  s_mov_b64 exec, s[70:71]
  s_mov_b32 s58, s61
  s_branch k12b_292
k12a_291:
  s_cmp_ge_u32 s58, s61
  s_cbranch_scc1 kvok_295
  s_mov_b32 s39, 0
kvp_296:
  buffer_load_dword v13, v9, s[8:11], 0 offen sc1
  s_waitcnt vmcnt(0)
  v_readlane_b32 s34, v13, 0
  v_readlane_b32 s35, v13, 1
s_nop 3
  s_min_u32 s58, s34, s35
  s_cmp_ge_u32 s58, s61
  s_cbranch_scc1 kvok_295
  s_sleep 2
  s_add_u32 s39, s39, 1
  s_cmp_lt_u32 s39, s33
  s_cbranch_scc1 kvp_296
  s_mov_b32 s33, 0
kvok_295:
k12b_292:
  s_cmp_eq_u32 s30, 6
  s_cbranch_scc1 kd_298
  s_add_u32 m0, s60, 0
  s_add_u32 s34, s56, 0
  buffer_load_dwordx4 v8, s[8:11], s34 offen offset:0 sc1 lds
  buffer_load_dwordx4 v8, s[8:11], s34 offen offset:1024 sc1 lds
  buffer_load_dwordx4 v8, s[8:11], s34 offen offset:2048 sc1 lds
  buffer_load_dwordx4 v8, s[8:11], s34 offen offset:3072 sc1 lds
  s_add_u32 m0, s60, 4096
  s_add_u32 s34, s56, 4096
  buffer_load_dwordx4 v8, s[8:11], s34 offen offset:0 sc1 lds
  buffer_load_dwordx4 v8, s[8:11], s34 offen offset:1024 sc1 lds
  buffer_load_dwordx4 v8, s[8:11], s34 offen offset:2048 sc1 lds
  buffer_load_dwordx4 v8, s[8:11], s34 offen offset:3072 sc1 lds
  s_add_u32 m0, s60, 8192
  s_add_u32 s34, s57, 0
  buffer_load_dwordx4 v8, s[8:11], s34 offen offset:0 sc1 lds
  buffer_load_dwordx4 v8, s[8:11], s34 offen offset:1024 sc1 lds
  buffer_load_dwordx4 v8, s[8:11], s34 offen offset:2048 sc1 lds
  buffer_load_dwordx4 v8, s[8:11], s34 offen offset:3072 sc1 lds
  s_add_u32 m0, s60, 12288
  s_add_u32 s34, s57, 4096
  buffer_load_dwordx4 v8, s[8:11], s34 offen offset:0 sc1 lds
  buffer_load_dwordx4 v8, s[8:11], s34 offen offset:1024 sc1 lds
  buffer_load_dwordx4 v8, s[8:11], s34 offen offset:2048 sc1 lds
  buffer_load_dwordx4 v8, s[8:11], s34 offen offset:3072 sc1 lds
  s_cmp_eq_u32 s30, 7
  s_cbranch_scc0 kd_298
  s_sub_u32 m0, s60, 16384
  s_sub_u32 s34, s56, 8192
  buffer_load_dwordx4 v8, s[8:11], s34 offen offset:0 sc1 lds
  buffer_load_dwordx4 v8, s[8:11], s34 offen offset:1024 sc1 lds
  buffer_load_dwordx4 v8, s[8:11], s34 offen offset:2048 sc1 lds
  buffer_load_dwordx4 v8, s[8:11], s34 offen offset:3072 sc1 lds
  s_sub_u32 m0, s60, 12288
  s_sub_u32 s34, s56, 4096
  buffer_load_dwordx4 v8, s[8:11], s34 offen offset:0 sc1 lds
  buffer_load_dwordx4 v8, s[8:11], s34 offen offset:1024 sc1 lds
  buffer_load_dwordx4 v8, s[8:11], s34 offen offset:2048 sc1 lds
  buffer_load_dwordx4 v8, s[8:11], s34 offen offset:3072 sc1 lds
  s_sub_u32 m0, s60, 8192
  s_sub_u32 s34, s57, 8192
  buffer_load_dwordx4 v8, s[8:11], s34 offen offset:0 sc1 lds
  buffer_load_dwordx4 v8, s[8:11], s34 offen offset:1024 sc1 lds
  buffer_load_dwordx4 v8, s[8:11], s34 offen offset:2048 sc1 lds
  buffer_load_dwordx4 v8, s[8:11], s34 offen offset:3072 sc1 lds
  s_sub_u32 m0, s60, 4096
  s_sub_u32 s34, s57, 4096
  buffer_load_dwordx4 v8, s[8:11], s34 offen offset:0 sc1 lds
  buffer_load_dwordx4 v8, s[8:11], s34 offen offset:1024 sc1 lds
  buffer_load_dwordx4 v8, s[8:11], s34 offen offset:2048 sc1 lds
  buffer_load_dwordx4 v8, s[8:11], s34 offen offset:3072 sc1 lds
kd_298:
  s_waitcnt vmcnt(0)
kvz_290:
  s_cmp_lg_u32 s30, 6
  s_cbranch_scc1 L_nextF
  v_mov_b32 v14, -1
  buffer_store_dword v14, v6, s[8:11], s49 offen
  buffer_store_dword v14, v6, s[8:11], s49 offen offset:128
L_nextF:
  s_waitcnt lgkmcnt(0)
  s_add_u32 s40, s40, 1
  s_branch L_stepF
L_s1onlyF:
  s_and_b32 s34, s40, 3
  s_add_u32 s51, s50, 4096
  s_mul_i32 s53, s34, 393216
  s_add_u32 s53, s53, 2097152
  s_add_u32 s53, s53, s32
  s_add_u32 s35, s40, 2
  s_and_b32 s35, s35, 3
  s_mul_i32 s52, s35, 196608
  s_add_u32 s52, s52, 524288
  s_mul_i32 s54, s35, 393216
  s_add_u32 s54, s54, 2097152
  s_add_u32 s54, s54, s32
  s_mul_i32 s36, s28, 10240
  s_add_u32 s36, s36, 131072
  s_add_u32 s35, s40, 1
  s_and_b32 s35, s35, 3
  s_mul_i32 s46, s35, 40960
  s_add_u32 s46, s46, s36
  s_add_u32 s47, s46, 4096
  s_add_u32 s48, s46, 8192
  s_add_u32 s35, s40, 3
  s_and_b32 s35, s35, 3
  s_mul_i32 s49, s35, 40960
  s_add_u32 s49, s49, s36
  s_mul_i32 s55, s40, 196608
  s_add_u32 s55, s55, 83886080
  s_add_u32 s59, s55, 4096
  s_add_u32 s35, s40, 1
  s_lshl_b32 s35, s35, 18
  s_add_u32 s56, s35, 16777216
  s_add_u32 s57, s35, 33554432
  s_mov_b32 s62, 1
  v_mov_b32 v14, -1
  buffer_store_dword v14, v4, s[8:11], s52 offen
  buffer_store_dword v14, v5, s[8:11], s52 offen
  v_mov_b32 v216, 0
  v_mov_b32 v217, 0
  v_mov_b32 v218, 0
  v_mov_b32 v219, 0
  v_mov_b32 v220, 0
  v_mov_b32 v221, 0
  v_mov_b32 v222, 0
  v_mov_b32 v223, 0
  s_sleep 52
  s_cmp_ge_u32 s30, 6
  s_cbranch_scc1 mA_299
  buffer_load_dwordx4 v[224:227], v3, s[8:11], s46 offen sc1
  buffer_load_dwordx4 v[228:231], v3, s[8:11], s47 offen sc1
  buffer_load_dwordx4 v[232:235], v3, s[8:11], s48 offen sc1
  s_mov_b32 s39, 0
pmc_302:
  s_waitcnt vmcnt(2)
  v_max3_u32 v236, v224, v225, v226
  v_max_u32 v236, v236, v227
  v_cmp_eq_u32 vcc, -1, v236
  s_cbranch_vccnz pms_301
pmb_303:
  ds_write_b128 v11, v[224:227] offset:0
pmc_305:
  s_waitcnt vmcnt(1)
  v_max3_u32 v236, v228, v229, v230
  v_max_u32 v236, v236, v231
  v_cmp_eq_u32 vcc, -1, v236
  s_cbranch_vccnz pms_304
pmb_306:
  ds_write_b128 v11, v[228:231] offset:4096
pmc_308:
  s_waitcnt vmcnt(0)
  v_max3_u32 v236, v232, v233, v234
  v_max_u32 v236, v236, v235
  v_cmp_eq_u32 vcc, -1, v236
  s_cbranch_vccnz pms_307
pmb_309:
  ds_write_b128 v11, v[232:235] offset:8192
  s_branch mD_300
mA_299:
  buffer_load_dwordx4 v[224:227], v3, s[8:11], s46 offen sc1
  buffer_load_dwordx4 v[228:231], v3, s[8:11], s47 offen sc1
  s_mov_b32 s39, 0
pmc_311:
  s_waitcnt vmcnt(1)
  v_max3_u32 v236, v224, v225, v226
  v_max_u32 v236, v236, v227
  v_cmp_eq_u32 vcc, -1, v236
  s_cbranch_vccnz pms_310
pmb_312:
  ds_write_b128 v11, v[224:227] offset:0
pmc_314:
  s_waitcnt vmcnt(0)
  v_max3_u32 v236, v228, v229, v230
  v_max_u32 v236, v236, v231
  v_cmp_eq_u32 vcc, -1, v236
  s_cbranch_vccnz pms_313
pmb_315:
  ds_write_b128 v11, v[228:231] offset:4096
mD_300:
  s_branch L_nextF
L_awF:
  s_setprio 2
  s_and_b32 s34, s40, 3
  s_mul_i32 s50, s34, 196608
  s_add_u32 s50, s50, 524288
  s_and_b32 s34, s40, 3
  s_add_u32 s51, s50, 4096
  s_mul_i32 s53, s34, 393216
  s_add_u32 s53, s53, 2097152
  s_add_u32 s53, s53, s32
  s_add_u32 s35, s40, 2
  s_and_b32 s35, s35, 3
  s_mul_i32 s52, s35, 196608
  s_add_u32 s52, s52, 524288
  s_mul_i32 s54, s35, 393216
  s_add_u32 s54, s54, 2097152
  s_add_u32 s54, s54, s32
  s_mul_i32 s36, s28, 10240
  s_add_u32 s36, s36, 131072
  s_add_u32 s35, s40, 1
  s_and_b32 s35, s35, 3
  s_mul_i32 s46, s35, 40960
  s_add_u32 s46, s46, s36
  s_add_u32 s47, s46, 4096
  s_add_u32 s48, s46, 8192
  s_add_u32 s35, s40, 3
  s_and_b32 s35, s35, 3
  s_mul_i32 s49, s35, 40960
  s_add_u32 s49, s49, s36
  s_mul_i32 s55, s40, 196608
  s_add_u32 s55, s55, 83886080
  s_add_u32 s59, s55, 4096
  s_add_u32 s35, s40, 1
  s_lshl_b32 s35, s35, 18
  s_add_u32 s56, s35, 16777216
  s_add_u32 s57, s35, 33554432
  s_cmp_ge_u32 s43, 10
  s_cbranch_scc1 L_aidleF
  s_cmp_eq_u32 s40, 63
  s_cbranch_scc1 L_fin
  s_sleep 3
  ds_read_b128 v[80:83], v14 offset:0
  ds_read_b128 v[84:87], v14 offset:1024
  ds_read_b128 v[88:91], v14 offset:2048
  ds_read_b128 v[92:95], v14 offset:3072
  ds_read_b128 v[96:99], v14 offset:4096
  ds_read_b128 v[100:103], v14 offset:5120
  ds_read_b128 v[104:107], v14 offset:6144
  ds_read_b128 v[108:111], v14 offset:7168
  s_waitcnt lgkmcnt(0)
  ds_read_b128 v[112:115], v14 offset:8192
  ds_read_b128 v[116:119], v14 offset:9216
  ds_read_b128 v[120:123], v14 offset:10240
  ds_read_b128 v[124:127], v14 offset:11264
  ds_read_b128 v[128:131], v14 offset:12288
  ds_read_b128 v[132:135], v14 offset:13312
  ds_read_b128 v[136:139], v14 offset:14336
  ds_read_b128 v[140:143], v14 offset:15360
  s_waitcnt lgkmcnt(0)
  s_barrier
  s_sleep 6
  s_mov_b32 s39, 0
  buffer_load_dwordx4 v[144:147], v3, s[8:11], s50 offen offset:0 sc1
  buffer_load_dwordx4 v[148:151], v3, s[8:11], s50 offen offset:1024 sc1
  buffer_load_dwordx4 v[152:155], v3, s[8:11], s50 offen offset:2048 sc1
  buffer_load_dwordx4 v[156:159], v3, s[8:11], s50 offen offset:3072 sc1
  s_sleep 1
  buffer_load_dwordx4 v[160:163], v3, s[8:11], s51 offen offset:0 sc1
  buffer_load_dwordx4 v[164:167], v3, s[8:11], s51 offen offset:1024 sc1
  s_waitcnt vmcnt(2)
pqm_316:
  v_mfma_f32_16x16x32_bf16 v[168:171], v[80:83], v[144:147], 0
  v_max3_u32 v244, v144, v145, v146
  v_max3_u32 v244, v244, v147, v148
  v_mfma_f32_16x16x32_bf16 v[168:171], v[84:87], v[148:151], v[168:171]
  v_max3_u32 v244, v244, v149, v150
  v_max3_u32 v244, v244, v151, v152
  v_mfma_f32_16x16x32_bf16 v[168:171], v[88:91], v[152:155], v[168:171]
  v_max3_u32 v244, v244, v153, v154
  v_max3_u32 v244, v244, v155, v156
  v_mfma_f32_16x16x32_bf16 v[168:171], v[92:95], v[156:159], v[168:171]
  v_max3_u32 v244, v244, v157, v158
  v_max_u32 v244, v244, v159
  v_mfma_f32_16x16x32_bf16 v[172:175], v[96:99], v[144:147], 0
  v_cmp_eq_u32 vcc, -1, v244
  v_mfma_f32_16x16x32_bf16 v[172:175], v[100:103], v[148:151], v[172:175]
  s_cbranch_vccnz pqr_317
pqx_318:
  v_mfma_f32_16x16x32_bf16 v[172:175], v[104:107], v[152:155], v[172:175]
  v_mov_b32 v186, 0
  v_mov_b32 v187, 0
  v_mfma_f32_16x16x32_bf16 v[172:175], v[108:111], v[156:159], v[172:175]
  v_mfma_f32_16x16x32_bf16 v[176:179], v[144:147], v[144:147], v[240:243]
  v_max3_f32 v244, v168, v169, v170
  v_mfma_f32_16x16x32_bf16 v[176:179], v[148:151], v[148:151], v[176:179]
  v_mfma_f32_16x16x32_bf16 v[176:179], v[152:155], v[152:155], v[176:179]
s_nop 3
  v_max3_f32 v244, v244, v171, v172
  v_mfma_f32_16x16x32_bf16 v[176:179], v[156:159], v[156:159], v[176:179]
  v_max3_f32 v244, v244, v173, v174
  v_max_f32 v244, v244, v175
s_nop 5
  v_max3_f32 v244, v244, v176, v177
  v_max3_f32 v244, v244, v178, v179
  v_mov_b32 v245, v244
s_nop 1
  v_permlane16_swap_b32 v244, v245
  v_max_f32 v244, v244, v245
  v_mov_b32 v245, v244
s_nop 1
  v_permlane32_swap_b32 v244, v245
  v_max_f32 v244, v244, v245
  v_mul_f32 v244, s79, v244
  v_mul_f32 v245, 1.0, v244
  v_pk_fma_f32 v[168:169], v[168:169], s[66:67], v[244:245]
  v_pk_fma_f32 v[170:171], v[170:171], s[66:67], v[244:245]
  v_pk_fma_f32 v[172:173], v[172:173], s[66:67], v[244:245]
  v_pk_fma_f32 v[174:175], v[174:175], s[66:67], v[244:245]
  v_pk_fma_f32 v[176:177], v[176:177], s[66:67], v[244:245]
  v_pk_fma_f32 v[178:179], v[178:179], s[66:67], v[244:245]
  v_exp_f32 v168, v168
  v_exp_f32 v169, v169
  v_exp_f32 v170, v170
  v_exp_f32 v171, v171
  v_exp_f32 v172, v172
  v_exp_f32 v173, v173
  v_exp_f32 v174, v174
  v_exp_f32 v175, v175
  v_cvt_pk_bf16_f32 v180, v168, v169
  v_cvt_pk_bf16_f32 v181, v170, v171
  v_cvt_pk_bf16_f32 v182, v172, v173
  v_cvt_pk_bf16_f32 v183, v174, v175
  s_waitcnt vmcnt(0)
  v_max3_u32 v247, v160, v161, v162
  v_max3_u32 v247, v247, v163, v164
  v_mfma_f32_16x16x32_bf16 v[192:195], v[112:115], v[180:183], 0
  v_exp_f32 v176, v176
  v_max3_u32 v247, v247, v165, v166
  v_mfma_f32_16x16x32_bf16 v[196:199], v[116:119], v[180:183], 0
  v_exp_f32 v177, v177
  v_max_u32 v247, v247, v167
  v_mfma_f32_16x16x32_bf16 v[200:203], v[120:123], v[180:183], 0
  v_exp_f32 v178, v178
  v_add_f32 v245, v168, v169
  v_mfma_f32_16x16x32_bf16 v[204:207], v[124:127], v[180:183], 0
  v_exp_f32 v179, v179
  v_add_f32 v246, v170, v171
  v_mfma_f32_16x16x32_bf16 v[208:211], v[128:131], v[180:183], 0
  v_cvt_pk_bf16_f32 v184, v176, v178
  v_cvt_pk_bf16_f32 v185, v177, v179
  v_cmp_eq_u32 vcc, -1, v247
  v_mfma_f32_16x16x32_bf16 v[212:215], v[132:135], v[180:183], 0
  v_mov_b32 v188, v184
  v_mov_b32 v189, v185
  v_mfma_f32_16x16x32_bf16 v[216:219], v[136:139], v[180:183], 0
  v_add_f32 v245, v245, v172
  v_add_f32 v246, v246, v173
  v_mfma_f32_16x16x32_bf16 v[220:223], v[140:143], v[180:183], 0
  v_permlane32_swap_b32 v188, v186
  v_permlane32_swap_b32 v189, v187
  s_cbranch_vccnz pvr_319
pvb_320:
  v_mfma_f32_16x16x16_bf16 v[192:195], v[160:161], v[184:185], v[192:195]
  v_add_f32 v245, v245, v176
  v_add_f32 v246, v246, v177
  v_mfma_f32_16x16x16_bf16 v[196:199], v[160:161], v[186:187], v[196:199]
  v_add_f32 v245, v245, v178
  v_add_f32 v246, v246, v179
  v_mfma_f32_16x16x16_bf16 v[200:203], v[162:163], v[184:185], v[200:203]
  v_add_f32 v245, v245, v174
  v_add_f32 v246, v246, v175
  v_mfma_f32_16x16x16_bf16 v[204:207], v[162:163], v[186:187], v[204:207]
  v_add_f32 v245, v245, v246
  v_mov_b32 v246, v245
  v_mfma_f32_16x16x16_bf16 v[208:211], v[164:165], v[184:185], v[208:211]
  v_cvt_pk_bf16_f32 v224, v192, v193
  v_cvt_pk_bf16_f32 v225, v194, v195
  v_mfma_f32_16x16x16_bf16 v[212:215], v[164:165], v[186:187], v[212:215]
  v_cvt_pk_bf16_f32 v226, v196, v197
  v_cvt_pk_bf16_f32 v227, v198, v199
  v_mfma_f32_16x16x16_bf16 v[216:219], v[166:167], v[184:185], v[216:219]
  v_cvt_pk_bf16_f32 v228, v200, v201
  v_cvt_pk_bf16_f32 v229, v202, v203
  v_mfma_f32_16x16x16_bf16 v[220:223], v[166:167], v[186:187], v[220:223]
  v_cvt_pk_bf16_f32 v230, v204, v205
  v_cvt_pk_bf16_f32 v231, v206, v207
  v_mfma_f32_16x16x32_bf16 v[144:147], v[16:19], v[224:227], 0
  v_permlane16_swap_b32 v245, v246
  v_mfma_f32_16x16x32_bf16 v[148:151], v[32:35], v[224:227], 0
  v_cvt_pk_bf16_f32 v232, v208, v209
  v_cvt_pk_bf16_f32 v233, v210, v211
  v_mfma_f32_16x16x32_bf16 v[152:155], v[48:51], v[224:227], 0
  v_cvt_pk_bf16_f32 v234, v212, v213
  v_cvt_pk_bf16_f32 v235, v214, v215
  v_mfma_f32_16x16x32_bf16 v[156:159], v[64:67], v[224:227], 0
  v_add_f32 v245, v245, v246
  v_mov_b32 v246, v245
  v_mfma_f32_16x16x32_bf16 v[144:147], v[20:23], v[228:231], v[144:147]
  v_cvt_pk_bf16_f32 v236, v216, v217
  v_cvt_pk_bf16_f32 v237, v218, v219
  v_mfma_f32_16x16x32_bf16 v[148:151], v[36:39], v[228:231], v[148:151]
  v_cvt_pk_bf16_f32 v238, v220, v221
  v_cvt_pk_bf16_f32 v239, v222, v223
  v_mfma_f32_16x16x32_bf16 v[152:155], v[52:55], v[228:231], v[152:155]
  v_permlane32_swap_b32 v245, v246
  v_mfma_f32_16x16x32_bf16 v[156:159], v[68:71], v[228:231], v[156:159]
  v_add_f32 v245, v245, v246
  v_mfma_f32_16x16x32_bf16 v[144:147], v[24:27], v[232:235], v[144:147]
  v_rcp_f32 v245, v245
  v_mfma_f32_16x16x32_bf16 v[144:147], v[28:31], v[236:239], v[144:147]
  v_mfma_f32_16x16x32_bf16 v[148:151], v[40:43], v[232:235], v[148:151]
  v_mov_b32 v244, v245
  v_mfma_f32_16x16x32_bf16 v[148:151], v[44:47], v[236:239], v[148:151]
  v_mfma_f32_16x16x32_bf16 v[152:155], v[56:59], v[232:235], v[152:155]
  v_mfma_f32_16x16x32_bf16 v[152:155], v[60:63], v[236:239], v[152:155]
  v_mfma_f32_16x16x32_bf16 v[156:159], v[72:75], v[232:235], v[156:159]
  v_mfma_f32_16x16x32_bf16 v[156:159], v[76:79], v[236:239], v[156:159]
s_nop 0
  v_pk_mul_f32 v[144:145], v[144:145], v[244:245]
  v_pk_mul_f32 v[146:147], v[146:147], v[244:245]
s_nop 0
  v_pk_mul_f32 v[148:149], v[148:149], v[244:245]
  v_pk_mul_f32 v[150:151], v[150:151], v[244:245]
s_nop 0
  v_mov_b32_dpp v144, v148 row_shr:8 row_mask:0xf bank_mask:0xc
  v_mov_b32_dpp v145, v149 row_shr:8 row_mask:0xf bank_mask:0xc
  v_mov_b32_dpp v146, v150 row_shr:8 row_mask:0xf bank_mask:0xc
  v_mov_b32_dpp v147, v151 row_shr:8 row_mask:0xf bank_mask:0xc
  ds_write_b128 v5, v[144:147] offset:0
  v_pk_mul_f32 v[152:153], v[152:153], v[244:245]
  v_pk_mul_f32 v[154:155], v[154:155], v[244:245]
  v_pk_mul_f32 v[156:157], v[156:157], v[244:245]
  v_pk_mul_f32 v[158:159], v[158:159], v[244:245]
s_nop 0
  v_mov_b32_dpp v152, v156 row_shr:8 row_mask:0xf bank_mask:0xc
  v_mov_b32_dpp v153, v157 row_shr:8 row_mask:0xf bank_mask:0xc
  v_mov_b32_dpp v154, v158 row_shr:8 row_mask:0xf bank_mask:0xc
  v_mov_b32_dpp v155, v159 row_shr:8 row_mask:0xf bank_mask:0xc
  ds_write_b128 v5, v[152:155] offset:1024
  s_waitcnt lgkmcnt(0)
  s_barrier
  s_barrier
  s_branch L_nextF
pqr_317:
  s_add_u32 s39, s39, 1
  s_cmp_ge_u32 s39, s33
  s_cbranch_scc1 pqr_317_t
  buffer_load_dwordx4 v[144:147], v3, s[8:11], s50 offen offset:0 sc1
  buffer_load_dwordx4 v[148:151], v3, s[8:11], s50 offen offset:1024 sc1
  buffer_load_dwordx4 v[152:155], v3, s[8:11], s50 offen offset:2048 sc1
  buffer_load_dwordx4 v[156:159], v3, s[8:11], s50 offen offset:3072 sc1
  s_waitcnt vmcnt(0)
  s_branch pqm_316
pqr_317_t:
  s_mov_b32 s33, 0
  s_branch pqx_318
pvr_319:
  s_add_u32 s39, s39, 1
  s_cmp_ge_u32 s39, s33
  s_cbranch_scc1 pvr_319_t
  buffer_load_dwordx4 v[160:163], v3, s[8:11], s51 offen offset:0 sc1
  buffer_load_dwordx4 v[164:167], v3, s[8:11], s51 offen offset:1024 sc1
  s_waitcnt vmcnt(0)
  v_max3_u32 v247, v160, v161, v162
  v_max3_u32 v247, v247, v163, v164
  v_max3_u32 v247, v247, v165, v166
  v_max_u32 v247, v247, v167
  v_cmp_eq_u32 vcc, -1, v247
  s_cbranch_vccnz pvr_319
  s_branch pvb_320
pvr_319_t:
  s_mov_b32 s33, 0
  s_branch pvb_320
L_aidleF:
  s_cmp_eq_u32 s43, 10
  s_cbranch_scc0 L_awarmF
  s_sleep 14
  s_mov_b32 s39, 0
pkF_321:
  buffer_load_dwordx4 v[144:147], v3, s[8:11], s50 offen offset:0 sc1
  buffer_load_dwordx4 v[148:151], v3, s[8:11], s50 offen offset:1024 sc1
  buffer_load_dwordx4 v[152:155], v3, s[8:11], s50 offen offset:2048 sc1
  buffer_load_dwordx4 v[156:159], v3, s[8:11], s50 offen offset:3072 sc1
  buffer_load_dwordx4 v[160:163], v3, s[8:11], s51 offen offset:0 sc1
  buffer_load_dwordx4 v[164:167], v3, s[8:11], s51 offen offset:1024 sc1
  s_waitcnt vmcnt(0)
  v_max3_u32 v244, v144, v145, v146
  v_max3_u32 v244, v244, v147, v148
  v_max3_u32 v244, v244, v149, v150
  v_max3_u32 v244, v244, v151, v152
  v_max3_u32 v244, v244, v153, v154
  v_max3_u32 v244, v244, v155, v156
  v_max3_u32 v244, v244, v157, v158
  v_max3_u32 v244, v244, v159, v160
  v_max3_u32 v244, v244, v161, v162
  v_max3_u32 v244, v244, v163, v164
  v_max3_u32 v244, v244, v165, v166
  v_max_u32 v244, v244, v167
  v_cmp_eq_u32 vcc, -1, v244
  s_cbranch_vccz pkFd_322
  s_sleep 2
  s_add_u32 s39, s39, 1
  s_cmp_lt_u32 s39, s33
  s_cbranch_scc1 pkF_321
  s_mov_b32 s33, 0
pkFd_322:
  buffer_store_dwordx4 v[144:147], v3, s[8:11], s55 offen offset:0 sc1
  buffer_store_dwordx4 v[148:151], v3, s[8:11], s55 offen offset:1024 sc1
  buffer_store_dwordx4 v[152:155], v3, s[8:11], s55 offen offset:2048 sc1
  buffer_store_dwordx4 v[156:159], v3, s[8:11], s55 offen offset:3072 sc1
  buffer_store_dwordx4 v[160:163], v3, s[8:11], s59 offen offset:0 sc1
  buffer_store_dwordx4 v[164:167], v3, s[8:11], s59 offen offset:1024 sc1
  s_waitcnt vmcnt(0)
  s_lshl_b32 s34, s44, 2
  s_add_u32 s34, s34, s30
  s_lshl_b32 s34, s34, 7
  s_add_u32 s34, s34, 4096
  s_add_u32 s34, s34, s100
  s_add_u32 s35, s40, 1
  v_mov_b32 v244, s34
  v_mov_b32 v245, s35
  s_mov_b64 exec, 1
  buffer_store_dword v245, v244, s[8:11], 0 offen sc1
  s_mov_b64 exec, -1
  s_cmp_eq_u32 s40, 63
  s_cbranch_scc1 L_fin
  s_branch L_nextF
L_awarmF:
  s_cmp_eq_u32 s40, 63
  s_cbranch_scc1 L_fin
  s_add_u32 s36, s40, 3
  s_cmp_gt_u32 s36, 64
  s_cbranch_scc1 wsk_323
  s_sleep 16
  buffer_load_dword v13, v9, s[8:11], 0 offen sc1
  s_waitcnt vmcnt(0)
  v_readlane_b32 s34, v13, 0
  v_readlane_b32 s35, v13, 1
s_nop 3
  s_min_u32 s34, s34, s35
  s_cmp_lt_u32 s34, s36
  s_cbranch_scc1 wsk_323
  s_add_u32 s36, s40, 2
  s_lshl_b32 s36, s36, 18
  s_add_u32 s37, s36, 33554432
  s_add_u32 s36, s36, 16777216
  s_add_u32 s34, s36, 4096
  s_add_u32 s35, s37, 4096
  buffer_load_dwordx4 v[80:83], v4, s[8:11], s36 offen offset:0 sc1
  buffer_load_dwordx4 v[84:87], v4, s[8:11], s36 offen offset:1024 sc1
  buffer_load_dwordx4 v[88:91], v4, s[8:11], s36 offen offset:2048 sc1
  buffer_load_dwordx4 v[92:95], v4, s[8:11], s36 offen offset:3072 sc1
  buffer_load_dwordx4 v[96:99], v4, s[8:11], s34 offen offset:0 sc1
  buffer_load_dwordx4 v[100:103], v4, s[8:11], s34 offen offset:1024 sc1
  buffer_load_dwordx4 v[104:107], v4, s[8:11], s34 offen offset:2048 sc1
  buffer_load_dwordx4 v[108:111], v4, s[8:11], s34 offen offset:3072 sc1
  buffer_load_dwordx4 v[112:115], v4, s[8:11], s37 offen offset:0 sc1
  buffer_load_dwordx4 v[116:119], v4, s[8:11], s37 offen offset:1024 sc1
  buffer_load_dwordx4 v[120:123], v4, s[8:11], s37 offen offset:2048 sc1
  buffer_load_dwordx4 v[124:127], v4, s[8:11], s37 offen offset:3072 sc1
  buffer_load_dwordx4 v[128:131], v4, s[8:11], s35 offen offset:0 sc1
  buffer_load_dwordx4 v[132:135], v4, s[8:11], s35 offen offset:1024 sc1
  buffer_load_dwordx4 v[136:139], v4, s[8:11], s35 offen offset:2048 sc1
  buffer_load_dwordx4 v[140:143], v4, s[8:11], s35 offen offset:3072 sc1
wsk_323:
  s_branch L_nextF
pps_270:
  s_add_u32 s39, s39, 1
  s_cmp_ge_u32 s39, s33
  s_cbranch_scc1 pps_270_t
  buffer_load_dwordx4 v[176:179], v240, s[8:11], s53 offen sc1
  buffer_load_dwordx4 v[180:183], v241, s[8:11], s53 offen sc1
  buffer_load_dwordx4 v[184:187], v242, s[8:11], s53 offen sc1
  buffer_load_dwordx4 v[188:191], v243, s[8:11], s53 offen sc1
  buffer_load_dwordx4 v[192:195], v244, s[8:11], s53 offen sc1
  buffer_load_dwordx4 v[196:199], v245, s[8:11], s53 offen sc1
  buffer_load_dwordx4 v[200:203], v246, s[8:11], s53 offen sc1
  buffer_load_dwordx4 v[204:207], v247, s[8:11], s53 offen sc1
  s_branch ppc_271
pps_270_t:
  s_mov_b32 s33, 0
  s_waitcnt vmcnt(0)
  s_branch ppb_272
pms_275:
  s_add_u32 s39, s39, 1
  s_cmp_ge_u32 s39, s33
  s_cbranch_scc1 pms_275_t
  buffer_load_dwordx4 v[224:227], v3, s[8:11], s46 offen sc1
  buffer_load_dwordx4 v[228:231], v3, s[8:11], s47 offen sc1
  buffer_load_dwordx4 v[232:235], v3, s[8:11], s48 offen sc1
  s_branch pmc_276
pms_275_t:
  s_mov_b32 s33, 0
  s_waitcnt vmcnt(0)
  s_branch pmb_277
pms_278:
  s_add_u32 s39, s39, 1
  s_cmp_ge_u32 s39, s33
  s_cbranch_scc1 pms_278_t
  buffer_load_dwordx4 v[228:231], v3, s[8:11], s47 offen sc1
  buffer_load_dwordx4 v[232:235], v3, s[8:11], s48 offen sc1
  s_branch pmc_279
pms_278_t:
  s_mov_b32 s33, 0
  s_waitcnt vmcnt(0)
  s_branch pmb_280
pms_281:
  s_add_u32 s39, s39, 1
  s_cmp_ge_u32 s39, s33
  s_cbranch_scc1 pms_281_t
  buffer_load_dwordx4 v[232:235], v3, s[8:11], s48 offen sc1
  s_branch pmc_282
pms_281_t:
  s_mov_b32 s33, 0
  s_waitcnt vmcnt(0)
  s_branch pmb_283
pms_284:
  s_add_u32 s39, s39, 1
  s_cmp_ge_u32 s39, s33
  s_cbranch_scc1 pms_284_t
  buffer_load_dwordx4 v[224:227], v3, s[8:11], s46 offen sc1
  buffer_load_dwordx4 v[228:231], v3, s[8:11], s47 offen sc1
  s_branch pmc_285
pms_284_t:
  s_mov_b32 s33, 0
  s_waitcnt vmcnt(0)
  s_branch pmb_286
pms_287:
  s_add_u32 s39, s39, 1
  s_cmp_ge_u32 s39, s33
  s_cbranch_scc1 pms_287_t
  buffer_load_dwordx4 v[228:231], v3, s[8:11], s47 offen sc1
  s_branch pmc_288
pms_287_t:
  s_mov_b32 s33, 0
  s_waitcnt vmcnt(0)
  s_branch pmb_289
pms_301:
  s_add_u32 s39, s39, 1
  s_cmp_ge_u32 s39, s33
  s_cbranch_scc1 pms_301_t
  s_sleep 1
  buffer_load_dwordx4 v[224:227], v3, s[8:11], s46 offen sc1
  buffer_load_dwordx4 v[228:231], v3, s[8:11], s47 offen sc1
  buffer_load_dwordx4 v[232:235], v3, s[8:11], s48 offen sc1
  s_branch pmc_302
pms_301_t:
  s_mov_b32 s33, 0
  s_waitcnt vmcnt(0)
  s_branch pmb_303
pms_304:
  s_add_u32 s39, s39, 1
  s_cmp_ge_u32 s39, s33
  s_cbranch_scc1 pms_304_t
  s_sleep 1
  buffer_load_dwordx4 v[228:231], v3, s[8:11], s47 offen sc1
  buffer_load_dwordx4 v[232:235], v3, s[8:11], s48 offen sc1
  s_branch pmc_305
pms_304_t:
  s_mov_b32 s33, 0
  s_waitcnt vmcnt(0)
  s_branch pmb_306
pms_307:
  s_add_u32 s39, s39, 1
  s_cmp_ge_u32 s39, s33
  s_cbranch_scc1 pms_307_t
  s_sleep 1
  buffer_load_dwordx4 v[232:235], v3, s[8:11], s48 offen sc1
  s_branch pmc_308
pms_307_t:
  s_mov_b32 s33, 0
  s_waitcnt vmcnt(0)
  s_branch pmb_309
pms_310:
  s_add_u32 s39, s39, 1
  s_cmp_ge_u32 s39, s33
  s_cbranch_scc1 pms_310_t
  s_sleep 1
  buffer_load_dwordx4 v[224:227], v3, s[8:11], s46 offen sc1
  buffer_load_dwordx4 v[228:231], v3, s[8:11], s47 offen sc1
  s_branch pmc_311
pms_310_t:
  s_mov_b32 s33, 0
  s_waitcnt vmcnt(0)
  s_branch pmb_312
pms_313:
  s_add_u32 s39, s39, 1
  s_cmp_ge_u32 s39, s33
  s_cbranch_scc1 pms_313_t
  s_sleep 1
  buffer_load_dwordx4 v[228:231], v3, s[8:11], s47 offen sc1
  s_branch pmc_314
pms_313_t:
  s_mov_b32 s33, 0
  s_waitcnt vmcnt(0)
  s_branch pmb_315
L_entryS:
L_stepS:
  s_barrier
  s_cmp_lt_u32 s30, 4
  s_cbranch_scc1 L_awS
  s_setprio 3
  ds_read_b128 v[176:179], v10 offset:0
  ds_read_b128 v[180:183], v10 offset:1024
  ds_read_b128 v[184:187], v10 offset:2048
  ds_read_b128 v[188:191], v10 offset:3072
  ds_read_b128 v[192:195], v10 offset:4096
  ds_read_b128 v[196:199], v10 offset:5120
  ds_read_b128 v[200:203], v10 offset:6144
  ds_read_b128 v[204:207], v10 offset:7168
  ds_read_b128 v[208:211], v10 offset:8192
  ds_read_b128 v[212:215], v10 offset:9216
  s_and_b32 s34, s40, 3
  s_mul_i32 s50, s34, 196608
  s_add_u32 s50, s50, 524288
  s_waitcnt lgkmcnt(9)
  v_smfmac_f32_16x16x64_bf16 v[216:219], v[176:179], v[16:23], v15
  v_smfmac_f32_16x16x64_bf16 v[220:223], v[176:179], v[96:103], v15
  s_waitcnt lgkmcnt(8)
  v_smfmac_f32_16x16x64_bf16 v[216:219], v[180:183], v[24:31], v15
  v_smfmac_f32_16x16x64_bf16 v[220:223], v[180:183], v[104:111], v15
  s_waitcnt lgkmcnt(7)
  v_smfmac_f32_16x16x64_bf16 v[216:219], v[184:187], v[32:39], v15
  v_smfmac_f32_16x16x64_bf16 v[220:223], v[184:187], v[112:119], v15
  s_waitcnt lgkmcnt(6)
  v_smfmac_f32_16x16x64_bf16 v[216:219], v[188:191], v[40:47], v15
  v_smfmac_f32_16x16x64_bf16 v[220:223], v[188:191], v[120:127], v15
  s_waitcnt lgkmcnt(5)
  v_smfmac_f32_16x16x64_bf16 v[216:219], v[192:195], v[48:55], v15
  v_smfmac_f32_16x16x64_bf16 v[220:223], v[192:195], v[128:135], v15
  s_waitcnt lgkmcnt(4)
  v_smfmac_f32_16x16x64_bf16 v[216:219], v[196:199], v[56:63], v15
  v_smfmac_f32_16x16x64_bf16 v[220:223], v[196:199], v[136:143], v15
  s_waitcnt lgkmcnt(3)
  v_smfmac_f32_16x16x64_bf16 v[216:219], v[200:203], v[64:71], v15
  v_smfmac_f32_16x16x64_bf16 v[220:223], v[200:203], v[144:151], v15
  s_waitcnt lgkmcnt(2)
  v_smfmac_f32_16x16x64_bf16 v[216:219], v[204:207], v[72:79], v15
  v_smfmac_f32_16x16x64_bf16 v[220:223], v[204:207], v[152:159], v15
  s_waitcnt lgkmcnt(1)
  v_smfmac_f32_16x16x64_bf16 v[216:219], v[208:211], v[80:87], v15
  v_smfmac_f32_16x16x64_bf16 v[220:223], v[208:211], v[160:167], v15
  s_waitcnt lgkmcnt(0)
  v_smfmac_f32_16x16x64_bf16 v[216:219], v[212:215], v[88:95], v15
  v_smfmac_f32_16x16x64_bf16 v[220:223], v[212:215], v[168:175], v15
  s_cmp_eq_u32 s42, 2
  s_mov_b64 vcc, s[74:75]
s_nop 4
  v_permlane32_swap_b32 v216, v217
  v_permlane32_swap_b32 v218, v219
  v_add_f32 v216, v216, v217
  v_add_f32 v218, v218, v219
  v_permlane32_swap_b32 v220, v221
  v_permlane32_swap_b32 v222, v223
  v_add_f32 v220, v220, v221
  v_add_f32 v222, v222, v223
  s_cbranch_scc1 L_s1vS
  v_cndmask_b32_dpp v224, v218, v216, vcc quad_perm:[1,0,3,2] row_mask:0xf bank_mask:0xf
  v_cndmask_b32_dpp v226, v222, v220, vcc quad_perm:[1,0,3,2] row_mask:0xf bank_mask:0xf
  s_mov_b64 vcc, s[76:77]
  v_cndmask_b32_dpp v225, v216, v218, vcc quad_perm:[1,0,3,2] row_mask:0xf bank_mask:0xf
  v_cndmask_b32_dpp v227, v220, v222, vcc quad_perm:[1,0,3,2] row_mask:0xf bank_mask:0xf
  v_cvt_pk_bf16_f32 v12, v224, v225
  v_cvt_pk_bf16_f32 v13, v226, v227
  s_branch L_s1sS
L_s1vS:
  v_cvt_pk_bf16_f32 v12, v216, v218
  v_cvt_pk_bf16_f32 v13, v220, v222
L_s1sS:
  buffer_store_dword v12, v4, s[8:11], s50 offen sc1
  buffer_store_dword v13, v5, s[8:11], s50 offen sc1
  s_cmp_eq_u32 s40, 63
  s_cbranch_scc1 L_fin
  s_cmp_ge_u32 s43, 10
  s_cbranch_scc1 L_s1onlyS
  s_barrier
  s_setprio 0
  s_and_b32 s34, s40, 3
  s_add_u32 s51, s50, 4096
  s_mul_i32 s53, s34, 393216
  s_add_u32 s53, s53, 2097152
  s_add_u32 s53, s53, s32
  s_add_u32 s35, s40, 2
  s_and_b32 s35, s35, 3
  s_mul_i32 s52, s35, 196608
  s_add_u32 s52, s52, 524288
  s_mul_i32 s54, s35, 393216
  s_add_u32 s54, s54, 2097152
  s_add_u32 s54, s54, s32
  s_mul_i32 s36, s28, 10240
  s_add_u32 s36, s36, 131072
  s_add_u32 s35, s40, 1
  s_and_b32 s35, s35, 3
  s_mul_i32 s46, s35, 40960
  s_add_u32 s46, s46, s36
  s_add_u32 s47, s46, 4096
  s_add_u32 s48, s46, 8192
  s_add_u32 s35, s40, 3
  s_and_b32 s35, s35, 3
  s_mul_i32 s49, s35, 40960
  s_add_u32 s49, s49, s36
  s_mul_i32 s55, s40, 196608
  s_add_u32 s55, s55, 83886080
  s_add_u32 s59, s55, 4096
  s_add_u32 s35, s40, 1
  s_lshl_b32 s35, s35, 18
  s_add_u32 s56, s35, 16777216
  s_add_u32 s57, s35, 33554432
  v_mov_b32 v14, -1
  buffer_store_dword v14, v4, s[8:11], s52 offen sc1
  buffer_store_dword v14, v5, s[8:11], s52 offen sc1
  v_mov_b32 v216, 0
  v_mov_b32 v217, 0
  v_mov_b32 v218, 0
  v_mov_b32 v219, 0
  v_mov_b32 v220, 0
  v_mov_b32 v221, 0
  v_mov_b32 v222, 0
  v_mov_b32 v223, 0
  s_add_u32 s61, s40, 2
  s_mov_b32 s62, 1
  s_cmp_ge_u32 s58, s61
  s_cbranch_scc1 kvl_324
  s_cmp_gt_u32 s61, 3
  s_cbranch_scc1 k12_326
  buffer_load_dword v13, v238, s[8:11], 0 offen sc1
  s_waitcnt vmcnt(0)
  v_readlane_b32 s34, v13, 0
  v_readlane_b32 s35, v13, 1
s_nop 3
  s_min_u32 s34, s34, s35
  v_readlane_b32 s35, v13, 2
s_nop 3
  s_min_u32 s34, s34, s35
  v_readlane_b32 s35, v13, 3
s_nop 3
  s_min_u32 s34, s34, s35
  s_mov_b32 s58, s34
  s_cmp_ge_u32 s58, s61
  s_cselect_b32 s62, 1, 0
  s_branch kvq_325
k12_326:
  buffer_load_dword v13, v9, s[8:11], 0 offen sc1
  s_waitcnt vmcnt(0)
  v_readlane_b32 s34, v13, 0
  v_readlane_b32 s35, v13, 1
s_nop 3
  s_min_u32 s58, s34, s35
  s_cmp_ge_u32 s58, s61
  s_cselect_b32 s62, 1, 0
  s_branch kvq_325
kvl_324:
  s_sleep 8
kvq_325:
  s_cmp_eq_u32 s62, 0
  s_cbranch_scc1 kvs_327
  s_cmp_eq_u32 s30, 6
  s_cbranch_scc1 kd_329
  s_add_u32 m0, s60, 0
  s_add_u32 s34, s56, 0
  buffer_load_dwordx4 v8, s[8:11], s34 offen offset:0 sc1 lds
  buffer_load_dwordx4 v8, s[8:11], s34 offen offset:1024 sc1 lds
  buffer_load_dwordx4 v8, s[8:11], s34 offen offset:2048 sc1 lds
  buffer_load_dwordx4 v8, s[8:11], s34 offen offset:3072 sc1 lds
  s_add_u32 m0, s60, 4096
  s_add_u32 s34, s56, 4096
  buffer_load_dwordx4 v8, s[8:11], s34 offen offset:0 sc1 lds
  buffer_load_dwordx4 v8, s[8:11], s34 offen offset:1024 sc1 lds
  buffer_load_dwordx4 v8, s[8:11], s34 offen offset:2048 sc1 lds
  buffer_load_dwordx4 v8, s[8:11], s34 offen offset:3072 sc1 lds
  s_add_u32 m0, s60, 8192
  s_add_u32 s34, s57, 0
  buffer_load_dwordx4 v8, s[8:11], s34 offen offset:0 sc1 lds
  buffer_load_dwordx4 v8, s[8:11], s34 offen offset:1024 sc1 lds
  buffer_load_dwordx4 v8, s[8:11], s34 offen offset:2048 sc1 lds
  buffer_load_dwordx4 v8, s[8:11], s34 offen offset:3072 sc1 lds
  s_add_u32 m0, s60, 12288
  s_add_u32 s34, s57, 4096
  buffer_load_dwordx4 v8, s[8:11], s34 offen offset:0 sc1 lds
  buffer_load_dwordx4 v8, s[8:11], s34 offen offset:1024 sc1 lds
  buffer_load_dwordx4 v8, s[8:11], s34 offen offset:2048 sc1 lds
  buffer_load_dwordx4 v8, s[8:11], s34 offen offset:3072 sc1 lds
  s_cmp_eq_u32 s30, 7
  s_cbranch_scc0 kd_329
  s_sub_u32 m0, s60, 16384
  s_sub_u32 s34, s56, 8192
  buffer_load_dwordx4 v8, s[8:11], s34 offen offset:0 sc1 lds
  buffer_load_dwordx4 v8, s[8:11], s34 offen offset:1024 sc1 lds
  buffer_load_dwordx4 v8, s[8:11], s34 offen offset:2048 sc1 lds
  buffer_load_dwordx4 v8, s[8:11], s34 offen offset:3072 sc1 lds
  s_sub_u32 m0, s60, 12288
  s_sub_u32 s34, s56, 4096
  buffer_load_dwordx4 v8, s[8:11], s34 offen offset:0 sc1 lds
  buffer_load_dwordx4 v8, s[8:11], s34 offen offset:1024 sc1 lds
  buffer_load_dwordx4 v8, s[8:11], s34 offen offset:2048 sc1 lds
  buffer_load_dwordx4 v8, s[8:11], s34 offen offset:3072 sc1 lds
  s_sub_u32 m0, s60, 8192
  s_sub_u32 s34, s57, 8192
  buffer_load_dwordx4 v8, s[8:11], s34 offen offset:0 sc1 lds
  buffer_load_dwordx4 v8, s[8:11], s34 offen offset:1024 sc1 lds
  buffer_load_dwordx4 v8, s[8:11], s34 offen offset:2048 sc1 lds
  buffer_load_dwordx4 v8, s[8:11], s34 offen offset:3072 sc1 lds
  s_sub_u32 m0, s60, 4096
  s_sub_u32 s34, s57, 4096
  buffer_load_dwordx4 v8, s[8:11], s34 offen offset:0 sc1 lds
  buffer_load_dwordx4 v8, s[8:11], s34 offen offset:1024 sc1 lds
  buffer_load_dwordx4 v8, s[8:11], s34 offen offset:2048 sc1 lds
  buffer_load_dwordx4 v8, s[8:11], s34 offen offset:3072 sc1 lds
kd_329:
kvs_327:
  s_setprio 3
  s_barrier
  s_cmp_ge_u32 s30, 6
  s_cbranch_scc1 L_bw6S
  ds_read_b128 v[176:179], v6 offset:0
  ds_read_b128 v[180:183], v6 offset:2048
  ds_read_b128 v[184:187], v6 offset:4096
  ds_read_b128 v[188:191], v6 offset:6144
  s_waitcnt lgkmcnt(2)
  v_pk_add_f32 v[176:177], v[176:177], v[180:181]
  v_pk_add_f32 v[178:179], v[178:179], v[182:183]
  s_waitcnt lgkmcnt(0)
  v_pk_add_f32 v[184:185], v[184:185], v[188:189]
  v_pk_add_f32 v[186:187], v[186:187], v[190:191]
  v_pk_add_f32 v[176:177], v[176:177], v[184:185]
  v_pk_add_f32 v[178:179], v[178:179], v[186:187]
  buffer_store_dwordx4 v[176:179], v7, s[8:11], s53 offen sc1
  v_mov_b32 v180, -1
  v_mov_b32 v181, -1
  v_mov_b32 v182, -1
  v_mov_b32 v183, -1
  buffer_store_dwordx4 v[180:183], v7, s[8:11], s54 offen sc1
  s_branch L_b3S
L_bw6S:
  s_cmp_lg_u32 s30, 6
  s_cbranch_scc1 L_b3S
  s_sleep 11
  buffer_load_dwordx4 v[176:179], v240, s[8:11], s53 offen sc1
  buffer_load_dwordx4 v[180:183], v241, s[8:11], s53 offen sc1
  buffer_load_dwordx4 v[184:187], v242, s[8:11], s53 offen sc1
  buffer_load_dwordx4 v[188:191], v243, s[8:11], s53 offen sc1
  buffer_load_dwordx4 v[192:195], v244, s[8:11], s53 offen sc1
  buffer_load_dwordx4 v[196:199], v245, s[8:11], s53 offen sc1
  buffer_load_dwordx4 v[200:203], v246, s[8:11], s53 offen sc1
  buffer_load_dwordx4 v[204:207], v247, s[8:11], s53 offen sc1
  s_mov_b32 s39, 0
ppc_331:
  s_waitcnt vmcnt(7)
  v_mov_b32 v224, v176
  s_waitcnt vmcnt(6)
  v_max_u32 v224, v224, v180
  v_pk_add_f32 v[176:177], v[176:177], v[180:181]
  v_pk_add_f32 v[178:179], v[178:179], v[182:183]
  s_waitcnt vmcnt(5)
  v_max_u32 v224, v224, v184
  v_pk_add_f32 v[176:177], v[176:177], v[184:185]
  v_pk_add_f32 v[178:179], v[178:179], v[186:187]
  s_waitcnt vmcnt(4)
  v_max_u32 v224, v224, v188
  v_pk_add_f32 v[176:177], v[176:177], v[188:189]
  v_pk_add_f32 v[178:179], v[178:179], v[190:191]
  s_waitcnt vmcnt(3)
  v_max_u32 v224, v224, v192
  v_pk_add_f32 v[176:177], v[176:177], v[192:193]
  v_pk_add_f32 v[178:179], v[178:179], v[194:195]
  s_waitcnt vmcnt(2)
  v_max_u32 v224, v224, v196
  v_pk_add_f32 v[176:177], v[176:177], v[196:197]
  v_pk_add_f32 v[178:179], v[178:179], v[198:199]
  s_waitcnt vmcnt(1)
  v_max_u32 v224, v224, v200
  v_pk_add_f32 v[176:177], v[176:177], v[200:201]
  v_pk_add_f32 v[178:179], v[178:179], v[202:203]
  s_waitcnt vmcnt(0)
  v_max_u32 v224, v224, v204
  v_pk_add_f32 v[176:177], v[176:177], v[204:205]
  v_pk_add_f32 v[178:179], v[178:179], v[206:207]
  v_cmp_eq_u32 vcc, -1, v224
  s_cbranch_vccnz pps_330
ppb_332:
  v_cvt_pk_bf16_f32 v176, v176, v177
  v_cvt_pk_bf16_f32 v177, v178, v179
  buffer_store_dword v176, v6, s[8:11], s46 offen sc1
  buffer_store_dword v177, v6, s[8:11], s46 offen offset:128 sc1
L_b3S:
  s_barrier
  s_sleep 2
  s_cmp_ge_u32 s30, 6
  s_cbranch_scc1 mA_333
  buffer_load_dwordx4 v[224:227], v3, s[8:11], s46 offen sc1
  buffer_load_dwordx4 v[228:231], v3, s[8:11], s47 offen sc1
  buffer_load_dwordx4 v[232:235], v3, s[8:11], s48 offen sc1
  s_mov_b32 s39, 0
pmc_336:
  s_waitcnt vmcnt(2)
  v_max3_u32 v236, v224, v225, v226
  v_max_u32 v236, v236, v227
  v_cmp_eq_u32 vcc, -1, v236
  s_cbranch_vccnz pms_335
pmb_337:
  ds_write_b128 v11, v[224:227] offset:0
pmc_339:
  s_waitcnt vmcnt(1)
  v_max3_u32 v236, v228, v229, v230
  v_max_u32 v236, v236, v231
  v_cmp_eq_u32 vcc, -1, v236
  s_cbranch_vccnz pms_338
pmb_340:
  ds_write_b128 v11, v[228:231] offset:4096
pmc_342:
  s_waitcnt vmcnt(0)
  v_max3_u32 v236, v232, v233, v234
  v_max_u32 v236, v236, v235
  v_cmp_eq_u32 vcc, -1, v236
  s_cbranch_vccnz pms_341
pmb_343:
  ds_write_b128 v11, v[232:235] offset:8192
  s_branch mD_334
mA_333:
  buffer_load_dwordx4 v[224:227], v3, s[8:11], s46 offen sc1
  buffer_load_dwordx4 v[228:231], v3, s[8:11], s47 offen sc1
  s_mov_b32 s39, 0
pmc_345:
  s_waitcnt vmcnt(1)
  v_max3_u32 v236, v224, v225, v226
  v_max_u32 v236, v236, v227
  v_cmp_eq_u32 vcc, -1, v236
  s_cbranch_vccnz pms_344
pmb_346:
  ds_write_b128 v11, v[224:227] offset:0
pmc_348:
  s_waitcnt vmcnt(0)
  v_max3_u32 v236, v228, v229, v230
  v_max_u32 v236, v236, v231
  v_cmp_eq_u32 vcc, -1, v236
  s_cbranch_vccnz pms_347
pmb_349:
  ds_write_b128 v11, v[228:231] offset:4096
mD_334:
  s_cmp_lg_u32 s62, 0
  s_cbranch_scc1 kvz_350
  s_cmp_gt_u32 s61, 3
  s_cbranch_scc1 k12a_351
  s_mov_b32 s39, 0
  s_mov_b64 s[70:71], exec
  s_mov_b32 exec_lo, 0xf
  s_mov_b32 exec_hi, 0x0
k12w_353:
  buffer_load_dword v13, v238, s[8:11], 0 offen sc1
  s_waitcnt vmcnt(0)
  v_cmp_gt_u32 vcc, s61, v13
  s_cbranch_vccz k12wd_354
  s_sleep 1
  s_add_u32 s39, s39, 1
  s_cmp_lt_u32 s39, s33
  s_cbranch_scc1 k12w_353
  s_mov_b32 s33, 0
k12wd_354:
  s_mov_b64 exec, s[70:71]
  s_mov_b32 s58, s61
  s_branch k12b_352
k12a_351:
  s_cmp_ge_u32 s58, s61
  s_cbranch_scc1 kvok_355
  s_mov_b32 s39, 0
kvp_356:
  buffer_load_dword v13, v9, s[8:11], 0 offen sc1
  s_waitcnt vmcnt(0)
  v_readlane_b32 s34, v13, 0
  v_readlane_b32 s35, v13, 1
s_nop 3
  s_min_u32 s58, s34, s35
  s_cmp_ge_u32 s58, s61
  s_cbranch_scc1 kvok_355
  s_sleep 2
  s_add_u32 s39, s39, 1
  s_cmp_lt_u32 s39, s33
  s_cbranch_scc1 kvp_356
  s_mov_b32 s33, 0
kvok_355:
k12b_352:
  s_cmp_eq_u32 s30, 6
  s_cbranch_scc1 kd_358
  s_add_u32 m0, s60, 0
  s_add_u32 s34, s56, 0
  buffer_load_dwordx4 v8, s[8:11], s34 offen offset:0 sc1 lds
  buffer_load_dwordx4 v8, s[8:11], s34 offen offset:1024 sc1 lds
  buffer_load_dwordx4 v8, s[8:11], s34 offen offset:2048 sc1 lds
  buffer_load_dwordx4 v8, s[8:11], s34 offen offset:3072 sc1 lds
  s_add_u32 m0, s60, 4096
  s_add_u32 s34, s56, 4096
  buffer_load_dwordx4 v8, s[8:11], s34 offen offset:0 sc1 lds
  buffer_load_dwordx4 v8, s[8:11], s34 offen offset:1024 sc1 lds
  buffer_load_dwordx4 v8, s[8:11], s34 offen offset:2048 sc1 lds
  buffer_load_dwordx4 v8, s[8:11], s34 offen offset:3072 sc1 lds
  s_add_u32 m0, s60, 8192
  s_add_u32 s34, s57, 0
  buffer_load_dwordx4 v8, s[8:11], s34 offen offset:0 sc1 lds
  buffer_load_dwordx4 v8, s[8:11], s34 offen offset:1024 sc1 lds
  buffer_load_dwordx4 v8, s[8:11], s34 offen offset:2048 sc1 lds
  buffer_load_dwordx4 v8, s[8:11], s34 offen offset:3072 sc1 lds
  s_add_u32 m0, s60, 12288
  s_add_u32 s34, s57, 4096
  buffer_load_dwordx4 v8, s[8:11], s34 offen offset:0 sc1 lds
  buffer_load_dwordx4 v8, s[8:11], s34 offen offset:1024 sc1 lds
  buffer_load_dwordx4 v8, s[8:11], s34 offen offset:2048 sc1 lds
  buffer_load_dwordx4 v8, s[8:11], s34 offen offset:3072 sc1 lds
  s_cmp_eq_u32 s30, 7
  s_cbranch_scc0 kd_358
  s_sub_u32 m0, s60, 16384
  s_sub_u32 s34, s56, 8192
  buffer_load_dwordx4 v8, s[8:11], s34 offen offset:0 sc1 lds
  buffer_load_dwordx4 v8, s[8:11], s34 offen offset:1024 sc1 lds
  buffer_load_dwordx4 v8, s[8:11], s34 offen offset:2048 sc1 lds
  buffer_load_dwordx4 v8, s[8:11], s34 offen offset:3072 sc1 lds
  s_sub_u32 m0, s60, 12288
  s_sub_u32 s34, s56, 4096
  buffer_load_dwordx4 v8, s[8:11], s34 offen offset:0 sc1 lds
  buffer_load_dwordx4 v8, s[8:11], s34 offen offset:1024 sc1 lds
  buffer_load_dwordx4 v8, s[8:11], s34 offen offset:2048 sc1 lds
  buffer_load_dwordx4 v8, s[8:11], s34 offen offset:3072 sc1 lds
  s_sub_u32 m0, s60, 8192
  s_sub_u32 s34, s57, 8192
  buffer_load_dwordx4 v8, s[8:11], s34 offen offset:0 sc1 lds
  buffer_load_dwordx4 v8, s[8:11], s34 offen offset:1024 sc1 lds
  buffer_load_dwordx4 v8, s[8:11], s34 offen offset:2048 sc1 lds
  buffer_load_dwordx4 v8, s[8:11], s34 offen offset:3072 sc1 lds
  s_sub_u32 m0, s60, 4096
  s_sub_u32 s34, s57, 4096
  buffer_load_dwordx4 v8, s[8:11], s34 offen offset:0 sc1 lds
  buffer_load_dwordx4 v8, s[8:11], s34 offen offset:1024 sc1 lds
  buffer_load_dwordx4 v8, s[8:11], s34 offen offset:2048 sc1 lds
  buffer_load_dwordx4 v8, s[8:11], s34 offen offset:3072 sc1 lds
kd_358:
  s_waitcnt vmcnt(0)
kvz_350:
  s_cmp_lg_u32 s30, 6
  s_cbranch_scc1 L_nextS
  v_mov_b32 v14, -1
  buffer_store_dword v14, v6, s[8:11], s49 offen sc1
  buffer_store_dword v14, v6, s[8:11], s49 offen offset:128 sc1
L_nextS:
  s_waitcnt lgkmcnt(0)
  s_add_u32 s40, s40, 1
  s_branch L_stepS
L_s1onlyS:
  s_and_b32 s34, s40, 3
  s_add_u32 s51, s50, 4096
  s_mul_i32 s53, s34, 393216
  s_add_u32 s53, s53, 2097152
  s_add_u32 s53, s53, s32
  s_add_u32 s35, s40, 2
  s_and_b32 s35, s35, 3
  s_mul_i32 s52, s35, 196608
  s_add_u32 s52, s52, 524288
  s_mul_i32 s54, s35, 393216
  s_add_u32 s54, s54, 2097152
  s_add_u32 s54, s54, s32
  s_mul_i32 s36, s28, 10240
  s_add_u32 s36, s36, 131072
  s_add_u32 s35, s40, 1
  s_and_b32 s35, s35, 3
  s_mul_i32 s46, s35, 40960
  s_add_u32 s46, s46, s36
  s_add_u32 s47, s46, 4096
  s_add_u32 s48, s46, 8192
  s_add_u32 s35, s40, 3
  s_and_b32 s35, s35, 3
  s_mul_i32 s49, s35, 40960
  s_add_u32 s49, s49, s36
  s_mul_i32 s55, s40, 196608
  s_add_u32 s55, s55, 83886080
  s_add_u32 s59, s55, 4096
  s_add_u32 s35, s40, 1
  s_lshl_b32 s35, s35, 18
  s_add_u32 s56, s35, 16777216
  s_add_u32 s57, s35, 33554432
  s_mov_b32 s62, 1
  v_mov_b32 v14, -1
  buffer_store_dword v14, v4, s[8:11], s52 offen sc1
  buffer_store_dword v14, v5, s[8:11], s52 offen sc1
  v_mov_b32 v216, 0
  v_mov_b32 v217, 0
  v_mov_b32 v218, 0
  v_mov_b32 v219, 0
  v_mov_b32 v220, 0
  v_mov_b32 v221, 0
  v_mov_b32 v222, 0
  v_mov_b32 v223, 0
  s_sleep 52
  s_cmp_ge_u32 s30, 6
  s_cbranch_scc1 mA_359
  buffer_load_dwordx4 v[224:227], v3, s[8:11], s46 offen sc1
  buffer_load_dwordx4 v[228:231], v3, s[8:11], s47 offen sc1
  buffer_load_dwordx4 v[232:235], v3, s[8:11], s48 offen sc1
  s_mov_b32 s39, 0
pmc_362:
  s_waitcnt vmcnt(2)
  v_max3_u32 v236, v224, v225, v226
  v_max_u32 v236, v236, v227
  v_cmp_eq_u32 vcc, -1, v236
  s_cbranch_vccnz pms_361
pmb_363:
  ds_write_b128 v11, v[224:227] offset:0
pmc_365:
  s_waitcnt vmcnt(1)
  v_max3_u32 v236, v228, v229, v230
  v_max_u32 v236, v236, v231
  v_cmp_eq_u32 vcc, -1, v236
  s_cbranch_vccnz pms_364
pmb_366:
  ds_write_b128 v11, v[228:231] offset:4096
pmc_368:
  s_waitcnt vmcnt(0)
  v_max3_u32 v236, v232, v233, v234
  v_max_u32 v236, v236, v235
  v_cmp_eq_u32 vcc, -1, v236
  s_cbranch_vccnz pms_367
pmb_369:
  ds_write_b128 v11, v[232:235] offset:8192
  s_branch mD_360
mA_359:
  buffer_load_dwordx4 v[224:227], v3, s[8:11], s46 offen sc1
  buffer_load_dwordx4 v[228:231], v3, s[8:11], s47 offen sc1
  s_mov_b32 s39, 0
pmc_371:
  s_waitcnt vmcnt(1)
  v_max3_u32 v236, v224, v225, v226
  v_max_u32 v236, v236, v227
  v_cmp_eq_u32 vcc, -1, v236
  s_cbranch_vccnz pms_370
pmb_372:
  ds_write_b128 v11, v[224:227] offset:0
pmc_374:
  s_waitcnt vmcnt(0)
  v_max3_u32 v236, v228, v229, v230
  v_max_u32 v236, v236, v231
  v_cmp_eq_u32 vcc, -1, v236
  s_cbranch_vccnz pms_373
pmb_375:
  ds_write_b128 v11, v[228:231] offset:4096
mD_360:
  s_branch L_nextS
L_awS:
  s_setprio 2
  s_and_b32 s34, s40, 3
  s_mul_i32 s50, s34, 196608
  s_add_u32 s50, s50, 524288
  s_and_b32 s34, s40, 3
  s_add_u32 s51, s50, 4096
  s_mul_i32 s53, s34, 393216
  s_add_u32 s53, s53, 2097152
  s_add_u32 s53, s53, s32
  s_add_u32 s35, s40, 2
  s_and_b32 s35, s35, 3
  s_mul_i32 s52, s35, 196608
  s_add_u32 s52, s52, 524288
  s_mul_i32 s54, s35, 393216
  s_add_u32 s54, s54, 2097152
  s_add_u32 s54, s54, s32
  s_mul_i32 s36, s28, 10240
  s_add_u32 s36, s36, 131072
  s_add_u32 s35, s40, 1
  s_and_b32 s35, s35, 3
  s_mul_i32 s46, s35, 40960
  s_add_u32 s46, s46, s36
  s_add_u32 s47, s46, 4096
  s_add_u32 s48, s46, 8192
  s_add_u32 s35, s40, 3
  s_and_b32 s35, s35, 3
  s_mul_i32 s49, s35, 40960
  s_add_u32 s49, s49, s36
  s_mul_i32 s55, s40, 196608
  s_add_u32 s55, s55, 83886080
  s_add_u32 s59, s55, 4096
  s_add_u32 s35, s40, 1
  s_lshl_b32 s35, s35, 18
  s_add_u32 s56, s35, 16777216
  s_add_u32 s57, s35, 33554432
  s_cmp_ge_u32 s43, 10
  s_cbranch_scc1 L_aidleS
  s_cmp_eq_u32 s40, 63
  s_cbranch_scc1 L_fin
  s_sleep 3
  ds_read_b128 v[80:83], v14 offset:0
  ds_read_b128 v[84:87], v14 offset:1024
  ds_read_b128 v[88:91], v14 offset:2048
  ds_read_b128 v[92:95], v14 offset:3072
  ds_read_b128 v[96:99], v14 offset:4096
  ds_read_b128 v[100:103], v14 offset:5120
  ds_read_b128 v[104:107], v14 offset:6144
  ds_read_b128 v[108:111], v14 offset:7168
  s_waitcnt lgkmcnt(0)
  ds_read_b128 v[112:115], v14 offset:8192
  ds_read_b128 v[116:119], v14 offset:9216
  ds_read_b128 v[120:123], v14 offset:10240
  ds_read_b128 v[124:127], v14 offset:11264
  ds_read_b128 v[128:131], v14 offset:12288
  ds_read_b128 v[132:135], v14 offset:13312
  ds_read_b128 v[136:139], v14 offset:14336
  ds_read_b128 v[140:143], v14 offset:15360
  s_waitcnt lgkmcnt(0)
  s_barrier
  s_sleep 6
  s_mov_b32 s39, 0
  buffer_load_dwordx4 v[144:147], v3, s[8:11], s50 offen offset:0 sc1
  buffer_load_dwordx4 v[148:151], v3, s[8:11], s50 offen offset:1024 sc1
  buffer_load_dwordx4 v[152:155], v3, s[8:11], s50 offen offset:2048 sc1
  buffer_load_dwordx4 v[156:159], v3, s[8:11], s50 offen offset:3072 sc1
  s_sleep 1
  buffer_load_dwordx4 v[160:163], v3, s[8:11], s51 offen offset:0 sc1
  buffer_load_dwordx4 v[164:167], v3, s[8:11], s51 offen offset:1024 sc1
  s_waitcnt vmcnt(2)
pqm_376:
  v_mfma_f32_16x16x32_bf16 v[168:171], v[80:83], v[144:147], 0
  v_max3_u32 v244, v144, v145, v146
  v_max3_u32 v244, v244, v147, v148
  v_mfma_f32_16x16x32_bf16 v[168:171], v[84:87], v[148:151], v[168:171]
  v_max3_u32 v244, v244, v149, v150
  v_max3_u32 v244, v244, v151, v152
  v_mfma_f32_16x16x32_bf16 v[168:171], v[88:91], v[152:155], v[168:171]
  v_max3_u32 v244, v244, v153, v154
  v_max3_u32 v244, v244, v155, v156
  v_mfma_f32_16x16x32_bf16 v[168:171], v[92:95], v[156:159], v[168:171]
  v_max3_u32 v244, v244, v157, v158
  v_max_u32 v244, v244, v159
  v_mfma_f32_16x16x32_bf16 v[172:175], v[96:99], v[144:147], 0
  v_cmp_eq_u32 vcc, -1, v244
  v_mfma_f32_16x16x32_bf16 v[172:175], v[100:103], v[148:151], v[172:175]
  s_cbranch_vccnz pqr_377
pqx_378:
  v_mfma_f32_16x16x32_bf16 v[172:175], v[104:107], v[152:155], v[172:175]
  v_mov_b32 v186, 0
  v_mov_b32 v187, 0
  v_mfma_f32_16x16x32_bf16 v[172:175], v[108:111], v[156:159], v[172:175]
  v_mfma_f32_16x16x32_bf16 v[176:179], v[144:147], v[144:147], v[240:243]
  v_max3_f32 v244, v168, v169, v170
  v_mfma_f32_16x16x32_bf16 v[176:179], v[148:151], v[148:151], v[176:179]
  v_mfma_f32_16x16x32_bf16 v[176:179], v[152:155], v[152:155], v[176:179]
s_nop 3
  v_max3_f32 v244, v244, v171, v172
  v_mfma_f32_16x16x32_bf16 v[176:179], v[156:159], v[156:159], v[176:179]
  v_max3_f32 v244, v244, v173, v174
  v_max_f32 v244, v244, v175
s_nop 5
  v_max3_f32 v244, v244, v176, v177
  v_max3_f32 v244, v244, v178, v179
  v_mov_b32 v245, v244
s_nop 1
  v_permlane16_swap_b32 v244, v245
  v_max_f32 v244, v244, v245
  v_mov_b32 v245, v244
s_nop 1
  v_permlane32_swap_b32 v244, v245
  v_max_f32 v244, v244, v245
  v_mul_f32 v244, s79, v244
  v_mul_f32 v245, 1.0, v244
  v_pk_fma_f32 v[168:169], v[168:169], s[66:67], v[244:245]
  v_pk_fma_f32 v[170:171], v[170:171], s[66:67], v[244:245]
  v_pk_fma_f32 v[172:173], v[172:173], s[66:67], v[244:245]
  v_pk_fma_f32 v[174:175], v[174:175], s[66:67], v[244:245]
  v_pk_fma_f32 v[176:177], v[176:177], s[66:67], v[244:245]
  v_pk_fma_f32 v[178:179], v[178:179], s[66:67], v[244:245]
  v_exp_f32 v168, v168
  v_exp_f32 v169, v169
  v_exp_f32 v170, v170
  v_exp_f32 v171, v171
  v_exp_f32 v172, v172
  v_exp_f32 v173, v173
  v_exp_f32 v174, v174
  v_exp_f32 v175, v175
  v_cvt_pk_bf16_f32 v180, v168, v169
  v_cvt_pk_bf16_f32 v181, v170, v171
  v_cvt_pk_bf16_f32 v182, v172, v173
  v_cvt_pk_bf16_f32 v183, v174, v175
  s_waitcnt vmcnt(0)
  v_max3_u32 v247, v160, v161, v162
  v_max3_u32 v247, v247, v163, v164
  v_mfma_f32_16x16x32_bf16 v[192:195], v[112:115], v[180:183], 0
  v_exp_f32 v176, v176
  v_max3_u32 v247, v247, v165, v166
  v_mfma_f32_16x16x32_bf16 v[196:199], v[116:119], v[180:183], 0
  v_exp_f32 v177, v177
  v_max_u32 v247, v247, v167
  v_mfma_f32_16x16x32_bf16 v[200:203], v[120:123], v[180:183], 0
  v_exp_f32 v178, v178
  v_add_f32 v245, v168, v169
  v_mfma_f32_16x16x32_bf16 v[204:207], v[124:127], v[180:183], 0
  v_exp_f32 v179, v179
  v_add_f32 v246, v170, v171
  v_mfma_f32_16x16x32_bf16 v[208:211], v[128:131], v[180:183], 0
  v_cvt_pk_bf16_f32 v184, v176, v178
  v_cvt_pk_bf16_f32 v185, v177, v179
  v_cmp_eq_u32 vcc, -1, v247
  v_mfma_f32_16x16x32_bf16 v[212:215], v[132:135], v[180:183], 0
  v_mov_b32 v188, v184
  v_mov_b32 v189, v185
  v_mfma_f32_16x16x32_bf16 v[216:219], v[136:139], v[180:183], 0
  v_add_f32 v245, v245, v172
  v_add_f32 v246, v246, v173
  v_mfma_f32_16x16x32_bf16 v[220:223], v[140:143], v[180:183], 0
  v_permlane32_swap_b32 v188, v186
  v_permlane32_swap_b32 v189, v187
  s_cbranch_vccnz pvr_379
pvb_380:
  v_mfma_f32_16x16x16_bf16 v[192:195], v[160:161], v[184:185], v[192:195]
  v_add_f32 v245, v245, v176
  v_add_f32 v246, v246, v177
  v_mfma_f32_16x16x16_bf16 v[196:199], v[160:161], v[186:187], v[196:199]
  v_add_f32 v245, v245, v178
  v_add_f32 v246, v246, v179
  v_mfma_f32_16x16x16_bf16 v[200:203], v[162:163], v[184:185], v[200:203]
  v_add_f32 v245, v245, v174
  v_add_f32 v246, v246, v175
  v_mfma_f32_16x16x16_bf16 v[204:207], v[162:163], v[186:187], v[204:207]
  v_add_f32 v245, v245, v246
  v_mov_b32 v246, v245
  v_mfma_f32_16x16x16_bf16 v[208:211], v[164:165], v[184:185], v[208:211]
  v_cvt_pk_bf16_f32 v224, v192, v193
  v_cvt_pk_bf16_f32 v225, v194, v195
  v_mfma_f32_16x16x16_bf16 v[212:215], v[164:165], v[186:187], v[212:215]
  v_cvt_pk_bf16_f32 v226, v196, v197
  v_cvt_pk_bf16_f32 v227, v198, v199
  v_mfma_f32_16x16x16_bf16 v[216:219], v[166:167], v[184:185], v[216:219]
  v_cvt_pk_bf16_f32 v228, v200, v201
  v_cvt_pk_bf16_f32 v229, v202, v203
  v_mfma_f32_16x16x16_bf16 v[220:223], v[166:167], v[186:187], v[220:223]
  v_cvt_pk_bf16_f32 v230, v204, v205
  v_cvt_pk_bf16_f32 v231, v206, v207
  v_mfma_f32_16x16x32_bf16 v[144:147], v[16:19], v[224:227], 0
  v_permlane16_swap_b32 v245, v246
  v_mfma_f32_16x16x32_bf16 v[148:151], v[32:35], v[224:227], 0
  v_cvt_pk_bf16_f32 v232, v208, v209
  v_cvt_pk_bf16_f32 v233, v210, v211
  v_mfma_f32_16x16x32_bf16 v[152:155], v[48:51], v[224:227], 0
  v_cvt_pk_bf16_f32 v234, v212, v213
  v_cvt_pk_bf16_f32 v235, v214, v215
  v_mfma_f32_16x16x32_bf16 v[156:159], v[64:67], v[224:227], 0
  v_add_f32 v245, v245, v246
  v_mov_b32 v246, v245
  v_mfma_f32_16x16x32_bf16 v[144:147], v[20:23], v[228:231], v[144:147]
  v_cvt_pk_bf16_f32 v236, v216, v217
  v_cvt_pk_bf16_f32 v237, v218, v219
  v_mfma_f32_16x16x32_bf16 v[148:151], v[36:39], v[228:231], v[148:151]
  v_cvt_pk_bf16_f32 v238, v220, v221
  v_cvt_pk_bf16_f32 v239, v222, v223
  v_mfma_f32_16x16x32_bf16 v[152:155], v[52:55], v[228:231], v[152:155]
  v_permlane32_swap_b32 v245, v246
  v_mfma_f32_16x16x32_bf16 v[156:159], v[68:71], v[228:231], v[156:159]
  v_add_f32 v245, v245, v246
  v_mfma_f32_16x16x32_bf16 v[144:147], v[24:27], v[232:235], v[144:147]
  v_rcp_f32 v245, v245
  v_mfma_f32_16x16x32_bf16 v[144:147], v[28:31], v[236:239], v[144:147]
  v_mfma_f32_16x16x32_bf16 v[148:151], v[40:43], v[232:235], v[148:151]
  v_mov_b32 v244, v245
  v_mfma_f32_16x16x32_bf16 v[148:151], v[44:47], v[236:239], v[148:151]
  v_mfma_f32_16x16x32_bf16 v[152:155], v[56:59], v[232:235], v[152:155]
  v_mfma_f32_16x16x32_bf16 v[152:155], v[60:63], v[236:239], v[152:155]
  v_mfma_f32_16x16x32_bf16 v[156:159], v[72:75], v[232:235], v[156:159]
  v_mfma_f32_16x16x32_bf16 v[156:159], v[76:79], v[236:239], v[156:159]
s_nop 0
  v_pk_mul_f32 v[144:145], v[144:145], v[244:245]
  v_pk_mul_f32 v[146:147], v[146:147], v[244:245]
s_nop 0
  v_pk_mul_f32 v[148:149], v[148:149], v[244:245]
  v_pk_mul_f32 v[150:151], v[150:151], v[244:245]
s_nop 0
  v_mov_b32_dpp v144, v148 row_shr:8 row_mask:0xf bank_mask:0xc
  v_mov_b32_dpp v145, v149 row_shr:8 row_mask:0xf bank_mask:0xc
  v_mov_b32_dpp v146, v150 row_shr:8 row_mask:0xf bank_mask:0xc
  v_mov_b32_dpp v147, v151 row_shr:8 row_mask:0xf bank_mask:0xc
  ds_write_b128 v5, v[144:147] offset:0
  v_pk_mul_f32 v[152:153], v[152:153], v[244:245]
  v_pk_mul_f32 v[154:155], v[154:155], v[244:245]
  v_pk_mul_f32 v[156:157], v[156:157], v[244:245]
  v_pk_mul_f32 v[158:159], v[158:159], v[244:245]
s_nop 0
  v_mov_b32_dpp v152, v156 row_shr:8 row_mask:0xf bank_mask:0xc
  v_mov_b32_dpp v153, v157 row_shr:8 row_mask:0xf bank_mask:0xc
  v_mov_b32_dpp v154, v158 row_shr:8 row_mask:0xf bank_mask:0xc
  v_mov_b32_dpp v155, v159 row_shr:8 row_mask:0xf bank_mask:0xc
  ds_write_b128 v5, v[152:155] offset:1024
  s_waitcnt lgkmcnt(0)
  s_barrier
  s_barrier
  s_branch L_nextS
pqr_377:
  s_add_u32 s39, s39, 1
  s_cmp_ge_u32 s39, s33
  s_cbranch_scc1 pqr_377_t
  buffer_load_dwordx4 v[144:147], v3, s[8:11], s50 offen offset:0 sc1
  buffer_load_dwordx4 v[148:151], v3, s[8:11], s50 offen offset:1024 sc1
  buffer_load_dwordx4 v[152:155], v3, s[8:11], s50 offen offset:2048 sc1
  buffer_load_dwordx4 v[156:159], v3, s[8:11], s50 offen offset:3072 sc1
  s_waitcnt vmcnt(0)
  s_branch pqm_376
pqr_377_t:
  s_mov_b32 s33, 0
  s_branch pqx_378
pvr_379:
  s_add_u32 s39, s39, 1
  s_cmp_ge_u32 s39, s33
  s_cbranch_scc1 pvr_379_t
  buffer_load_dwordx4 v[160:163], v3, s[8:11], s51 offen offset:0 sc1
  buffer_load_dwordx4 v[164:167], v3, s[8:11], s51 offen offset:1024 sc1
  s_waitcnt vmcnt(0)
  v_max3_u32 v247, v160, v161, v162
  v_max3_u32 v247, v247, v163, v164
  v_max3_u32 v247, v247, v165, v166
  v_max_u32 v247, v247, v167
  v_cmp_eq_u32 vcc, -1, v247
  s_cbranch_vccnz pvr_379
  s_branch pvb_380
pvr_379_t:
  s_mov_b32 s33, 0
  s_branch pvb_380
L_aidleS:
  s_cmp_eq_u32 s43, 10
  s_cbranch_scc0 L_awarmS
  s_sleep 14
  s_mov_b32 s39, 0
pkS_381:
  buffer_load_dwordx4 v[144:147], v3, s[8:11], s50 offen offset:0 sc1
  buffer_load_dwordx4 v[148:151], v3, s[8:11], s50 offen offset:1024 sc1
  buffer_load_dwordx4 v[152:155], v3, s[8:11], s50 offen offset:2048 sc1
  buffer_load_dwordx4 v[156:159], v3, s[8:11], s50 offen offset:3072 sc1
  buffer_load_dwordx4 v[160:163], v3, s[8:11], s51 offen offset:0 sc1
  buffer_load_dwordx4 v[164:167], v3, s[8:11], s51 offen offset:1024 sc1
  s_waitcnt vmcnt(0)
  v_max3_u32 v244, v144, v145, v146
  v_max3_u32 v244, v244, v147, v148
  v_max3_u32 v244, v244, v149, v150
  v_max3_u32 v244, v244, v151, v152
  v_max3_u32 v244, v244, v153, v154
  v_max3_u32 v244, v244, v155, v156
  v_max3_u32 v244, v244, v157, v158
  v_max3_u32 v244, v244, v159, v160
  v_max3_u32 v244, v244, v161, v162
  v_max3_u32 v244, v244, v163, v164
  v_max3_u32 v244, v244, v165, v166
  v_max_u32 v244, v244, v167
  v_cmp_eq_u32 vcc, -1, v244
  s_cbranch_vccz pkSd_382
  s_sleep 2
  s_add_u32 s39, s39, 1
  s_cmp_lt_u32 s39, s33
  s_cbranch_scc1 pkS_381
  s_mov_b32 s33, 0
pkSd_382:
  buffer_store_dwordx4 v[144:147], v3, s[8:11], s55 offen offset:0 sc1
  buffer_store_dwordx4 v[148:151], v3, s[8:11], s55 offen offset:1024 sc1
  buffer_store_dwordx4 v[152:155], v3, s[8:11], s55 offen offset:2048 sc1
  buffer_store_dwordx4 v[156:159], v3, s[8:11], s55 offen offset:3072 sc1
  buffer_store_dwordx4 v[160:163], v3, s[8:11], s59 offen offset:0 sc1
  buffer_store_dwordx4 v[164:167], v3, s[8:11], s59 offen offset:1024 sc1
  s_waitcnt vmcnt(0)
  s_lshl_b32 s34, s44, 2
  s_add_u32 s34, s34, s30
  s_lshl_b32 s34, s34, 7
  s_add_u32 s34, s34, 4096
  s_add_u32 s34, s34, s100
  s_add_u32 s35, s40, 1
  v_mov_b32 v244, s34
  v_mov_b32 v245, s35
  s_mov_b64 exec, 1
  buffer_store_dword v245, v244, s[8:11], 0 offen sc1
  s_mov_b64 exec, -1
  s_cmp_eq_u32 s40, 63
  s_cbranch_scc1 L_fin
  s_branch L_nextS
L_awarmS:
  s_cmp_eq_u32 s40, 63
  s_cbranch_scc1 L_fin
  s_add_u32 s36, s40, 3
  s_cmp_gt_u32 s36, 64
  s_cbranch_scc1 wsk_383
  s_sleep 16
  buffer_load_dword v13, v9, s[8:11], 0 offen sc1
  s_waitcnt vmcnt(0)
  v_readlane_b32 s34, v13, 0
  v_readlane_b32 s35, v13, 1
s_nop 3
  s_min_u32 s34, s34, s35
  s_cmp_lt_u32 s34, s36
  s_cbranch_scc1 wsk_383
  s_add_u32 s36, s40, 2
  s_lshl_b32 s36, s36, 18
  s_add_u32 s37, s36, 33554432
  s_add_u32 s36, s36, 16777216
  s_add_u32 s34, s36, 4096
  s_add_u32 s35, s37, 4096
  buffer_load_dwordx4 v[80:83], v4, s[8:11], s36 offen offset:0 sc1
  buffer_load_dwordx4 v[84:87], v4, s[8:11], s36 offen offset:1024 sc1
  buffer_load_dwordx4 v[88:91], v4, s[8:11], s36 offen offset:2048 sc1
  buffer_load_dwordx4 v[92:95], v4, s[8:11], s36 offen offset:3072 sc1
  buffer_load_dwordx4 v[96:99], v4, s[8:11], s34 offen offset:0 sc1
  buffer_load_dwordx4 v[100:103], v4, s[8:11], s34 offen offset:1024 sc1
  buffer_load_dwordx4 v[104:107], v4, s[8:11], s34 offen offset:2048 sc1
  buffer_load_dwordx4 v[108:111], v4, s[8:11], s34 offen offset:3072 sc1
  buffer_load_dwordx4 v[112:115], v4, s[8:11], s37 offen offset:0 sc1
  buffer_load_dwordx4 v[116:119], v4, s[8:11], s37 offen offset:1024 sc1
  buffer_load_dwordx4 v[120:123], v4, s[8:11], s37 offen offset:2048 sc1
  buffer_load_dwordx4 v[124:127], v4, s[8:11], s37 offen offset:3072 sc1
  buffer_load_dwordx4 v[128:131], v4, s[8:11], s35 offen offset:0 sc1
  buffer_load_dwordx4 v[132:135], v4, s[8:11], s35 offen offset:1024 sc1
  buffer_load_dwordx4 v[136:139], v4, s[8:11], s35 offen offset:2048 sc1
  buffer_load_dwordx4 v[140:143], v4, s[8:11], s35 offen offset:3072 sc1
wsk_383:
  s_branch L_nextS
pps_330:
  s_add_u32 s39, s39, 1
  s_cmp_ge_u32 s39, s33
  s_cbranch_scc1 pps_330_t
  buffer_load_dwordx4 v[176:179], v240, s[8:11], s53 offen sc1
  buffer_load_dwordx4 v[180:183], v241, s[8:11], s53 offen sc1
  buffer_load_dwordx4 v[184:187], v242, s[8:11], s53 offen sc1
  buffer_load_dwordx4 v[188:191], v243, s[8:11], s53 offen sc1
  buffer_load_dwordx4 v[192:195], v244, s[8:11], s53 offen sc1
  buffer_load_dwordx4 v[196:199], v245, s[8:11], s53 offen sc1
  buffer_load_dwordx4 v[200:203], v246, s[8:11], s53 offen sc1
  buffer_load_dwordx4 v[204:207], v247, s[8:11], s53 offen sc1
  s_branch ppc_331
pps_330_t:
  s_mov_b32 s33, 0
  s_waitcnt vmcnt(0)
  s_branch ppb_332
pms_335:
  s_add_u32 s39, s39, 1
  s_cmp_ge_u32 s39, s33
  s_cbranch_scc1 pms_335_t
  buffer_load_dwordx4 v[224:227], v3, s[8:11], s46 offen sc1
  buffer_load_dwordx4 v[228:231], v3, s[8:11], s47 offen sc1
  buffer_load_dwordx4 v[232:235], v3, s[8:11], s48 offen sc1
  s_branch pmc_336
pms_335_t:
  s_mov_b32 s33, 0
  s_waitcnt vmcnt(0)
  s_branch pmb_337
pms_338:
  s_add_u32 s39, s39, 1
  s_cmp_ge_u32 s39, s33
  s_cbranch_scc1 pms_338_t
  buffer_load_dwordx4 v[228:231], v3, s[8:11], s47 offen sc1
  buffer_load_dwordx4 v[232:235], v3, s[8:11], s48 offen sc1
  s_branch pmc_339
pms_338_t:
  s_mov_b32 s33, 0
  s_waitcnt vmcnt(0)
  s_branch pmb_340
pms_341:
  s_add_u32 s39, s39, 1
  s_cmp_ge_u32 s39, s33
  s_cbranch_scc1 pms_341_t
  buffer_load_dwordx4 v[232:235], v3, s[8:11], s48 offen sc1
  s_branch pmc_342
pms_341_t:
  s_mov_b32 s33, 0
  s_waitcnt vmcnt(0)
  s_branch pmb_343
pms_344:
  s_add_u32 s39, s39, 1
  s_cmp_ge_u32 s39, s33
  s_cbranch_scc1 pms_344_t
  buffer_load_dwordx4 v[224:227], v3, s[8:11], s46 offen sc1
  buffer_load_dwordx4 v[228:231], v3, s[8:11], s47 offen sc1
  s_branch pmc_345
pms_344_t:
  s_mov_b32 s33, 0
  s_waitcnt vmcnt(0)
  s_branch pmb_346
pms_347:
  s_add_u32 s39, s39, 1
  s_cmp_ge_u32 s39, s33
  s_cbranch_scc1 pms_347_t
  buffer_load_dwordx4 v[228:231], v3, s[8:11], s47 offen sc1
  s_branch pmc_348
pms_347_t:
  s_mov_b32 s33, 0
  s_waitcnt vmcnt(0)
  s_branch pmb_349
pms_361:
  s_add_u32 s39, s39, 1
  s_cmp_ge_u32 s39, s33
  s_cbranch_scc1 pms_361_t
  s_sleep 1
  buffer_load_dwordx4 v[224:227], v3, s[8:11], s46 offen sc1
  buffer_load_dwordx4 v[228:231], v3, s[8:11], s47 offen sc1
  buffer_load_dwordx4 v[232:235], v3, s[8:11], s48 offen sc1
  s_branch pmc_362
pms_361_t:
  s_mov_b32 s33, 0
  s_waitcnt vmcnt(0)
  s_branch pmb_363
pms_364:
  s_add_u32 s39, s39, 1
  s_cmp_ge_u32 s39, s33
  s_cbranch_scc1 pms_364_t
  s_sleep 1
  buffer_load_dwordx4 v[228:231], v3, s[8:11], s47 offen sc1
  buffer_load_dwordx4 v[232:235], v3, s[8:11], s48 offen sc1
  s_branch pmc_365
pms_364_t:
  s_mov_b32 s33, 0
  s_waitcnt vmcnt(0)
  s_branch pmb_366
pms_367:
  s_add_u32 s39, s39, 1
  s_cmp_ge_u32 s39, s33
  s_cbranch_scc1 pms_367_t
  s_sleep 1
  buffer_load_dwordx4 v[232:235], v3, s[8:11], s48 offen sc1
  s_branch pmc_368
pms_367_t:
  s_mov_b32 s33, 0
  s_waitcnt vmcnt(0)
  s_branch pmb_369
pms_370:
  s_add_u32 s39, s39, 1
  s_cmp_ge_u32 s39, s33
  s_cbranch_scc1 pms_370_t
  s_sleep 1
  buffer_load_dwordx4 v[224:227], v3, s[8:11], s46 offen sc1
  buffer_load_dwordx4 v[228:231], v3, s[8:11], s47 offen sc1
  s_branch pmc_371
pms_370_t:
  s_mov_b32 s33, 0
  s_waitcnt vmcnt(0)
  s_branch pmb_372
pms_373:
  s_add_u32 s39, s39, 1
  s_cmp_ge_u32 s39, s33
  s_cbranch_scc1 pms_373_t
  s_sleep 1
  buffer_load_dwordx4 v[228:231], v3, s[8:11], s47 offen sc1
  s_branch pmc_374
pms_373_t:
  s_mov_b32 s33, 0
  s_waitcnt vmcnt(0)
  s_branch pmb_375
L_fin:
  s_branch L_end
L_end:
L_exit:
  s_endpgm
.section .rodata,"a"
.p2align 6
.amdhsa_kernel concat_heads__memory_aug_recurrent_mem_tr__mha_block__prompt_kernel
  .amdhsa_next_free_vgpr 256
  .amdhsa_next_free_sgpr 102
  .amdhsa_accum_offset 256
  .amdhsa_group_segment_fixed_size 0
  .amdhsa_kernarg_size 104
  .amdhsa_user_sgpr_count 2
  .amdhsa_user_sgpr_kernarg_segment_ptr 1
  .amdhsa_system_sgpr_workgroup_id_x 1
.end_amdhsa_kernel
```
